```python
import torch

def _softmax(x, axis=-1):
    return torch.softmax(x, dim=axis)
def _gelu(x):
    return torch.nn.functional.gelu(x, approximate="tanh")
def _silu(x):
    return torch.nn.functional.silu(x)
def _sigmoid(x):
    return torch.sigmoid(x)
def _layernorm(x, axis=-1, eps=1e-5):
    m = x.mean(dim=axis, keepdim=True)
    v = x.var(dim=axis, keepdim=True, unbiased=False)
    return (x - m) / torch.sqrt(v + eps)
def _scatter_add(tgt, idx, src, axis=0):
    return tgt.clone().index_add_(axis, idx, src)
def _segment_sum(src, seg, n):
    out = torch.zeros((n,) + src.shape[1:], dtype=src.dtype)
    return out.index_add_(0, seg, src)
def _pad(x, pw):
    flat = tuple(v for pair in reversed(pw) for v in pair)
    return torch.nn.functional.pad(x, flat)

kernel_name = 'sequential_preLN__softmax_full_mha__swiglu_ffn__prompt'

def setup_inputs():

    _w = (lambda a: (lambda t: t.to(torch.bfloat16) if t.is_floating_point() else t)(torch.as_tensor(a)))
    def _A_setup():
        B, S, D = 1, 2048, 576
        return {
            "x": _w((lambda *s: torch.randn(*s, dtype=torch.bfloat16) * 0.05)(B, S, D)),
            "wqkv": _w((lambda *s: torch.randn(*s, dtype=torch.bfloat16) * 0.05)(D, 3 * D)),
            "wo": _w((lambda *s: torch.randn(*s, dtype=torch.bfloat16) * 0.05)(D, D)),
        }
    _A_in = _A_setup()

    def _B_setup():
        B, S, D, F = 1, 2048, 576, 4608
        return {
            "x": _w((lambda *s: torch.randn(*s, dtype=torch.bfloat16) * 0.05)(B, S, D)),
            "w_gate": _w((lambda *s: torch.randn(*s, dtype=torch.bfloat16) * 0.05)(D, F)),
            "w_up": _w((lambda *s: torch.randn(*s, dtype=torch.bfloat16) * 0.05)(D, F)),
            "w_down": _w((lambda *s: torch.randn(*s, dtype=torch.bfloat16) * 0.05)(F, D)),
        }
    _B_in = _B_setup()

    return {
        "A_x": _A_in["x"],
        "A_wqkv": _A_in["wqkv"],
        "A_wo": _A_in["wo"],
        "B_x": _B_in["x"],
        "B_w_gate": _B_in["w_gate"],
        "B_w_up": _B_in["w_up"],
        "B_w_down": _B_in["w_down"],
    }

def reference(A_x, A_wqkv, A_wo, B_x, B_w_gate, B_w_up, B_w_down):
    def _A_ref(x, wqkv, wo):
        B, S, D = x.shape
        H = 32; Dh = D // H
        qkv = (lambda x, *d: x.permute(*d))((x @ wqkv).reshape(B, S, 3, H, Dh), 2, 0, 3, 1, 4)
        q, k, v = qkv[0], qkv[1], qkv[2]
        scale = Dh ** -0.5
        scores = torch.einsum("bhqd,bhkd->bhqk", q, k) * scale
        p = _softmax(scores, axis=-1)
        o = torch.einsum("bhqk,bhkd->bhqd", p, v)
        return (lambda x, *d: x.permute(*d))(o, 0, 2, 1, 3).reshape(B, S, D) @ wo

    def _B_ref(x, w_gate, w_up, w_down):
        g = _silu(x @ w_gate)
        u = x @ w_up
        return (g * u) @ w_down

    x = A_x
    h = x + _A_ref(_layernorm(x, axis=-1), A_wqkv, A_wo)
    h2 = h + _B_ref(_layernorm(h, axis=-1), B_w_gate, B_w_up, B_w_down)
    return h2
```

```asm
; @launch grid=(256,1,1) block=(256,1,1) lds=159744
.amdgcn_target "amdgcn-amd-amdhsa--gfx950"
.text
.globl sequential_preLN__softmax_full_mha__swiglu_ffn__prompt_kernel
.p2align 8
.type sequential_preLN__softmax_full_mha__swiglu_ffn__prompt_kernel,@function
sequential_preLN__softmax_full_mha__swiglu_ffn__prompt_kernel:
    s_cmp_ge_u32 s2, 256
    s_cbranch_scc1 Ldone1
    s_load_dwordx4 s[4:7], s[0:1], 0
    s_load_dwordx2 s[8:9], s[0:1], 16
    s_load_dwordx4 s[52:55], s[0:1], 64
    v_lshrrev_b32 v32, 6, v0
    v_and_b32 v1, 63, v0
    v_readfirstlane_b32 s3, v32
    s_getpc_b64 s[48:49]
p1_pc:
    v_lshlrev_b32 v33, 4, v0
    global_load_dwordx4 v[144:147], v33, s[48:49]
    v_add_u32 v33, 4096, v33
    global_load_dwordx4 v[148:151], v33, s[48:49]
    s_bfe_u32 s28, s2, 0x20001
    s_lshl_b32 s28, s28, 2
    s_bfe_u32 s33, s2, 0x20003
    s_add_u32 s28, s28, s33
    s_lshr_b32 s34, s2, 5
    s_and_b32 s33, s2, 1
    s_mul_i32 s29, s33, 7
    s_add_u32 s29, s29, s34
    s_mov_b32 s32, 0x3f803f80
    s_lshr_b32 s43, s3, 1
    s_and_b32 s44, s3, 1
    s_lshl_b32 s31, s29, 1
    s_add_u32 s31, s31, s44
    v_lshrrev_b32 v32, 3, v1
    v_mul_u32_u24 v32, 1152, v32
    v_and_b32 v33, 7, v1
    v_lshrrev_b32 v34, 4, v1
    v_xor_b32 v33, v33, v34
    v_lshl_add_u32 v2, v33, 4, v32
    v_xor_b32 v3, 64, v2
    v_add_u32 v3, 8192, v3
    v_add_u32 v4, 16384, v2
    v_add_u32 v5, 16384, v3
    v_bfe_u32 v35, v1, 2, 2
    v_and_b32 v36, 3, v1
    v_mul_u32_u24 v6, 3456, v35
    v_lshl_add_u32 v6, v34, 6, v6
    v_lshl_add_u32 v6, v36, 4, v6
    v_add_u32 v7, 12800, v6
    v_add_u32 v8, 25600, v6
    v_add_u32 v9, 38400, v6
    s_lshl_b32 s33, s28, 2
    s_add_u32 s33, s33, s3
    s_mul_i32 s36, s33, 36864
    s_mul_i32 s37, s3, 55296
    s_lshl_b32 s33, s29, 8
    s_add_u32 s37, s37, s33
    s_lshl_b32 s38, s3, 12
    s_mov_b32 s47, 9
    v_lshlrev_b32 v37, 15, v1
    v_mov_b32 v38, 0
    v_mov_b32 v39, 1
    s_lshl_b32 s30, s2, 7
    s_add_u32 s30, s30, 0xcc0000
    s_and_b32 s40, s2, 3
    s_lshl_b32 s40, s40, 6
    v_and_b32 v45, 3, v1
    v_lshlrev_b32 v45, 6, v45
    s_waitcnt lgkmcnt(0)
    s_mov_b32 s16, s4
    s_and_b32 s17, s5, 0xffff
    s_mov_b32 s18, 0x240000
    s_mov_b32 s19, 0x00020000
    s_mov_b32 s20, s6
    s_and_b32 s21, s7, 0xffff
    s_mov_b32 s22, 0x1e6000
    s_mov_b32 s23, 0x00020000
    s_mov_b32 s12, s54
    s_and_b32 s13, s55, 0xffff
    s_mov_b32 s14, 0x3c00000
    s_mov_b32 s15, 0x00020000
    s_mov_b32 s24, s52
    s_and_b32 s25, s53, 0xffff
    s_mov_b32 s26, 0x100
    s_mov_b32 s27, 0x00020000
    s_cmp_lg_u32 s3, 0
    s_cbranch_scc1 Lnz4
    s_mov_b64 exec, 31
    buffer_store_dword v38, v37, s[12:15], s30 offen sc1
    s_mov_b64 exec, -1
Lnz4:
    s_cmp_eq_u32 s34, 7
    s_cbranch_scc1 Lside2
    s_mov_b32 m0, s38
    s_nop 0
    buffer_load_dwordx4 v2, s[16:19], s36 offen offset:0 lds
    buffer_load_dwordx4 v3, s[16:19], s36 offen offset:1024 lds
    buffer_load_dwordx4 v4, s[16:19], s36 offen offset:2048 lds
    buffer_load_dwordx4 v5, s[16:19], s36 offen offset:3072 lds
    s_add_u32 m0, s38, 16384
    s_nop 0
    buffer_load_dwordx4 v6, s[20:23], s37 offen offset:0 lds
    buffer_load_dwordx4 v7, s[20:23], s37 offen offset:1024 lds
    buffer_load_dwordx4 v8, s[20:23], s37 offen offset:2048 lds
    buffer_load_dwordx4 v9, s[20:23], s37 offen offset:3072 lds
    s_add_u32 s36, s36, 128
    s_add_u32 s37, s37, 221184
    s_add_u32 s38, s38, 32768
    s_and_b32 s38, s38, 0x1ffff
    s_sub_u32 s47, s47, 1
    s_cmp_eq_u32 s47, 0
    s_cselect_b32 s36, 0x7f000000, s36
    s_mul_i32 s41, s31, 57
    s_lshr_b32 s41, s41, 9
    s_mov_b32 s45, s3
    s_lshl_b32 s46, s44, 1
    s_add_u32 s46, s46, s43
    v_lshrrev_b32 v43, 5, v1
    v_and_b32 v44, 31, v1
    v_bfe_u32 v40, v1, 1, 3
    v_xor_b32 v40, v40, v43
    v_lshlrev_b32 v40, 4, v40
    v_lshl_add_u32 v40, v44, 7, v40
    s_lshl_b32 s33, s45, 12
    v_add_u32 v20, s33, v40
    v_xor_b32 v21, 32, v20
    v_xor_b32 v22, 64, v20
    v_xor_b32 v23, 96, v20
    v_lshlrev_b32 v40, 3, v36
    v_and_b32 v41, 1, v36
    v_lshlrev_b32 v41, 4, v41
    v_lshrrev_b32 v42, 1, v36
    v_lshl_add_u32 v41, v42, 3, v41
    s_cmp_ge_u32 s41, 2
    s_cselect_b64 vcc, -1, 0
    v_cndmask_b32 v24, v41, v40, vcc
    v_lshl_add_u32 v24, v35, 6, v24
    v_bfe_u32 v40, v1, 4, 1
    v_lshl_add_u32 v24, v40, 5, v24
    v_lshl_add_u32 v24, v43, 11, v24
    s_lshl_b32 s33, s46, 8
    s_add_u32 s33, s33, 16384
    v_add_u32 v24, s33, v24
    v_mov_b32 v26, 0
    v_mov_b32 v27, 0
    v_mov_b32 v28, 0
    v_mov_b32 v29, 0
    v_mov_b32 v30, 0
    v_mov_b32 v31, 0
    v_mov_b32 v10, v20
    v_mov_b32 v11, v21
    v_mov_b32 v12, v22
    v_mov_b32 v13, v23
    v_xor_b32 v14, 4096, v20
    v_xor_b32 v15, 4096, v21
    v_xor_b32 v16, 4096, v22
    v_xor_b32 v17, 4096, v23
    v_mov_b32 v18, v24
    v_xor_b32 v19, 256, v24
    s_mov_b32 s42, 32768
    v_mov_b32 v80, 0
    v_mov_b32 v81, 0
    v_mov_b32 v82, 0
    v_mov_b32 v83, 0
    v_mov_b32 v84, 0
    s_mov_b32 m0, s38
    s_nop 0
    buffer_load_dwordx4 v2, s[16:19], s36 offen offset:0 lds
    v_mov_b32 v85, 0
    v_mov_b32 v86, 0
    v_mov_b32 v87, 0
    v_mov_b32 v88, 0
    v_mov_b32 v89, 0
    buffer_load_dwordx4 v3, s[16:19], s36 offen offset:1024 lds
    v_mov_b32 v90, 0
    v_mov_b32 v91, 0
    v_mov_b32 v92, 0
    v_mov_b32 v93, 0
    v_mov_b32 v94, 0
    buffer_load_dwordx4 v4, s[16:19], s36 offen offset:2048 lds
    v_mov_b32 v95, 0
    v_mov_b32 v96, 0
    v_mov_b32 v97, 0
    v_mov_b32 v98, 0
    v_mov_b32 v99, 0
    buffer_load_dwordx4 v5, s[16:19], s36 offen offset:3072 lds
    v_mov_b32 v100, 0
    v_mov_b32 v101, 0
    v_mov_b32 v102, 0
    v_mov_b32 v103, 0
    v_mov_b32 v104, 0
    s_add_u32 m0, s38, 16384
    s_nop 0
    buffer_load_dwordx4 v6, s[20:23], s37 offen offset:0 lds
    v_mov_b32 v105, 0
    v_mov_b32 v106, 0
    v_mov_b32 v107, 0
    v_mov_b32 v108, 0
    v_mov_b32 v109, 0
    buffer_load_dwordx4 v7, s[20:23], s37 offen offset:1024 lds
    v_mov_b32 v110, 0
    v_mov_b32 v111, 0
    v_mov_b32 v112, 0
    v_mov_b32 v113, 0
    v_mov_b32 v114, 0
    buffer_load_dwordx4 v8, s[20:23], s37 offen offset:2048 lds
    v_mov_b32 v115, 0
    v_mov_b32 v116, 0
    v_mov_b32 v117, 0
    v_mov_b32 v118, 0
    v_mov_b32 v119, 0
    buffer_load_dwordx4 v9, s[20:23], s37 offen offset:3072 lds
    s_add_u32 s36, s36, 128
    s_add_u32 s37, s37, 221184
    s_add_u32 s38, s38, 32768
    s_and_b32 s38, s38, 0x1ffff
    s_sub_u32 s47, s47, 1
    s_cmp_eq_u32 s47, 0
    s_cselect_b32 s36, 0x7f000000, s36
    v_mov_b32 v120, 0
    v_mov_b32 v121, 0
    v_mov_b32 v122, 0
    v_mov_b32 v123, 0
    v_mov_b32 v124, 0
    s_mov_b32 m0, s38
    s_nop 0
    buffer_load_dwordx4 v2, s[16:19], s36 offen offset:0 lds
    v_mov_b32 v125, 0
    v_mov_b32 v126, 0
    v_mov_b32 v127, 0
    v_mov_b32 v128, 0
    v_mov_b32 v129, 0
    buffer_load_dwordx4 v3, s[16:19], s36 offen offset:1024 lds
    v_mov_b32 v130, 0
    v_mov_b32 v131, 0
    v_mov_b32 v132, 0
    v_mov_b32 v133, 0
    v_mov_b32 v134, 0
    v_mov_b32 v135, 0
    v_mov_b32 v136, 0
    v_mov_b32 v137, 0
    v_mov_b32 v138, 0
    v_mov_b32 v139, 0
    v_mov_b32 v140, 0
    v_mov_b32 v141, 0
    v_mov_b32 v142, 0
    v_mov_b32 v143, 0
    s_waitcnt vmcnt(10)
    s_cmp_lg_u32 s3, 0
    s_cbranch_scc1 Lnc5
    s_mov_b64 exec, 1
    buffer_atomic_add v39, v38, s[24:27], s40 offen sc1
    s_mov_b64 exec, -1
Lnc5:
    s_barrier
    ds_read_b128 v[64:67], v10
    ds_read_b64_tr_b16 v[48:49], v18 offset:0
    ds_read_b64_tr_b16 v[50:51], v18 offset:1024
    ds_read_b128 v[68:71], v14
    ds_read_b64_tr_b16 v[52:53], v19 offset:0
    ds_read_b64_tr_b16 v[54:55], v19 offset:1024
    v_add_u32 v10, s42, v20
    v_xor_b32 v14, 4096, v10
    s_mov_b32 s39, 9
    s_cmp_ge_u32 s41, 2
    s_cbranch_scc1 Lvpath6
Lloop8:
    s_waitcnt lgkmcnt(0)
    v_mfma_f32_32x32x16_bf16 v[80:95], v[48:51], v[64:67], v[80:95]
    ds_read_b128 v[72:75], v11
    ds_read_b64_tr_b16 v[56:57], v18 offset:4096
    ds_read_b64_tr_b16 v[58:59], v18 offset:5120
    v_mfma_f32_32x32x16_bf16 v[96:111], v[48:51], v[68:71], v[96:111]
    buffer_load_dwordx4 v4, s[16:19], s36 offen offset:2048 lds
    v_mfma_f32_32x32x16_bf16 v[112:127], v[52:55], v[64:67], v[112:127]
    ds_read_b128 v[76:79], v15
    ds_read_b64_tr_b16 v[60:61], v19 offset:4096
    ds_read_b64_tr_b16 v[62:63], v19 offset:5120
    v_add_u32 v11, s42, v21
    v_xor_b32 v15, 4096, v11
    v_mfma_f32_32x32x16_bf16 v[128:143], v[52:55], v[68:71], v[128:143]
    buffer_load_dwordx4 v5, s[16:19], s36 offen offset:3072 lds
    v_dot2c_f32_bf16 v26, s32, v64
    v_dot2c_f32_bf16 v28, v64, v64
    v_dot2c_f32_bf16 v30, s32, v48
    v_dot2c_f32_bf16 v27, s32, v65
    v_dot2c_f32_bf16 v29, v65, v65
    v_dot2c_f32_bf16 v31, s32, v49
    v_dot2c_f32_bf16 v26, s32, v66
    v_dot2c_f32_bf16 v28, v66, v66
    v_dot2c_f32_bf16 v30, s32, v50
    v_dot2c_f32_bf16 v27, s32, v67
    v_dot2c_f32_bf16 v29, v67, v67
    v_dot2c_f32_bf16 v31, s32, v51
    s_waitcnt lgkmcnt(0)
    v_mfma_f32_32x32x16_bf16 v[80:95], v[56:59], v[72:75], v[80:95]
    ds_read_b128 v[64:67], v12
    ds_read_b64_tr_b16 v[48:49], v18 offset:8192
    ds_read_b64_tr_b16 v[50:51], v18 offset:9216
    v_mfma_f32_32x32x16_bf16 v[96:111], v[56:59], v[76:79], v[96:111]
    s_add_u32 m0, s38, 16384
    s_nop 0
    buffer_load_dwordx4 v6, s[20:23], s37 offen offset:0 lds
    v_mfma_f32_32x32x16_bf16 v[112:127], v[60:63], v[72:75], v[112:127]
    ds_read_b128 v[68:71], v16
    ds_read_b64_tr_b16 v[52:53], v19 offset:8192
    ds_read_b64_tr_b16 v[54:55], v19 offset:9216
    v_add_u32 v12, s42, v22
    v_xor_b32 v16, 4096, v12
    v_mfma_f32_32x32x16_bf16 v[128:143], v[60:63], v[76:79], v[128:143]
    buffer_load_dwordx4 v7, s[20:23], s37 offen offset:1024 lds
    v_dot2c_f32_bf16 v26, s32, v72
    v_dot2c_f32_bf16 v28, v72, v72
    v_dot2c_f32_bf16 v30, s32, v56
    v_dot2c_f32_bf16 v27, s32, v73
    v_dot2c_f32_bf16 v29, v73, v73
    v_dot2c_f32_bf16 v31, s32, v57
    v_dot2c_f32_bf16 v26, s32, v74
    v_dot2c_f32_bf16 v28, v74, v74
    v_dot2c_f32_bf16 v30, s32, v58
    v_dot2c_f32_bf16 v27, s32, v75
    v_dot2c_f32_bf16 v29, v75, v75
    v_dot2c_f32_bf16 v31, s32, v59
    s_waitcnt lgkmcnt(0)
    v_mfma_f32_32x32x16_bf16 v[80:95], v[48:51], v[64:67], v[80:95]
    ds_read_b128 v[72:75], v13
    ds_read_b64_tr_b16 v[56:57], v18 offset:12288
    ds_read_b64_tr_b16 v[58:59], v18 offset:13312
    v_mfma_f32_32x32x16_bf16 v[96:111], v[48:51], v[68:71], v[96:111]
    buffer_load_dwordx4 v8, s[20:23], s37 offen offset:2048 lds
    v_mfma_f32_32x32x16_bf16 v[112:127], v[52:55], v[64:67], v[112:127]
    ds_read_b128 v[76:79], v17
    ds_read_b64_tr_b16 v[60:61], v19 offset:12288
    ds_read_b64_tr_b16 v[62:63], v19 offset:13312
    v_add_u32 v13, s42, v23
    v_xor_b32 v17, 4096, v13
    v_add_u32 v18, s42, v24
    v_xor_b32 v19, 256, v18
    s_add_u32 s42, s42, 32768
    s_and_b32 s42, s42, 0x1ffff
    v_mfma_f32_32x32x16_bf16 v[128:143], v[52:55], v[68:71], v[128:143]
    buffer_load_dwordx4 v9, s[20:23], s37 offen offset:3072 lds
    s_add_u32 s36, s36, 128
    s_add_u32 s37, s37, 221184
    s_add_u32 s38, s38, 32768
    s_and_b32 s38, s38, 0x1ffff
    s_sub_u32 s47, s47, 1
    s_cmp_eq_u32 s47, 0
    s_cselect_b32 s36, 0x7f000000, s36
    v_dot2c_f32_bf16 v26, s32, v64
    v_dot2c_f32_bf16 v28, v64, v64
    v_dot2c_f32_bf16 v30, s32, v48
    v_dot2c_f32_bf16 v27, s32, v65
    v_dot2c_f32_bf16 v29, v65, v65
    v_dot2c_f32_bf16 v31, s32, v49
    v_dot2c_f32_bf16 v26, s32, v66
    v_dot2c_f32_bf16 v28, v66, v66
    v_dot2c_f32_bf16 v30, s32, v50
    v_dot2c_f32_bf16 v27, s32, v67
    v_dot2c_f32_bf16 v29, v67, v67
    v_dot2c_f32_bf16 v31, s32, v51
    s_waitcnt vmcnt(8) lgkmcnt(0)
    s_barrier
    v_mfma_f32_32x32x16_bf16 v[80:95], v[56:59], v[72:75], v[80:95]
    ds_read_b128 v[64:67], v10
    ds_read_b64_tr_b16 v[48:49], v18 offset:0
    ds_read_b64_tr_b16 v[50:51], v18 offset:1024
    v_mfma_f32_32x32x16_bf16 v[96:111], v[56:59], v[76:79], v[96:111]
    s_mov_b32 m0, s38
    s_nop 0
    buffer_load_dwordx4 v2, s[16:19], s36 offen offset:0 lds
    v_mfma_f32_32x32x16_bf16 v[112:127], v[60:63], v[72:75], v[112:127]
    ds_read_b128 v[68:71], v14
    ds_read_b64_tr_b16 v[52:53], v19 offset:0
    ds_read_b64_tr_b16 v[54:55], v19 offset:1024
    v_add_u32 v10, s42, v20
    v_xor_b32 v14, 4096, v10
    v_mfma_f32_32x32x16_bf16 v[128:143], v[60:63], v[76:79], v[128:143]
    buffer_load_dwordx4 v3, s[16:19], s36 offen offset:1024 lds
    v_dot2c_f32_bf16 v26, s32, v72
    v_dot2c_f32_bf16 v28, v72, v72
    v_dot2c_f32_bf16 v30, s32, v56
    v_dot2c_f32_bf16 v27, s32, v73
    v_dot2c_f32_bf16 v29, v73, v73
    v_dot2c_f32_bf16 v31, s32, v57
    v_dot2c_f32_bf16 v26, s32, v74
    v_dot2c_f32_bf16 v28, v74, v74
    v_dot2c_f32_bf16 v30, s32, v58
    v_dot2c_f32_bf16 v27, s32, v75
    v_dot2c_f32_bf16 v29, v75, v75
    v_dot2c_f32_bf16 v31, s32, v59
    s_sub_u32 s39, s39, 1
    s_cmp_lg_u32 s39, 0
    s_cbranch_scc1 Lloop8
    s_branch Lepi7
Lvpath6:
Lloop9:
    s_waitcnt lgkmcnt(0)
    v_mfma_f32_32x32x16_bf16 v[80:95], v[64:67], v[48:51], v[80:95]
    ds_read_b128 v[72:75], v11
    ds_read_b64_tr_b16 v[56:57], v18 offset:4096
    ds_read_b64_tr_b16 v[58:59], v18 offset:5120
    v_mfma_f32_32x32x16_bf16 v[96:111], v[68:71], v[48:51], v[96:111]
    buffer_load_dwordx4 v4, s[16:19], s36 offen offset:2048 lds
    v_mfma_f32_32x32x16_bf16 v[112:127], v[64:67], v[52:55], v[112:127]
    ds_read_b128 v[76:79], v15
    ds_read_b64_tr_b16 v[60:61], v19 offset:4096
    ds_read_b64_tr_b16 v[62:63], v19 offset:5120
    v_add_u32 v11, s42, v21
    v_xor_b32 v15, 4096, v11
    v_mfma_f32_32x32x16_bf16 v[128:143], v[68:71], v[52:55], v[128:143]
    buffer_load_dwordx4 v5, s[16:19], s36 offen offset:3072 lds
    v_dot2c_f32_bf16 v26, s32, v64
    v_dot2c_f32_bf16 v28, v64, v64
    v_dot2c_f32_bf16 v30, s32, v48
    v_dot2c_f32_bf16 v27, s32, v65
    v_dot2c_f32_bf16 v29, v65, v65
    v_dot2c_f32_bf16 v31, s32, v49
    v_dot2c_f32_bf16 v26, s32, v66
    v_dot2c_f32_bf16 v28, v66, v66
    v_dot2c_f32_bf16 v30, s32, v50
    v_dot2c_f32_bf16 v27, s32, v67
    v_dot2c_f32_bf16 v29, v67, v67
    v_dot2c_f32_bf16 v31, s32, v51
    s_waitcnt lgkmcnt(0)
    v_mfma_f32_32x32x16_bf16 v[80:95], v[72:75], v[56:59], v[80:95]
    ds_read_b128 v[64:67], v12
    ds_read_b64_tr_b16 v[48:49], v18 offset:8192
    ds_read_b64_tr_b16 v[50:51], v18 offset:9216
    v_mfma_f32_32x32x16_bf16 v[96:111], v[76:79], v[56:59], v[96:111]
    s_add_u32 m0, s38, 16384
    s_nop 0
    buffer_load_dwordx4 v6, s[20:23], s37 offen offset:0 lds
    v_mfma_f32_32x32x16_bf16 v[112:127], v[72:75], v[60:63], v[112:127]
    ds_read_b128 v[68:71], v16
    ds_read_b64_tr_b16 v[52:53], v19 offset:8192
    ds_read_b64_tr_b16 v[54:55], v19 offset:9216
    v_add_u32 v12, s42, v22
    v_xor_b32 v16, 4096, v12
    v_mfma_f32_32x32x16_bf16 v[128:143], v[76:79], v[60:63], v[128:143]
    buffer_load_dwordx4 v7, s[20:23], s37 offen offset:1024 lds
    v_dot2c_f32_bf16 v26, s32, v72
    v_dot2c_f32_bf16 v28, v72, v72
    v_dot2c_f32_bf16 v30, s32, v56
    v_dot2c_f32_bf16 v27, s32, v73
    v_dot2c_f32_bf16 v29, v73, v73
    v_dot2c_f32_bf16 v31, s32, v57
    v_dot2c_f32_bf16 v26, s32, v74
    v_dot2c_f32_bf16 v28, v74, v74
    v_dot2c_f32_bf16 v30, s32, v58
    v_dot2c_f32_bf16 v27, s32, v75
    v_dot2c_f32_bf16 v29, v75, v75
    v_dot2c_f32_bf16 v31, s32, v59
    s_waitcnt lgkmcnt(0)
    v_mfma_f32_32x32x16_bf16 v[80:95], v[64:67], v[48:51], v[80:95]
    ds_read_b128 v[72:75], v13
    ds_read_b64_tr_b16 v[56:57], v18 offset:12288
    ds_read_b64_tr_b16 v[58:59], v18 offset:13312
    v_mfma_f32_32x32x16_bf16 v[96:111], v[68:71], v[48:51], v[96:111]
    buffer_load_dwordx4 v8, s[20:23], s37 offen offset:2048 lds
    v_mfma_f32_32x32x16_bf16 v[112:127], v[64:67], v[52:55], v[112:127]
    ds_read_b128 v[76:79], v17
    ds_read_b64_tr_b16 v[60:61], v19 offset:12288
    ds_read_b64_tr_b16 v[62:63], v19 offset:13312
    v_add_u32 v13, s42, v23
    v_xor_b32 v17, 4096, v13
    v_add_u32 v18, s42, v24
    v_xor_b32 v19, 256, v18
    s_add_u32 s42, s42, 32768
    s_and_b32 s42, s42, 0x1ffff
    v_mfma_f32_32x32x16_bf16 v[128:143], v[68:71], v[52:55], v[128:143]
    buffer_load_dwordx4 v9, s[20:23], s37 offen offset:3072 lds
    s_add_u32 s36, s36, 128
    s_add_u32 s37, s37, 221184
    s_add_u32 s38, s38, 32768
    s_and_b32 s38, s38, 0x1ffff
    s_sub_u32 s47, s47, 1
    s_cmp_eq_u32 s47, 0
    s_cselect_b32 s36, 0x7f000000, s36
    v_dot2c_f32_bf16 v26, s32, v64
    v_dot2c_f32_bf16 v28, v64, v64
    v_dot2c_f32_bf16 v30, s32, v48
    v_dot2c_f32_bf16 v27, s32, v65
    v_dot2c_f32_bf16 v29, v65, v65
    v_dot2c_f32_bf16 v31, s32, v49
    v_dot2c_f32_bf16 v26, s32, v66
    v_dot2c_f32_bf16 v28, v66, v66
    v_dot2c_f32_bf16 v30, s32, v50
    v_dot2c_f32_bf16 v27, s32, v67
    v_dot2c_f32_bf16 v29, v67, v67
    v_dot2c_f32_bf16 v31, s32, v51
    s_waitcnt vmcnt(8) lgkmcnt(0)
    s_barrier
    v_mfma_f32_32x32x16_bf16 v[80:95], v[72:75], v[56:59], v[80:95]
    ds_read_b128 v[64:67], v10
    ds_read_b64_tr_b16 v[48:49], v18 offset:0
    ds_read_b64_tr_b16 v[50:51], v18 offset:1024
    v_mfma_f32_32x32x16_bf16 v[96:111], v[76:79], v[56:59], v[96:111]
    s_mov_b32 m0, s38
    s_nop 0
    buffer_load_dwordx4 v2, s[16:19], s36 offen offset:0 lds
    v_mfma_f32_32x32x16_bf16 v[112:127], v[72:75], v[60:63], v[112:127]
    ds_read_b128 v[68:71], v14
    ds_read_b64_tr_b16 v[52:53], v19 offset:0
    ds_read_b64_tr_b16 v[54:55], v19 offset:1024
    v_add_u32 v10, s42, v20
    v_xor_b32 v14, 4096, v10
    v_mfma_f32_32x32x16_bf16 v[128:143], v[76:79], v[60:63], v[128:143]
    buffer_load_dwordx4 v3, s[16:19], s36 offen offset:1024 lds
    v_dot2c_f32_bf16 v26, s32, v72
    v_dot2c_f32_bf16 v28, v72, v72
    v_dot2c_f32_bf16 v30, s32, v56
    v_dot2c_f32_bf16 v27, s32, v73
    v_dot2c_f32_bf16 v29, v73, v73
    v_dot2c_f32_bf16 v31, s32, v57
    v_dot2c_f32_bf16 v26, s32, v74
    v_dot2c_f32_bf16 v28, v74, v74
    v_dot2c_f32_bf16 v30, s32, v58
    v_dot2c_f32_bf16 v27, s32, v75
    v_dot2c_f32_bf16 v29, v75, v75
    v_dot2c_f32_bf16 v31, s32, v59
    s_sub_u32 s39, s39, 1
    s_cmp_lg_u32 s39, 0
    s_cbranch_scc1 Lloop9
Lepi7:
    buffer_load_dword v176, v45, s[24:27], 0 offen sc1
    v_add_f32 v26, v26, v27
    v_add_f32 v28, v28, v29
    v_add_f32 v30, v30, v31
    v_mov_b32 v27, v26
    v_mov_b32 v29, v28
    v_mov_b32 v31, v30
    v_permlane32_swap_b32 v26, v27
    v_permlane32_swap_b32 v28, v29
    v_permlane32_swap_b32 v30, v31
    v_add_f32 v26, v26, v27
    v_add_f32 v28, v28, v29
    v_add_f32 v30, v30, v31
    v_mul_f32 v26, 0xbae38e39, v26
    v_mul_f32 v28, 0x3ae38e39, v28
    v_fma_f32 v28, -v26, v26, v28
    v_max_f32 v28, 0, v28
    v_add_f32 v28, 0x3727c5ac, v28
    v_rsq_f32 v28, v28
    s_waitcnt lgkmcnt(0)
    v_cvt_pk_bf16_f32 v64, v26, v26
    v_lshlrev_b32 v32, 16, v64
    v_sub_f32 v32, v26, v32
    v_cvt_pk_bf16_f32 v65, v32, 0
    v_cvt_pk_bf16_f32 v49, v30, 0
    v_lshlrev_b32 v33, 16, v49
    v_sub_f32 v33, v30, v33
    v_cvt_pk_bf16_f32 v48, v30, v33
    v_cmp_gt_u32 vcc, 32, v1
    s_nop 1
    v_cndmask_b32 v64, 0, v64, vcc
    v_cndmask_b32 v65, 0, v65, vcc
    s_lshl_b32 s33, s45, 9
    s_add_u32 s33, s33, 131072
    v_lshl_add_u32 v34, v1, 3, s33
    s_lshl_b32 s33, s46, 9
    s_add_u32 s33, s33, 133120
    v_lshl_add_u32 v35, v1, 3, s33
    s_lshl_b32 s33, s45, 7
    s_add_u32 s33, s33, 135168
    v_lshl_add_u32 v36, v44, 2, s33
    ds_write_b64 v34, v[64:65]
    ds_write_b64 v35, v[48:49]
    ds_write_b32 v36, v28
    v_xor_b32 v34, 512, v34
    v_xor_b32 v35, 512, v35
    v_xor_b32 v36, 128, v36
    s_lshl_b32 s35, s28, 2
    s_add_u32 s45, s45, s35
    s_cmp_lg_u32 s29, 0
    s_cbranch_scc1 Lnomean10
    s_lshl_b32 s34, s45, 7
    s_add_u32 s34, s34, 0xbc0000
    v_sub_f32 v152, 0, v26
    v_lshlrev_b32 v33, 2, v44
    s_nop 0
    v_mov_b32_dpp v153, v152 quad_perm:[1,1,1,1] row_mask:0xf bank_mask:0xf
    v_mov_b32_dpp v154, v152 quad_perm:[2,2,2,2] row_mask:0xf bank_mask:0xf
    v_mov_b32_dpp v155, v152 quad_perm:[3,3,3,3] row_mask:0xf bank_mask:0xf
    s_mov_b32 exec_lo, 0x11111111
    s_mov_b32 exec_hi, 0
    buffer_store_dwordx4 v[152:155], v33, s[12:15], s34 offen sc1
    s_mov_b64 exec, -1
Lnomean10:
    s_waitcnt lgkmcnt(0)
    s_barrier
    s_cmp_eq_u32 s41, 3
    s_cbranch_scc1 Lones11
    ds_read_b64 v[66:67], v34
    ds_read_b64 v[50:51], v35
    s_mul_i32 s33, s41, 9
    s_sub_u32 s33, s31, s33
    s_lshl_b32 s33, s33, 1
    s_add_u32 s46, s33, s43
    s_cmp_eq_u32 s41, 2
    s_cbranch_scc1 Lvepi12
    ds_read_b32 v29, v36
    s_cmp_eq_u32 s41, 0
    s_cselect_b32 s40, 0x3eae1a93, 1.0
    s_cselect_b32 s34, 0, 0x240000
    v_lshlrev_b32 v32, 4, v44
    v_lshl_add_u32 v32, v43, 15, v32
    v_add_u32 v33, 65536, v32
    s_waitcnt lgkmcnt(0)
    v_mfma_f32_32x32x8_bf16 v[80:95], v[48:49], v[64:65], v[80:95]
    v_mfma_f32_32x32x8_bf16 v[96:111], v[48:49], v[66:67], v[96:111]
    v_mfma_f32_32x32x8_bf16 v[112:127], v[50:51], v[64:65], v[112:127]
    v_mfma_f32_32x32x8_bf16 v[128:143], v[50:51], v[66:67], v[128:143]
    v_mul_f32 v28, s40, v28
    v_mul_f32 v29, s40, v29
    s_xor_b32 s33, s46, 0
    s_lshl_b32 s33, s33, 17
    s_xor_b32 s35, s45, 0
    s_lshl_b32 s35, s35, 9
    s_add_u32 s33, s33, s35
    s_add_u32 s33, s33, s34
    s_nop 0
    v_pk_mul_f32 v[80:81], v[80:81], v[28:29] op_sel:[0,0] op_sel_hi:[1,0]
    v_pk_mul_f32 v[82:83], v[82:83], v[28:29] op_sel:[0,0] op_sel_hi:[1,0]
    v_pk_mul_f32 v[84:85], v[84:85], v[28:29] op_sel:[0,0] op_sel_hi:[1,0]
    v_pk_mul_f32 v[86:87], v[86:87], v[28:29] op_sel:[0,0] op_sel_hi:[1,0]
    v_cvt_pk_bf16_f32 v80, v80, v81
    v_cvt_pk_bf16_f32 v81, v82, v83
    v_cvt_pk_bf16_f32 v82, v84, v85
    v_cvt_pk_bf16_f32 v83, v86, v87
    buffer_store_dwordx4 v[80:83], v32, s[12:15], s33 offen sc1
    v_pk_mul_f32 v[88:89], v[88:89], v[28:29] op_sel:[0,0] op_sel_hi:[1,0]
    v_pk_mul_f32 v[90:91], v[90:91], v[28:29] op_sel:[0,0] op_sel_hi:[1,0]
    v_pk_mul_f32 v[92:93], v[92:93], v[28:29] op_sel:[0,0] op_sel_hi:[1,0]
    v_pk_mul_f32 v[94:95], v[94:95], v[28:29] op_sel:[0,0] op_sel_hi:[1,0]
    v_cvt_pk_bf16_f32 v88, v88, v89
    v_cvt_pk_bf16_f32 v89, v90, v91
    v_cvt_pk_bf16_f32 v90, v92, v93
    v_cvt_pk_bf16_f32 v91, v94, v95
    buffer_store_dwordx4 v[88:91], v33, s[12:15], s33 offen sc1
    s_xor_b32 s33, s46, 0
    s_lshl_b32 s33, s33, 17
    s_xor_b32 s35, s45, 1
    s_lshl_b32 s35, s35, 9
    s_add_u32 s33, s33, s35
    s_add_u32 s33, s33, s34
    v_pk_mul_f32 v[96:97], v[96:97], v[28:29] op_sel:[0,1] op_sel_hi:[1,1]
    v_pk_mul_f32 v[98:99], v[98:99], v[28:29] op_sel:[0,1] op_sel_hi:[1,1]
    v_pk_mul_f32 v[100:101], v[100:101], v[28:29] op_sel:[0,1] op_sel_hi:[1,1]
    v_pk_mul_f32 v[102:103], v[102:103], v[28:29] op_sel:[0,1] op_sel_hi:[1,1]
    v_cvt_pk_bf16_f32 v96, v96, v97
    v_cvt_pk_bf16_f32 v97, v98, v99
    v_cvt_pk_bf16_f32 v98, v100, v101
    v_cvt_pk_bf16_f32 v99, v102, v103
    buffer_store_dwordx4 v[96:99], v32, s[12:15], s33 offen sc1
    v_pk_mul_f32 v[104:105], v[104:105], v[28:29] op_sel:[0,1] op_sel_hi:[1,1]
    v_pk_mul_f32 v[106:107], v[106:107], v[28:29] op_sel:[0,1] op_sel_hi:[1,1]
    v_pk_mul_f32 v[108:109], v[108:109], v[28:29] op_sel:[0,1] op_sel_hi:[1,1]
    v_pk_mul_f32 v[110:111], v[110:111], v[28:29] op_sel:[0,1] op_sel_hi:[1,1]
    v_cvt_pk_bf16_f32 v104, v104, v105
    v_cvt_pk_bf16_f32 v105, v106, v107
    v_cvt_pk_bf16_f32 v106, v108, v109
    v_cvt_pk_bf16_f32 v107, v110, v111
    buffer_store_dwordx4 v[104:107], v33, s[12:15], s33 offen sc1
    s_xor_b32 s33, s46, 1
    s_lshl_b32 s33, s33, 17
    s_xor_b32 s35, s45, 0
    s_lshl_b32 s35, s35, 9
    s_add_u32 s33, s33, s35
    s_add_u32 s33, s33, s34
    v_pk_mul_f32 v[112:113], v[112:113], v[28:29] op_sel:[0,0] op_sel_hi:[1,0]
    v_pk_mul_f32 v[114:115], v[114:115], v[28:29] op_sel:[0,0] op_sel_hi:[1,0]
    v_pk_mul_f32 v[116:117], v[116:117], v[28:29] op_sel:[0,0] op_sel_hi:[1,0]
    v_pk_mul_f32 v[118:119], v[118:119], v[28:29] op_sel:[0,0] op_sel_hi:[1,0]
    v_cvt_pk_bf16_f32 v112, v112, v113
    v_cvt_pk_bf16_f32 v113, v114, v115
    v_cvt_pk_bf16_f32 v114, v116, v117
    v_cvt_pk_bf16_f32 v115, v118, v119
    buffer_store_dwordx4 v[112:115], v32, s[12:15], s33 offen sc1
    v_pk_mul_f32 v[120:121], v[120:121], v[28:29] op_sel:[0,0] op_sel_hi:[1,0]
    v_pk_mul_f32 v[122:123], v[122:123], v[28:29] op_sel:[0,0] op_sel_hi:[1,0]
    v_pk_mul_f32 v[124:125], v[124:125], v[28:29] op_sel:[0,0] op_sel_hi:[1,0]
    v_pk_mul_f32 v[126:127], v[126:127], v[28:29] op_sel:[0,0] op_sel_hi:[1,0]
    v_cvt_pk_bf16_f32 v120, v120, v121
    v_cvt_pk_bf16_f32 v121, v122, v123
    v_cvt_pk_bf16_f32 v122, v124, v125
    v_cvt_pk_bf16_f32 v123, v126, v127
    buffer_store_dwordx4 v[120:123], v33, s[12:15], s33 offen sc1
    s_xor_b32 s33, s46, 1
    s_lshl_b32 s33, s33, 17
    s_xor_b32 s35, s45, 1
    s_lshl_b32 s35, s35, 9
    s_add_u32 s33, s33, s35
    s_add_u32 s33, s33, s34
    v_pk_mul_f32 v[128:129], v[128:129], v[28:29] op_sel:[0,1] op_sel_hi:[1,1]
    v_pk_mul_f32 v[130:131], v[130:131], v[28:29] op_sel:[0,1] op_sel_hi:[1,1]
    v_pk_mul_f32 v[132:133], v[132:133], v[28:29] op_sel:[0,1] op_sel_hi:[1,1]
    v_pk_mul_f32 v[134:135], v[134:135], v[28:29] op_sel:[0,1] op_sel_hi:[1,1]
    v_cvt_pk_bf16_f32 v128, v128, v129
    v_cvt_pk_bf16_f32 v129, v130, v131
    v_cvt_pk_bf16_f32 v130, v132, v133
    v_cvt_pk_bf16_f32 v131, v134, v135
    buffer_store_dwordx4 v[128:131], v32, s[12:15], s33 offen sc1
    v_pk_mul_f32 v[136:137], v[136:137], v[28:29] op_sel:[0,1] op_sel_hi:[1,1]
    v_pk_mul_f32 v[138:139], v[138:139], v[28:29] op_sel:[0,1] op_sel_hi:[1,1]
    v_pk_mul_f32 v[140:141], v[140:141], v[28:29] op_sel:[0,1] op_sel_hi:[1,1]
    v_pk_mul_f32 v[142:143], v[142:143], v[28:29] op_sel:[0,1] op_sel_hi:[1,1]
    v_cvt_pk_bf16_f32 v136, v136, v137
    v_cvt_pk_bf16_f32 v137, v138, v139
    v_cvt_pk_bf16_f32 v138, v140, v141
    v_cvt_pk_bf16_f32 v139, v142, v143
    buffer_store_dwordx4 v[136:139], v33, s[12:15], s33 offen sc1
    s_branch Lp1fin3
Lvepi12:
    v_and_b32 v36, 0xffffff80, v36
    v_lshl_add_u32 v36, v43, 4, v36
    v_xor_b32 v40, 128, v36
    ds_read_b128 v[144:147], v40 offset:0
    ds_read_b128 v[160:163], v36 offset:0
    ds_read_b128 v[148:151], v40 offset:32
    ds_read_b128 v[164:167], v36 offset:32
    ds_read_b128 v[152:155], v40 offset:64
    ds_read_b128 v[168:171], v36 offset:64
    ds_read_b128 v[156:159], v40 offset:96
    ds_read_b128 v[172:175], v36 offset:96
    v_mul_u32_u24 v32, 9344, v43
    v_lshl_add_u32 v32, v44, 4, v32
    v_add_u32 v33, 18688, v32
    s_waitcnt lgkmcnt(8)
    v_mfma_f32_32x32x8_bf16 v[80:95], v[64:65], v[48:49], v[80:95]
    v_mfma_f32_32x32x8_bf16 v[96:111], v[66:67], v[48:49], v[96:111]
    v_mfma_f32_32x32x8_bf16 v[112:127], v[64:65], v[50:51], v[112:127]
    v_mfma_f32_32x32x8_bf16 v[128:143], v[66:67], v[50:51], v[128:143]
    s_waitcnt lgkmcnt(0)
    s_xor_b32 s33, s46, 0
    s_lshl_b32 s33, s33, 9
    s_xor_b32 s35, s45, 0
    s_mul_i32 s35, s35, 37376
    s_add_u32 s33, s33, s35
    s_add_u32 s33, s33, 0x480000
    s_nop 1
    v_pk_mul_f32 v[80:81], v[80:81], v[144:145]
    v_pk_mul_f32 v[82:83], v[82:83], v[146:147]
    v_pk_mul_f32 v[84:85], v[84:85], v[148:149]
    v_pk_mul_f32 v[86:87], v[86:87], v[150:151]
    v_cvt_pk_bf16_f32 v80, v80, v81
    v_cvt_pk_bf16_f32 v81, v82, v83
    v_cvt_pk_bf16_f32 v82, v84, v85
    v_cvt_pk_bf16_f32 v83, v86, v87
    buffer_store_dwordx4 v[80:83], v32, s[12:15], s33 offen sc1
    v_pk_mul_f32 v[88:89], v[88:89], v[152:153]
    v_pk_mul_f32 v[90:91], v[90:91], v[154:155]
    v_pk_mul_f32 v[92:93], v[92:93], v[156:157]
    v_pk_mul_f32 v[94:95], v[94:95], v[158:159]
    v_cvt_pk_bf16_f32 v88, v88, v89
    v_cvt_pk_bf16_f32 v89, v90, v91
    v_cvt_pk_bf16_f32 v90, v92, v93
    v_cvt_pk_bf16_f32 v91, v94, v95
    buffer_store_dwordx4 v[88:91], v33, s[12:15], s33 offen sc1
    s_xor_b32 s33, s46, 0
    s_lshl_b32 s33, s33, 9
    s_xor_b32 s35, s45, 1
    s_mul_i32 s35, s35, 37376
    s_add_u32 s33, s33, s35
    s_add_u32 s33, s33, 0x480000
    v_pk_mul_f32 v[96:97], v[96:97], v[160:161]
    v_pk_mul_f32 v[98:99], v[98:99], v[162:163]
    v_pk_mul_f32 v[100:101], v[100:101], v[164:165]
    v_pk_mul_f32 v[102:103], v[102:103], v[166:167]
    v_cvt_pk_bf16_f32 v96, v96, v97
    v_cvt_pk_bf16_f32 v97, v98, v99
    v_cvt_pk_bf16_f32 v98, v100, v101
    v_cvt_pk_bf16_f32 v99, v102, v103
    buffer_store_dwordx4 v[96:99], v32, s[12:15], s33 offen sc1
    v_pk_mul_f32 v[104:105], v[104:105], v[168:169]
    v_pk_mul_f32 v[106:107], v[106:107], v[170:171]
    v_pk_mul_f32 v[108:109], v[108:109], v[172:173]
    v_pk_mul_f32 v[110:111], v[110:111], v[174:175]
    v_cvt_pk_bf16_f32 v104, v104, v105
    v_cvt_pk_bf16_f32 v105, v106, v107
    v_cvt_pk_bf16_f32 v106, v108, v109
    v_cvt_pk_bf16_f32 v107, v110, v111
    buffer_store_dwordx4 v[104:107], v33, s[12:15], s33 offen sc1
    s_xor_b32 s33, s46, 1
    s_lshl_b32 s33, s33, 9
    s_xor_b32 s35, s45, 0
    s_mul_i32 s35, s35, 37376
    s_add_u32 s33, s33, s35
    s_add_u32 s33, s33, 0x480000
    v_pk_mul_f32 v[112:113], v[112:113], v[144:145]
    v_pk_mul_f32 v[114:115], v[114:115], v[146:147]
    v_pk_mul_f32 v[116:117], v[116:117], v[148:149]
    v_pk_mul_f32 v[118:119], v[118:119], v[150:151]
    v_cvt_pk_bf16_f32 v112, v112, v113
    v_cvt_pk_bf16_f32 v113, v114, v115
    v_cvt_pk_bf16_f32 v114, v116, v117
    v_cvt_pk_bf16_f32 v115, v118, v119
    buffer_store_dwordx4 v[112:115], v32, s[12:15], s33 offen sc1
    v_pk_mul_f32 v[120:121], v[120:121], v[152:153]
    v_pk_mul_f32 v[122:123], v[122:123], v[154:155]
    v_pk_mul_f32 v[124:125], v[124:125], v[156:157]
    v_pk_mul_f32 v[126:127], v[126:127], v[158:159]
    v_cvt_pk_bf16_f32 v120, v120, v121
    v_cvt_pk_bf16_f32 v121, v122, v123
    v_cvt_pk_bf16_f32 v122, v124, v125
    v_cvt_pk_bf16_f32 v123, v126, v127
    buffer_store_dwordx4 v[120:123], v33, s[12:15], s33 offen sc1
    s_xor_b32 s33, s46, 1
    s_lshl_b32 s33, s33, 9
    s_xor_b32 s35, s45, 1
    s_mul_i32 s35, s35, 37376
    s_add_u32 s33, s33, s35
    s_add_u32 s33, s33, 0x480000
    v_pk_mul_f32 v[128:129], v[128:129], v[160:161]
    v_pk_mul_f32 v[130:131], v[130:131], v[162:163]
    v_pk_mul_f32 v[132:133], v[132:133], v[164:165]
    v_pk_mul_f32 v[134:135], v[134:135], v[166:167]
    v_cvt_pk_bf16_f32 v128, v128, v129
    v_cvt_pk_bf16_f32 v129, v130, v131
    v_cvt_pk_bf16_f32 v130, v132, v133
    v_cvt_pk_bf16_f32 v131, v134, v135
    buffer_store_dwordx4 v[128:131], v32, s[12:15], s33 offen sc1
    v_pk_mul_f32 v[136:137], v[136:137], v[168:169]
    v_pk_mul_f32 v[138:139], v[138:139], v[170:171]
    v_pk_mul_f32 v[140:141], v[140:141], v[172:173]
    v_pk_mul_f32 v[142:143], v[142:143], v[174:175]
    v_cvt_pk_bf16_f32 v136, v136, v137
    v_cvt_pk_bf16_f32 v137, v138, v139
    v_cvt_pk_bf16_f32 v138, v140, v141
    v_cvt_pk_bf16_f32 v139, v142, v143
    buffer_store_dwordx4 v[136:139], v33, s[12:15], s33 offen sc1
    s_branch Lp1fin3
Lones11:
    s_mul_i32 s34, s28, 149504
    s_add_u32 s34, s34, 0x482400
    v_mul_u32_u24 v32, 9344, v1
    v_mov_b32 v156, s32
    v_mov_b32 v157, s32
    v_mov_b32 v158, s32
    v_mov_b32 v159, s32
    s_mov_b64 exec, 0xffff
    buffer_store_dwordx4 v[156:159], v32, s[12:15], s34 offen sc1
    s_mov_b64 exec, -1
    s_branch Lp1fin3
Lside2:
    s_mov_b32 s60, s8
    s_and_b32 s61, s9, 0xffff
    s_mov_b32 s62, 0xa2000
    s_mov_b32 s63, 0x00020000
    s_and_b32 s33, s2, 31
    s_lshl_b32 s33, s33, 2
    s_add_u32 s33, s33, s3
    s_bfe_u32 s34, s2, 0x20003
    s_lshl_b32 s34, s34, 2
    s_add_u32 s34, s34, s3
    s_bfe_u32 s35, s2, 0x20001
    s_lshl_b32 s35, s35, 4
    s_add_u32 s35, s35, s34
    s_mul_i32 s36, s35, 36864
    s_add_u32 s36, s36, 384
    v_and_b32 v20, 31, v1
    v_mul_u32_u24 v20, 1152, v20
    v_lshrrev_b32 v14, 5, v1
    v_lshl_add_u32 v20, v14, 7, v20
    s_and_b32 s35, s2, 1
    s_mul_i32 s37, s35, 1792
    s_mul_i32 s35, s34, 13824
    s_add_u32 s37, s37, s35
    s_add_u32 s37, s37, 663552
    v_lshrrev_b32 v14, 4, v1
    v_mul_u32_u24 v14, 3456, v14
    v_and_b32 v15, 15, v1
    v_min_u32 v15, 13, v15
    v_lshl_add_u32 v14, v15, 7, v14
    buffer_load_dword v23, v20, s[16:19], s36 offen offset:0 sc1
    buffer_load_dword v22, v14, s[20:23], s37 offen sc1
    s_add_u32 s37, s37, 221184
    buffer_load_dword v22, v14, s[20:23], s37 offen sc1
    s_add_u32 s37, s37, 221184
    buffer_load_dword v23, v20, s[16:19], s36 offen offset:256 sc1
    buffer_load_dword v22, v14, s[20:23], s37 offen sc1
    s_add_u32 s37, s37, 221184
    buffer_load_dword v22, v14, s[20:23], s37 offen sc1
    s_add_u32 s37, s37, 221184
    buffer_load_dword v23, v20, s[16:19], s36 offen offset:512 sc1
    buffer_load_dword v22, v14, s[20:23], s37 offen sc1
    s_add_u32 s37, s37, 221184
    buffer_load_dword v22, v14, s[20:23], s37 offen sc1
    s_add_u32 s37, s37, 221184
    s_bfe_u32 s34, s2, 0x20003
    s_lshl_b32 s34, s34, 12
    s_add_u32 s34, s34, p2_start-p1_pc
    v_lshl_add_u32 v12, v0, 4, s34
    v_min_u32 v13, p3_start-p1_pc-16, v12
    global_load_dwordx4 v[24:27], v13, s[48:49]
    v_add_u32 v12, 16384, v12
    v_min_u32 v13, p3_start-p1_pc-16, v12
    global_load_dwordx4 v[28:31], v13, s[48:49]
    v_add_u32 v12, 16384, v12
    s_waitcnt vmcnt(11)
    s_cmp_lg_u32 s3, 0
    s_cbranch_scc1 Lnc13
    s_mov_b64 exec, 1
    buffer_atomic_add v39, v38, s[24:27], s40 offen sc1
    s_mov_b64 exec, -1
Lnc13:
    v_lshrrev_b32 v2, 3, v1
    v_and_b32 v3, 7, v1
    v_lshrrev_b32 v4, 2, v2
    v_lshlrev_b32 v4, 3, v4
    v_and_b32 v5, 3, v2
    v_add_u32 v4, v4, v5
    v_mul_u32_u24 v4, 1152, v4
    v_lshl_add_u32 v4, v3, 4, v4
    v_lshrrev_b32 v5, 1, v2
    v_mul_u32_u24 v5, 18, v5
    v_and_b32 v6, 1, v2
    v_add3_u32 v5, v5, v6, 16
    v_mul_u32_u24 v5, 1152, v5
    v_lshl_add_u32 v5, v3, 4, v5
    s_lshl_b32 s38, s3, 13
    v_lshrrev_b32 v7, 4, v1
    v_lshlrev_b32 v7, 10, v7
    v_lshl_add_u32 v7, v35, 7, v7
    v_lshl_add_u32 v7, v36, 3, v7
    v_add_u32 v7, s38, v7
    v_lshlrev_b32 v8, 4, v1
    s_add_u32 s39, s33, 0
    s_mul_i32 s34, s39, 57
    s_lshr_b32 s34, s34, 9
    s_mul_i32 s35, s34, 9
    s_sub_u32 s35, s39, s35
    s_mul_i32 s36, s34, 41472
    s_sub_u32 s37, s34, 16
    s_mul_i32 s37, s37, 331776
    s_cmp_ge_u32 s34, 16
    s_cselect_b64 vcc, -1, 0
    s_cselect_b32 s36, s37, s36
    s_mov_b32 s42, 4608
    s_cselect_b32 s42, 82944, s42
    s_mov_b32 s41, 16128
    s_cselect_b32 s41, 82944, s41
    v_cndmask_b32 v9, v4, v5, vcc
    s_lshl_b32 s37, s35, 7
    s_add_u32 s36, s36, s37
    s_add_u32 m0, s38, 0
    s_nop 0
    buffer_load_dwordx4 v9, s[60:63], s36 offen lds
    s_add_u32 s36, s36, s42
    s_add_u32 m0, s38, 1024
    s_nop 0
    buffer_load_dwordx4 v9, s[60:63], s36 offen lds
    s_add_u32 s36, s36, s41
    s_add_u32 m0, s38, 2048
    s_nop 0
    buffer_load_dwordx4 v9, s[60:63], s36 offen lds
    s_add_u32 s36, s36, s42
    s_add_u32 m0, s38, 3072
    s_nop 0
    buffer_load_dwordx4 v9, s[60:63], s36 offen lds
    s_add_u32 s36, s36, s42
    s_mul_i32 s35, s35, 73728
    s_lshl_b32 s34, s34, 10
    s_add_u32 s35, s35, s34
    s_add_u32 s45, s35, 0xc00000
    s_cmp_ge_u32 s39, 162
    s_cselect_b32 s45, 0x7f000000, s45
    s_add_u32 s39, s33, 128
    s_mul_i32 s34, s39, 57
    s_lshr_b32 s34, s34, 9
    s_mul_i32 s35, s34, 9
    s_sub_u32 s35, s39, s35
    s_mul_i32 s36, s34, 41472
    s_sub_u32 s37, s34, 16
    s_mul_i32 s37, s37, 331776
    s_cmp_ge_u32 s34, 16
    s_cselect_b64 vcc, -1, 0
    s_cselect_b32 s36, s37, s36
    s_mov_b32 s42, 4608
    s_cselect_b32 s42, 82944, s42
    s_mov_b32 s41, 16128
    s_cselect_b32 s41, 82944, s41
    v_cndmask_b32 v9, v4, v5, vcc
    s_lshl_b32 s37, s35, 7
    s_add_u32 s36, s36, s37
    s_add_u32 m0, s38, 4096
    s_nop 0
    buffer_load_dwordx4 v9, s[60:63], s36 offen lds
    s_add_u32 s36, s36, s42
    s_add_u32 m0, s38, 5120
    s_nop 0
    buffer_load_dwordx4 v9, s[60:63], s36 offen lds
    s_add_u32 s36, s36, s41
    s_add_u32 m0, s38, 6144
    s_nop 0
    buffer_load_dwordx4 v9, s[60:63], s36 offen lds
    s_add_u32 s36, s36, s42
    s_add_u32 m0, s38, 7168
    s_nop 0
    buffer_load_dwordx4 v9, s[60:63], s36 offen lds
    s_add_u32 s36, s36, s42
    s_mul_i32 s35, s35, 73728
    s_lshl_b32 s34, s34, 10
    s_add_u32 s35, s35, s34
    s_add_u32 s46, s35, 0xc00000
    s_cmp_ge_u32 s39, 162
    s_cselect_b32 s46, 0x7f000000, s46
    s_sub_u32 s39, s33, 56
    s_lshr_b32 s34, s39, 1
    s_mul_i32 s34, s34, 20736
    s_and_b32 s35, s39, 1
    s_mul_i32 s35, s35, 4608
    s_add_u32 s34, s34, s35
    s_sub_u32 s35, s39, 64
    s_mul_i32 s35, s35, 82944
    s_cmp_ge_u32 s33, 120
    s_cselect_b32 s34, s35, s34
    s_cselect_b64 vcc, -1, 0
    v_cndmask_b32 v9, v4, v5, vcc
    s_lshl_b32 s35, s39, 5
    s_add_u32 s35, s35, 0xbd4000
    s_cmp_lt_u32 s33, 56
    s_cbranch_scc1 Lnorm14
    buffer_load_dwordx4 v[80:83], v9, s[60:63], s34 offen offset:0
    buffer_load_dwordx4 v[84:87], v9, s[60:63], s34 offen offset:128
    buffer_load_dwordx4 v[88:91], v9, s[60:63], s34 offen offset:256
    buffer_load_dwordx4 v[92:95], v9, s[60:63], s34 offen offset:384
    buffer_load_dwordx4 v[96:99], v9, s[60:63], s34 offen offset:512
    buffer_load_dwordx4 v[100:103], v9, s[60:63], s34 offen offset:640
    buffer_load_dwordx4 v[104:107], v9, s[60:63], s34 offen offset:768
    buffer_load_dwordx4 v[108:111], v9, s[60:63], s34 offen offset:896
    buffer_load_dwordx4 v[112:115], v9, s[60:63], s34 offen offset:1024
Lnorm14:
    v_mov_b32 v10, 0
    v_mov_b32 v11, 0
    s_waitcnt vmcnt(0)
    ds_read_b64_tr_b16 v[48:49], v7 offset:0
    ds_read_b64_tr_b16 v[50:51], v7 offset:512
    ds_read_b64_tr_b16 v[52:53], v7 offset:32
    ds_read_b64_tr_b16 v[54:55], v7 offset:544
    ds_read_b64_tr_b16 v[56:57], v7 offset:64
    ds_read_b64_tr_b16 v[58:59], v7 offset:576
    ds_read_b64_tr_b16 v[60:61], v7 offset:96
    ds_read_b64_tr_b16 v[62:63], v7 offset:608
    ds_read_b64_tr_b16 v[64:65], v7 offset:4096
    ds_read_b64_tr_b16 v[66:67], v7 offset:4608
    ds_read_b64_tr_b16 v[68:69], v7 offset:4128
    ds_read_b64_tr_b16 v[70:71], v7 offset:4640
    ds_read_b64_tr_b16 v[72:73], v7 offset:4160
    ds_read_b64_tr_b16 v[74:75], v7 offset:4672
    ds_read_b64_tr_b16 v[76:77], v7 offset:4192
    ds_read_b64_tr_b16 v[78:79], v7 offset:4704
    s_waitcnt lgkmcnt(8)
    buffer_store_dwordx4 v[48:51], v8, s[12:15], s45 offen sc1
    s_add_u32 s45, s45, 18432
    buffer_store_dwordx4 v[52:55], v8, s[12:15], s45 offen sc1
    s_add_u32 s45, s45, 18432
    buffer_store_dwordx4 v[56:59], v8, s[12:15], s45 offen sc1
    s_add_u32 s45, s45, 18432
    buffer_store_dwordx4 v[60:63], v8, s[12:15], s45 offen sc1
    s_add_u32 s45, s45, 18432
    s_waitcnt lgkmcnt(0)
    buffer_store_dwordx4 v[64:67], v8, s[12:15], s46 offen sc1
    s_add_u32 s46, s46, 18432
    buffer_store_dwordx4 v[68:71], v8, s[12:15], s46 offen sc1
    s_add_u32 s46, s46, 18432
    buffer_store_dwordx4 v[72:75], v8, s[12:15], s46 offen sc1
    s_add_u32 s46, s46, 18432
    buffer_store_dwordx4 v[76:79], v8, s[12:15], s46 offen sc1
    s_add_u32 s46, s46, 18432
    s_cmp_lt_u32 s33, 56
    s_cbranch_scc1 Lnorm215
    v_dot2c_f32_bf16 v10, s32, v80
    v_dot2c_f32_bf16 v11, s32, v81
    v_dot2c_f32_bf16 v10, s32, v82
    v_dot2c_f32_bf16 v11, s32, v83
    v_dot2c_f32_bf16 v10, s32, v84
    v_dot2c_f32_bf16 v11, s32, v85
    v_dot2c_f32_bf16 v10, s32, v86
    v_dot2c_f32_bf16 v11, s32, v87
    v_dot2c_f32_bf16 v10, s32, v88
    v_dot2c_f32_bf16 v11, s32, v89
    v_dot2c_f32_bf16 v10, s32, v90
    v_dot2c_f32_bf16 v11, s32, v91
    v_dot2c_f32_bf16 v10, s32, v92
    v_dot2c_f32_bf16 v11, s32, v93
    v_dot2c_f32_bf16 v10, s32, v94
    v_dot2c_f32_bf16 v11, s32, v95
    v_dot2c_f32_bf16 v10, s32, v96
    v_dot2c_f32_bf16 v11, s32, v97
    v_dot2c_f32_bf16 v10, s32, v98
    v_dot2c_f32_bf16 v11, s32, v99
    v_dot2c_f32_bf16 v10, s32, v100
    v_dot2c_f32_bf16 v11, s32, v101
    v_dot2c_f32_bf16 v10, s32, v102
    v_dot2c_f32_bf16 v11, s32, v103
    v_dot2c_f32_bf16 v10, s32, v104
    v_dot2c_f32_bf16 v11, s32, v105
    v_dot2c_f32_bf16 v10, s32, v106
    v_dot2c_f32_bf16 v11, s32, v107
    v_dot2c_f32_bf16 v10, s32, v108
    v_dot2c_f32_bf16 v11, s32, v109
    v_dot2c_f32_bf16 v10, s32, v110
    v_dot2c_f32_bf16 v11, s32, v111
    v_dot2c_f32_bf16 v10, s32, v112
    v_dot2c_f32_bf16 v11, s32, v113
    v_dot2c_f32_bf16 v10, s32, v114
    v_dot2c_f32_bf16 v11, s32, v115
    s_nop 2
    v_add_f32 v10, v10, v11
    s_nop 1
    v_add_f32_dpp v10, v10, v10 quad_perm:[1,0,3,2] row_mask:0xf bank_mask:0xf
    s_nop 1
    v_add_f32_dpp v10, v10, v10 quad_perm:[2,3,0,1] row_mask:0xf bank_mask:0xf
    s_nop 1
    v_add_f32_dpp v10, v10, v10 row_half_mirror row_mask:0xf bank_mask:0xf
    v_mul_f32 v10, 0x3ae38e39, v10
    v_cvt_pk_bf16_f32 v11, v10, v10
    v_lshlrev_b32 v12, 16, v11
    v_sub_f32 v12, v10, v12
    v_cvt_pk_bf16_f32 v12, v12, v12
    v_lshlrev_b32 v2, 1, v2
    s_mov_b32 exec_lo, 0x01010101
    s_mov_b32 exec_hi, 0x01010101
    buffer_store_short v11, v2, s[12:15], s35 offen sc1
    buffer_store_short v12, v2, s[12:15], s35 offen offset:16 sc1
    s_mov_b64 exec, -1
Lnorm215:
    v_mov_b32 v176, 0
Lp1fin3:
    v_mov_b32 v32, 0
    v_mov_b32 v33, 1
    s_waitcnt vmcnt(0)
    s_barrier
    s_cmp_lg_u32 s3, 1
    s_cbranch_scc1 Lnosig16
    s_mov_b64 exec, 1
    buffer_store_dword v33, v32, s[12:15], s30 offen sc1
    s_mov_b64 exec, -1
Lnosig16:
    s_cmp_lg_u32 s3, 0
    s_cbranch_scc1 Lcntok17
    s_mov_b32 s39, 0x40000
Lcntl18:
    v_cmp_gt_u32 vcc, 64, v176
    s_nop 4
    s_cbranch_vccz Lcntok17
    s_sub_u32 s39, s39, 1
    s_cbranch_scc1 Lcntok17
    buffer_load_dword v176, v45, s[24:27], 0 offen sc1
    s_waitcnt vmcnt(0)
    s_branch Lcntl18
Lcntok17:
p2_start:
    s_load_dwordx4 s[56:59], s[0:1], 32
    s_load_dwordx2 s[60:61], s[0:1], 48
    s_load_dwordx2 s[62:63], s[0:1], 0
    v_and_b32 v1, 63, v0
    s_and_b32 s27, s2, 7
    s_lshl_b32 s27, s27, 2
    s_bfe_u32 s44, s2, 0x20003
    s_add_u32 s25, s27, s44
    s_lshr_b32 s26, s2, 5
    v_lshrrev_b32 v13, 5, v1
    v_and_b32 v14, 31, v1
    s_mul_i32 s27, s25, 18
    s_and_b32 s28, s27, 0xfff8
    v_bfe_u32 v15, v1, 4, 1
    v_mul_u32_u24 v16, 23, v15
    v_add_u32 v16, s28, v16
    v_mul_u32_u24 v17, 576, v13
    v_add3_u32 v17, v17, v16, v16
    v_sub_u32 v17, v17, v16
    v_add_u32 v17, 576, v17
    v_min_u32 v17, 1727, v17
    v_and_b32 v18, 15, v1
    v_lshrrev_b32 v196, 7, v17
    v_cmp_lt_u32 vcc, 6, v196
    v_lshlrev_b32 v196, 5, v196
    v_mov_b32 v19, 223
    v_cndmask_b32 v19, 0, v19, vcc
    v_sub_u32 v196, v196, v19
    v_and_b32 v19, 3, v18
    v_lshl_add_u32 v196, v19, 3, v196
    v_lshrrev_b32 v19, 2, v18
    v_lshl_add_u32 v196, v19, 1, v196
    s_lshl_b32 s29, s26, 1
    v_and_b32 v19, 1, v1
    v_add_u32 v19, s29, v19
    v_cmp_gt_u32 vcc, 32, v1
    v_mov_b32 v17, 1727
    s_nop 0
    v_cndmask_b32 v18, v18, v19, vcc
    v_cndmask_b32 v16, v17, v16, vcc
    v_lshrrev_b32 v197, 7, v16
    v_cmp_lt_u32 vcc, 6, v197
    v_lshlrev_b32 v197, 5, v197
    v_mov_b32 v19, 223
    v_cndmask_b32 v19, 0, v19, vcc
    v_sub_u32 v197, v197, v19
    v_and_b32 v19, 3, v18
    v_lshl_add_u32 v197, v19, 3, v197
    v_lshrrev_b32 v19, 2, v18
    v_lshl_add_u32 v197, v19, 1, v197
    s_mov_b32 s29, 0xcc0000
    v_lshl_add_u32 v196, v196, 7, s29
    v_lshl_add_u32 v197, v197, 7, s29
    v_lshlrev_b32 v15, 4, v14
    v_lshl_add_u32 v2, v13, 15, v15
    v_lshl_add_u32 v3, v13, 3, v15
    v_lshlrev_b32 v5, 4, v1
    s_mul_i32 s27, s25, 288
    v_add_u32 v4, s27, v15
    v_mov_b32 v16, 9216
    v_cmp_eq_u32 vcc, 18, v14
    s_nop 1
    v_cndmask_b32 v4, v4, v16, vcc
    v_mov_b32 v16, 0x7f000000
    v_cmp_lt_u32 vcc, 18, v14
    s_nop 1
    v_cndmask_b32 v4, v4, v16, vcc
    v_mul_u32_u24 v16, 9344, v13
    v_add_u32 v4, v4, v16
    v_add_u32 v12, 18688, v4
    s_lshr_b32 s27, s28, 3
    s_cmp_eq_u32 s44, 3
    s_cselect_b32 s28, 1, 0
    s_cselect_b32 s29, 0, 2
    s_cselect_b32 s66, -1, 0
    s_cselect_b32 s67, 0, -1
    s_cselect_b32 s54, 0, -1
    s_cselect_b32 s65, -1, 0
    s_add_u32 s28, s28, s27
    s_add_u32 s29, s29, s27
    s_lshl_b32 s28, s28, 15
    s_lshl_b32 s29, s29, 15
    s_cmp_eq_u32 s44, 2
    s_cselect_b32 s55, -1, 0
    s_cselect_b32 s52, 0, -1
    s_sub_u32 s27, s44, 1
    s_cmp_lt_u32 s27, 2
    s_cselect_b32 s50, 0, -1
    s_cselect_b32 s64, -1, 0
    s_mov_b32 s51, -1
    s_mov_b32 s53, -1
    s_add_u32 s42, s28, 0x240000
    s_add_u32 s43, s29, 0x240000
    s_lshl_b32 s27, s3, 13
    s_add_u32 s30, s42, s27
    s_add_u32 s31, s43, s27
    s_lshl_b32 s45, s26, 8
    s_lshl_b32 s27, s3, 6
    s_add_u32 s45, s45, s27
    s_lshl_b32 s27, s45, 4
    s_add_u32 s34, s28, s27
    s_add_u32 s35, s29, s27
    s_mul_i32 s32, s3, 598016
    s_add_u32 s32, s32, 0x480000
    s_lshl_b32 s27, s2, 2
    s_add_u32 s27, s27, s3
    s_lshl_b32 s41, s3, 14
    s_add_u32 s41, s41, 94208
    v_lshrrev_b32 v15, 3, v1
    v_and_b32 v16, 7, v1
    v_bfe_u32 v17, v1, 2, 2
    v_and_b32 v18, 3, v1
    v_lshrrev_b32 v19, 4, v1
    v_lshl_add_u32 v8, v17, 7, s41
    s_waitcnt lgkmcnt(0)
    s_cmp_lt_u32 s27, 648
    s_cbranch_scc1 Lgu19
    v_lshl_add_u32 v8, v19, 10, v8
    v_lshl_add_u32 v8, v18, 3, v8
    s_mov_b32 s16, s60
    s_and_b32 s17, s61, 0xffff
    s_mov_b32 s18, 0x510000
    s_mov_b32 s19, 0x00020000
    s_mov_b32 s20, s60
    s_and_b32 s21, s61, 0xffff
    s_mov_b32 s22, 0x510000
    s_mov_b32 s23, 0x00020000
    s_sub_u32 s27, s27, 648
    s_mul_i32 s28, s27, 57
    s_lshr_b32 s28, s28, 9
    s_mul_i32 s29, s28, 9
    s_sub_u32 s29, s27, s29
    s_mov_b32 s4, 4096
    s_mov_b32 s5, 0
    s_mul_i32 s46, s28, 57
    s_lshr_b32 s46, s46, 9
    s_mul_i32 s47, s46, 9
    s_sub_u32 s47, s28, s47
    s_lshl_b32 s47, s47, 2
    s_lshl_b32 s6, s29, 2
    s_add_u32 s6, s6, 0
    s_mul_i32 s33, s6, 57
    s_lshr_b32 s33, s33, 9
    s_mul_i32 s10, s33, 9
    s_sub_u32 s6, s6, s10
    s_lshr_b32 s10, s6, 1
    s_sub_u32 s10, s10, s46
    s_and_b32 s10, s10, 3
    s_cmp_eq_u32 s6, 8
    s_cselect_b32 s10, 4, s10
    s_mul_i32 s10, s10, 12
    s_mov_b32 s68, 0x2a004fc
    s_mov_b32 s69, 0xa044b4a
    s_lshr_b64 s[68:69], s[68:69], s10
    s_bfe_u32 s10, s68, 0x30009
    s_and_b32 s68, s68, 511
    s_and_b32 s6, s6, 1
    s_add_u32 s6, s6, s68
    s_mul_i32 s68, s10, s47
    s_add_u32 s6, s6, s68
    s_lshl_b32 s33, s33, 2
    s_add_u32 s33, s33, s46
    s_mul_i32 s33, s33, 324
    s_add_u32 s6, s6, s33
    s_lshl_b32 s6, s6, 10
    s_add_u32 s6, s6, 0x1800000
    s_lshl_b32 s10, s10, 10
    s_cmp_ge_u32 s28, 36
    s_cselect_b32 s6, 0x7f000000, s6
    s_lshl_b32 s7, s29, 2
    s_add_u32 s7, s7, 1
    s_mul_i32 s33, s7, 57
    s_lshr_b32 s33, s33, 9
    s_mul_i32 s24, s33, 9
    s_sub_u32 s7, s7, s24
    s_lshr_b32 s24, s7, 1
    s_sub_u32 s24, s24, s46
    s_and_b32 s24, s24, 3
    s_cmp_eq_u32 s7, 8
    s_cselect_b32 s24, 4, s24
    s_mul_i32 s24, s24, 12
    s_mov_b32 s68, 0x2a004fc
    s_mov_b32 s69, 0xa044b4a
    s_lshr_b64 s[68:69], s[68:69], s24
    s_bfe_u32 s24, s68, 0x30009
    s_and_b32 s68, s68, 511
    s_and_b32 s7, s7, 1
    s_add_u32 s7, s7, s68
    s_mul_i32 s68, s24, s47
    s_add_u32 s7, s7, s68
    s_lshl_b32 s33, s33, 2
    s_add_u32 s33, s33, s46
    s_mul_i32 s33, s33, 324
    s_add_u32 s7, s7, s33
    s_lshl_b32 s7, s7, 10
    s_add_u32 s7, s7, 0x1800000
    s_lshl_b32 s24, s24, 10
    s_cmp_ge_u32 s28, 36
    s_cselect_b32 s7, 0x7f000000, s7
    s_lshl_b32 s8, s29, 2
    s_add_u32 s8, s8, 2
    s_mul_i32 s33, s8, 57
    s_lshr_b32 s33, s33, 9
    s_mul_i32 s39, s33, 9
    s_sub_u32 s8, s8, s39
    s_lshr_b32 s39, s8, 1
    s_sub_u32 s39, s39, s46
    s_and_b32 s39, s39, 3
    s_cmp_eq_u32 s8, 8
    s_cselect_b32 s39, 4, s39
    s_mul_i32 s39, s39, 12
    s_mov_b32 s68, 0x2a004fc
    s_mov_b32 s69, 0xa044b4a
    s_lshr_b64 s[68:69], s[68:69], s39
    s_bfe_u32 s39, s68, 0x30009
    s_and_b32 s68, s68, 511
    s_and_b32 s8, s8, 1
    s_add_u32 s8, s8, s68
    s_mul_i32 s68, s39, s47
    s_add_u32 s8, s8, s68
    s_lshl_b32 s33, s33, 2
    s_add_u32 s33, s33, s46
    s_mul_i32 s33, s33, 324
    s_add_u32 s8, s8, s33
    s_lshl_b32 s8, s8, 10
    s_add_u32 s8, s8, 0x1800000
    s_lshl_b32 s39, s39, 10
    s_cmp_ge_u32 s28, 36
    s_cselect_b32 s8, 0x7f000000, s8
    s_lshl_b32 s9, s29, 2
    s_add_u32 s9, s9, 3
    s_mul_i32 s33, s9, 57
    s_lshr_b32 s33, s33, 9
    s_mul_i32 s40, s33, 9
    s_sub_u32 s9, s9, s40
    s_lshr_b32 s40, s9, 1
    s_sub_u32 s40, s40, s46
    s_and_b32 s40, s40, 3
    s_cmp_eq_u32 s9, 8
    s_cselect_b32 s40, 4, s40
    s_mul_i32 s40, s40, 12
    s_mov_b32 s68, 0x2a004fc
    s_mov_b32 s69, 0xa044b4a
    s_lshr_b64 s[68:69], s[68:69], s40
    s_bfe_u32 s40, s68, 0x30009
    s_and_b32 s68, s68, 511
    s_and_b32 s9, s9, 1
    s_add_u32 s9, s9, s68
    s_mul_i32 s68, s40, s47
    s_add_u32 s9, s9, s68
    s_lshl_b32 s33, s33, 2
    s_add_u32 s33, s33, s46
    s_mul_i32 s33, s33, 324
    s_add_u32 s9, s9, s33
    s_lshl_b32 s9, s9, 10
    s_add_u32 s9, s9, 0x1800000
    s_lshl_b32 s40, s40, 10
    s_cmp_ge_u32 s28, 36
    s_cselect_b32 s9, 0x7f000000, s9
    s_lshl_b32 s36, s29, 7
    s_mul_i32 s29, s28, 57
    s_lshr_b32 s29, s29, 9
    s_mul_i32 s29, s29, 1161216
    s_mul_i32 s28, s28, 18432
    s_add_u32 s36, s36, s28
    s_add_u32 s36, s36, s29
    v_mul_u32_u24 v6, 1152, v15
    v_lshl_add_u32 v6, v16, 4, v6
    v_add_u32 v7, 8192, v6
    s_add_u32 s37, s36, 165888
    s_mov_b32 s38, 331776
    s_branch Lset20
Lgu19:
    s_mov_b32 s16, s56
    s_and_b32 s17, s57, 0xffff
    s_mov_b32 s18, 0x510000
    s_mov_b32 s19, 0x00020000
    s_mov_b32 s20, s58
    s_and_b32 s21, s59, 0xffff
    s_mov_b32 s22, 0x510000
    s_mov_b32 s23, 0x00020000
    s_mul_i32 s28, s27, 14564
    s_lshr_b32 s28, s28, 20
    s_mul_i32 s29, s28, 72
    s_sub_u32 s29, s27, s29
    s_mul_i32 s39, s29, 147456
    s_lshl_b32 s40, s28, 12
    s_add_u32 s39, s39, s40
    s_add_u32 s39, s39, 0xd00000
    s_lshl_b32 s36, s29, 7
    s_mul_i32 s28, s28, 589824
    s_add_u32 s36, s36, s28
    s_mov_b32 s37, s36
    v_mul_u32_u24 v6, 9216, v15
    v_lshl_add_u32 v6, v16, 4, v6
    v_add_u32 v7, 72704, v6
    s_mov_b32 s38, 147456
    v_lshrrev_b32 v17, 1, v19
    v_lshl_add_u32 v8, v17, 12, v8
    v_and_b32 v17, 1, v19
    v_lshl_add_u32 v8, v17, 10, v8
    v_lshl_add_u32 v8, v18, 3, v8
    s_mov_b32 s4, 2048
    s_mov_b32 s5, 4096
    s_add_u32 s6, s39, 0
    s_add_u32 s7, s39, 36864
    s_add_u32 s8, s39, 73728
    s_add_u32 s9, s39, 110592
    s_mov_b32 s10, 1024
    s_mov_b32 s24, 1024
    s_mov_b32 s39, 1024
    s_mov_b32 s40, 1024
Lset20:
    v_mov_b32 v9, v5
    v_lshlrev_b32 v10, 3, v1
    s_mul_i32 s27, s3, 20480
    s_add_u32 s27, s27, 12288
    v_add_u32 v11, s27, v5
    s_mul_i32 s27, s3, 3072
    v_add_u32 v15, s27, v9
    v_add_u32 v16, s27, v10
    v_mov_b32 v17, 0x3f80
    s_mul_i32 s11, s2, 27648
    s_mul_i32 s27, s3, 2304
    s_add_u32 s11, s11, s27
    s_add_u32 s11, s11, 0x3200000
    v_mov_b32 v240, -1
    v_mov_b32 v241, -1
    v_mov_b32 v242, -1
    v_mov_b32 v243, -1
    v_min_u32 v244, 240, v5
    s_mov_b32 s56, s62
    s_and_b32 s57, s63, 0xffff
    s_mov_b32 s58, 0x240000
    s_mov_b32 s59, 0x00020000
    s_and_b32 s27, s2, 7
    s_lshl_b32 s27, s27, 4
    s_lshl_b32 s28, s44, 2
    s_add_u32 s27, s27, s28
    s_add_u32 s27, s27, s3
    s_mul_i32 s27, s27, 18432
    s_mul_i32 s28, s26, 5
    s_lshl_b32 s29, s26, 2
    s_add_u32 s29, s29, 4
    s_min_u32 s28, s28, s29
    s_lshl_b32 s28, s28, 5
    s_add_u32 s27, s27, s28
    v_and_b32 v247, 15, v1
    v_mul_u32_u24 v247, 1152, v247
    v_lshrrev_b32 v207, 4, v1
    v_lshl_add_u32 v247, v207, 3, v247
    s_mov_b32 s49, s27
    s_lshr_b32 s48, s2, 3
    s_lshl_b32 s48, s48, 2
    s_add_u32 s48, s48, s3
    s_mul_i32 s48, s48, 5248
    s_add_u32 s48, s48, 0xc00000
    v_min_u32 v245, 40, v1
    v_lshlrev_b32 v245, 7, v245
    v_and_b32 v238, 31, v1
    v_lshlrev_b32 v238, 7, v238
    v_add_u32 v238, 0xcc7000, v238
    s_cmp_lg_u32 s3, 0
    s_cbranch_scc1 Lnopoll21
    s_mov_b32 s33, 0x40000
Lpoll22:
    s_sub_u32 s33, s33, 1
    s_cbranch_scc1 Lnopoll21
    buffer_load_dword v198, v196, s[12:15], 0 offen sc1
    buffer_load_dword v199, v197, s[12:15], 0 offen sc1
    s_waitcnt vmcnt(0)
    v_and_b32 v198, v198, v199
    v_cmp_ne_u32 vcc, 1, v198
    s_nop 4
    s_cbranch_vccnz Lpoll22
Lnopoll21:
    s_barrier
    buffer_load_dwordx4 v[156:159], v2, s[12:15], s34 offen offset:0 sc1
    buffer_load_dwordx2 v[160:161], v3, s[12:15], s35 offen offset:0 sc1
    buffer_load_dwordx4 v[164:167], v2, s[12:15], s34 offen offset:512 sc1
    buffer_load_dwordx2 v[168:169], v3, s[12:15], s35 offen offset:512 sc1
    buffer_load_dwordx4 a[0:3], v2, s[12:15], s30 offen offset:0 sc1
    buffer_load_dwordx2 v[108:109], v3, s[12:15], s31 offen offset:0 sc1
    buffer_load_dwordx4 a[64:67], v4, s[12:15], s32 offen sc1
    buffer_load_dwordx4 a[68:71], v12, s[12:15], s32 offen sc1
    s_add_u32 s32, s32, 37376
    buffer_load_dwordx4 a[4:7], v2, s[12:15], s30 offen offset:512 sc1
    buffer_load_dwordx2 v[110:111], v3, s[12:15], s31 offen offset:512 sc1
    buffer_load_dwordx4 a[72:75], v4, s[12:15], s32 offen sc1
    buffer_load_dwordx4 a[76:79], v12, s[12:15], s32 offen sc1
    s_add_u32 s32, s32, 37376
    s_waitcnt vmcnt(6)
    v_cndmask_b32 v156, 0, v156, s[50:51]
    v_cndmask_b32 v157, 0, v157, s[52:53]
    v_cndmask_b32 v160, 0, v160, s[54:55]
    v_cndmask_b32 v161, 0, v161, s[64:65]
    v_cndmask_b32 v164, 0, v164, s[50:51]
    v_cndmask_b32 v165, 0, v165, s[52:53]
    v_cndmask_b32 v168, 0, v168, s[54:55]
    v_cndmask_b32 v169, 0, v169, s[64:65]
    v_cndmask_b32 v109, v109, v17, s[66:67]
    s_nop 1
    v_mfma_f32_32x32x8_bf16 v[36:51], v[108:109], v[160:161], 0
    v_mfma_f32_32x32x8_bf16 v[52:67], v[108:109], v[168:169], 0
    v_mfma_f32_32x32x16_bf16 v[36:51], a[0:3], v[156:159], v[36:51]
    ds_write_b128 v15, v[156:159] offset:0
    buffer_load_dwordx4 a[8:11], v2, s[12:15], s30 offen offset:1024 sc1
    buffer_load_dwordx2 v[112:113], v3, s[12:15], s31 offen offset:1024 sc1
    v_mfma_f32_32x32x16_bf16 v[52:67], a[0:3], v[164:167], v[52:67]
    ds_write_b128 v15, v[164:167] offset:1536
    buffer_load_dwordx4 a[80:83], v4, s[12:15], s32 offen sc1
    buffer_load_dwordx4 a[84:87], v12, s[12:15], s32 offen sc1
    s_add_u32 s32, s32, 37376
    s_nop 3
    v_max3_f32 v36, v36, v37, v38
    v_max3_f32 v39, v39, v40, v41
    v_max3_f32 v42, v42, v43, v44
    v_max3_f32 v36, v36, v39, v42
    v_sub_f32 v36, 0xc1800000, v36
    v_cvt_pk_bf16_f32 v36, v36, 0
    v_cndmask_b32 v161, v161, v36, s[66:67]
    ds_write_b64 v16, v[160:161] offset:1024
    v_max3_f32 v52, v52, v53, v54
    v_max3_f32 v55, v55, v56, v57
    v_max3_f32 v58, v58, v59, v60
    v_max3_f32 v52, v52, v55, v58
    v_sub_f32 v52, 0xc1800000, v52
    v_cvt_pk_bf16_f32 v52, v52, 0
    v_cndmask_b32 v169, v169, v52, s[66:67]
    ds_write_b64 v16, v[168:169] offset:2560
    s_waitcnt lgkmcnt(0)
    s_barrier
    ds_read_b128 v[204:207], v9 offset:0
    ds_read_b64 v[208:209], v10 offset:1024
    ds_read_b128 v[28:31], v9 offset:1536
    ds_read_b64 v[32:33], v10 offset:2560
    buffer_load_dwordx4 a[12:15], v2, s[12:15], s30 offen offset:1536 sc1
    buffer_load_dwordx2 v[114:115], v3, s[12:15], s31 offen offset:1536 sc1
    buffer_load_dwordx4 a[88:91], v4, s[12:15], s32 offen sc1
    buffer_load_dwordx4 a[92:95], v12, s[12:15], s32 offen sc1
    s_add_u32 s32, s32, 37376
    s_waitcnt lgkmcnt(2)
    v_mfma_f32_32x32x8_bf16 v[36:51], v[108:109], v[208:209], 0
    v_mfma_f32_32x32x16_bf16 v[36:51], a[0:3], v[204:207], v[36:51]
    v_add_u32 v9, 1536, v9
    v_add_u32 v10, 1536, v10
    s_nop 9
    v_exp_f32 v36, v36
    s_waitcnt lgkmcnt(0)
    v_mfma_f32_32x32x8_bf16 v[52:67], v[108:109], v[32:33], 0
    v_exp_f32 v37, v37
    v_exp_f32 v38, v38
    v_cvt_pk_bf16_f32 v68, v36, v37
    v_exp_f32 v39, v39
    v_exp_f32 v40, v40
    v_cvt_pk_bf16_f32 v69, v38, v39
    v_mfma_f32_32x32x16_bf16 v[52:67], a[0:3], v[28:31], v[52:67]
    buffer_load_dwordx4 a[16:19], v2, s[12:15], s30 offen offset:2048 sc1
    buffer_load_dwordx2 v[116:117], v3, s[12:15], s31 offen offset:2048 sc1
    v_exp_f32 v41, v41
    v_exp_f32 v42, v42
    v_cvt_pk_bf16_f32 v70, v40, v41
    v_exp_f32 v43, v43
    v_exp_f32 v44, v44
    v_cvt_pk_bf16_f32 v71, v42, v43
    v_exp_f32 v45, v45
    v_exp_f32 v46, v46
    v_cvt_pk_bf16_f32 v72, v44, v45
    v_exp_f32 v47, v47
    v_exp_f32 v48, v48
    s_waitcnt vmcnt(14)
    v_mfma_f32_32x32x16_bf16 v[212:227], a[64:67], v[68:71], 0
    v_cvt_pk_bf16_f32 v73, v46, v47
    v_exp_f32 v49, v49
    v_exp_f32 v50, v50
    v_cvt_pk_bf16_f32 v74, v48, v49
    v_exp_f32 v51, v51
    s_waitcnt vmcnt(12)
    v_cndmask_b32 v111, v111, v17, s[66:67]
    v_exp_f32 v52, v52
    v_cvt_pk_bf16_f32 v75, v50, v51
    v_mfma_f32_32x32x8_bf16 v[36:51], v[110:111], v[208:209], 0
    v_exp_f32 v53, v53
    v_exp_f32 v54, v54
    v_cvt_pk_bf16_f32 v68, v52, v53
    v_exp_f32 v55, v55
    v_exp_f32 v56, v56
    v_cvt_pk_bf16_f32 v69, v54, v55
    v_mfma_f32_32x32x16_bf16 v[36:51], a[4:7], v[204:207], v[36:51]
    buffer_load_dwordx4 a[96:99], v4, s[12:15], s32 offen sc1
    buffer_load_dwordx4 a[100:103], v12, s[12:15], s32 offen sc1
    s_add_u32 s32, s32, 37376
    v_exp_f32 v57, v57
    v_exp_f32 v58, v58
    v_cvt_pk_bf16_f32 v70, v56, v57
    v_exp_f32 v59, v59
    v_exp_f32 v60, v60
    v_mfma_f32_32x32x16_bf16 v[212:227], a[68:71], v[72:75], v[212:227]
    v_cvt_pk_bf16_f32 v71, v58, v59
    v_exp_f32 v61, v61
    v_exp_f32 v62, v62
    v_cvt_pk_bf16_f32 v72, v60, v61
    v_exp_f32 v63, v63
    v_exp_f32 v64, v64
    v_mfma_f32_32x32x16_bf16 v[76:91], a[64:67], v[68:71], 0
    v_cvt_pk_bf16_f32 v73, v62, v63
    v_exp_f32 v65, v65
    v_exp_f32 v66, v66
    v_cvt_pk_bf16_f32 v74, v64, v65
    v_exp_f32 v67, v67
    v_exp_f32 v36, v36
    v_cvt_pk_bf16_f32 v75, v66, v67
    v_mfma_f32_32x32x8_bf16 v[52:67], v[110:111], v[32:33], 0
    v_exp_f32 v37, v37
    v_exp_f32 v38, v38
    v_cvt_pk_bf16_f32 v68, v36, v37
    v_exp_f32 v39, v39
    v_exp_f32 v40, v40
    v_cvt_pk_bf16_f32 v69, v38, v39
    v_mfma_f32_32x32x16_bf16 v[52:67], a[4:7], v[28:31], v[52:67]
    buffer_load_dwordx4 a[20:23], v2, s[12:15], s30 offen offset:2560 sc1
    buffer_load_dwordx2 v[118:119], v3, s[12:15], s31 offen offset:2560 sc1
    v_exp_f32 v41, v41
    v_exp_f32 v42, v42
    v_cvt_pk_bf16_f32 v70, v40, v41
    v_exp_f32 v43, v43
    v_exp_f32 v44, v44
    v_mfma_f32_32x32x16_bf16 v[76:91], a[68:71], v[72:75], v[76:91]
    v_cvt_pk_bf16_f32 v71, v42, v43
    v_exp_f32 v45, v45
    v_exp_f32 v46, v46
    v_cvt_pk_bf16_f32 v72, v44, v45
    v_exp_f32 v47, v47
    v_exp_f32 v48, v48
    s_waitcnt vmcnt(14)
    v_mfma_f32_32x32x16_bf16 v[212:227], a[72:75], v[68:71], v[212:227]
    v_cvt_pk_bf16_f32 v73, v46, v47
    v_exp_f32 v49, v49
    v_exp_f32 v50, v50
    v_cvt_pk_bf16_f32 v74, v48, v49
    v_exp_f32 v51, v51
    s_waitcnt vmcnt(12)
    v_cndmask_b32 v113, v113, v17, s[66:67]
    v_exp_f32 v52, v52
    v_cvt_pk_bf16_f32 v75, v50, v51
    v_mfma_f32_32x32x8_bf16 v[36:51], v[112:113], v[208:209], 0
    v_exp_f32 v53, v53
    v_exp_f32 v54, v54
    v_cvt_pk_bf16_f32 v68, v52, v53
    v_exp_f32 v55, v55
    v_exp_f32 v56, v56
    v_cvt_pk_bf16_f32 v69, v54, v55
    v_mfma_f32_32x32x16_bf16 v[36:51], a[8:11], v[204:207], v[36:51]
    buffer_load_dwordx4 a[104:107], v4, s[12:15], s32 offen sc1
    buffer_load_dwordx4 a[108:111], v12, s[12:15], s32 offen sc1
    s_add_u32 s32, s32, 37376
    v_exp_f32 v57, v57
    v_exp_f32 v58, v58
    v_cvt_pk_bf16_f32 v70, v56, v57
    v_exp_f32 v59, v59
    v_exp_f32 v60, v60
    v_mfma_f32_32x32x16_bf16 v[212:227], a[76:79], v[72:75], v[212:227]
    ds_read_b128 v[20:23], v9 offset:1536
    ds_read_b64 v[24:25], v10 offset:2560
    v_cvt_pk_bf16_f32 v71, v58, v59
    v_exp_f32 v61, v61
    v_exp_f32 v62, v62
    v_cvt_pk_bf16_f32 v72, v60, v61
    v_exp_f32 v63, v63
    v_exp_f32 v64, v64
    v_mfma_f32_32x32x16_bf16 v[76:91], a[72:75], v[68:71], v[76:91]
    v_cvt_pk_bf16_f32 v73, v62, v63
    v_exp_f32 v65, v65
    v_exp_f32 v66, v66
    v_cvt_pk_bf16_f32 v74, v64, v65
    v_exp_f32 v67, v67
    v_exp_f32 v36, v36
    v_cvt_pk_bf16_f32 v75, v66, v67
    v_mfma_f32_32x32x8_bf16 v[52:67], v[112:113], v[32:33], 0
    v_exp_f32 v37, v37
    v_exp_f32 v38, v38
    v_cvt_pk_bf16_f32 v68, v36, v37
    v_exp_f32 v39, v39
    v_exp_f32 v40, v40
    v_cvt_pk_bf16_f32 v69, v38, v39
    v_mfma_f32_32x32x16_bf16 v[52:67], a[8:11], v[28:31], v[52:67]
    buffer_load_dwordx4 a[24:27], v2, s[12:15], s30 offen offset:3072 sc1
    buffer_load_dwordx2 v[120:121], v3, s[12:15], s31 offen offset:3072 sc1
    v_exp_f32 v41, v41
    v_exp_f32 v42, v42
    v_cvt_pk_bf16_f32 v70, v40, v41
    v_exp_f32 v43, v43
    v_exp_f32 v44, v44
    v_mfma_f32_32x32x16_bf16 v[76:91], a[76:79], v[72:75], v[76:91]
    v_cvt_pk_bf16_f32 v71, v42, v43
    v_exp_f32 v45, v45
    v_exp_f32 v46, v46
    v_cvt_pk_bf16_f32 v72, v44, v45
    v_exp_f32 v47, v47
    v_exp_f32 v48, v48
    s_waitcnt vmcnt(14)
    v_mfma_f32_32x32x16_bf16 v[212:227], a[80:83], v[68:71], v[212:227]
    v_cvt_pk_bf16_f32 v73, v46, v47
    v_exp_f32 v49, v49
    v_exp_f32 v50, v50
    v_cvt_pk_bf16_f32 v74, v48, v49
    v_exp_f32 v51, v51
    s_waitcnt vmcnt(12)
    v_cndmask_b32 v115, v115, v17, s[66:67]
    v_exp_f32 v52, v52
    v_cvt_pk_bf16_f32 v75, v50, v51
    v_mfma_f32_32x32x8_bf16 v[36:51], v[114:115], v[208:209], 0
    v_exp_f32 v53, v53
    v_exp_f32 v54, v54
    v_cvt_pk_bf16_f32 v68, v52, v53
    v_exp_f32 v55, v55
    v_exp_f32 v56, v56
    v_cvt_pk_bf16_f32 v69, v54, v55
    v_mfma_f32_32x32x16_bf16 v[36:51], a[12:15], v[204:207], v[36:51]
    buffer_load_dwordx4 a[112:115], v4, s[12:15], s32 offen sc1
    buffer_load_dwordx4 a[116:119], v12, s[12:15], s32 offen sc1
    s_add_u32 s32, s32, 37376
    v_exp_f32 v57, v57
    v_exp_f32 v58, v58
    v_cvt_pk_bf16_f32 v70, v56, v57
    v_exp_f32 v59, v59
    v_exp_f32 v60, v60
    v_mfma_f32_32x32x16_bf16 v[212:227], a[84:87], v[72:75], v[212:227]
    v_cvt_pk_bf16_f32 v71, v58, v59
    v_exp_f32 v61, v61
    v_exp_f32 v62, v62
    v_cvt_pk_bf16_f32 v72, v60, v61
    v_exp_f32 v63, v63
    v_exp_f32 v64, v64
    v_mfma_f32_32x32x16_bf16 v[76:91], a[80:83], v[68:71], v[76:91]
    v_cvt_pk_bf16_f32 v73, v62, v63
    v_exp_f32 v65, v65
    v_exp_f32 v66, v66
    v_cvt_pk_bf16_f32 v74, v64, v65
    v_exp_f32 v67, v67
    v_exp_f32 v36, v36
    v_cvt_pk_bf16_f32 v75, v66, v67
    v_mfma_f32_32x32x8_bf16 v[52:67], v[114:115], v[32:33], 0
    v_exp_f32 v37, v37
    v_exp_f32 v38, v38
    v_cvt_pk_bf16_f32 v68, v36, v37
    v_exp_f32 v39, v39
    v_exp_f32 v40, v40
    v_cvt_pk_bf16_f32 v69, v38, v39
    v_mfma_f32_32x32x16_bf16 v[52:67], a[12:15], v[28:31], v[52:67]
    buffer_load_dwordx4 a[28:31], v2, s[12:15], s30 offen offset:3584 sc1
    buffer_load_dwordx2 v[122:123], v3, s[12:15], s31 offen offset:3584 sc1
    v_exp_f32 v41, v41
    v_exp_f32 v42, v42
    v_cvt_pk_bf16_f32 v70, v40, v41
    v_exp_f32 v43, v43
    v_exp_f32 v44, v44
    v_mfma_f32_32x32x16_bf16 v[76:91], a[84:87], v[72:75], v[76:91]
    v_cvt_pk_bf16_f32 v71, v42, v43
    v_exp_f32 v45, v45
    v_exp_f32 v46, v46
    v_cvt_pk_bf16_f32 v72, v44, v45
    v_exp_f32 v47, v47
    v_exp_f32 v48, v48
    s_waitcnt vmcnt(14)
    v_mfma_f32_32x32x16_bf16 v[212:227], a[88:91], v[68:71], v[212:227]
    v_cvt_pk_bf16_f32 v73, v46, v47
    v_exp_f32 v49, v49
    v_exp_f32 v50, v50
    v_cvt_pk_bf16_f32 v74, v48, v49
    v_exp_f32 v51, v51
    s_waitcnt vmcnt(12)
    v_cndmask_b32 v117, v117, v17, s[66:67]
    v_exp_f32 v52, v52
    v_cvt_pk_bf16_f32 v75, v50, v51
    v_mfma_f32_32x32x8_bf16 v[36:51], v[116:117], v[208:209], 0
    v_exp_f32 v53, v53
    v_exp_f32 v54, v54
    v_cvt_pk_bf16_f32 v68, v52, v53
    v_exp_f32 v55, v55
    v_exp_f32 v56, v56
    v_cvt_pk_bf16_f32 v69, v54, v55
    v_mfma_f32_32x32x16_bf16 v[36:51], a[16:19], v[204:207], v[36:51]
    buffer_load_dwordx4 a[120:123], v4, s[12:15], s32 offen sc1
    buffer_load_dwordx4 a[124:127], v12, s[12:15], s32 offen sc1
    s_add_u32 s32, s32, 37376
    s_add_u32 s30, s30, 4096
    s_add_u32 s31, s31, 4096
    v_exp_f32 v57, v57
    v_exp_f32 v58, v58
    v_cvt_pk_bf16_f32 v70, v56, v57
    v_exp_f32 v59, v59
    v_exp_f32 v60, v60
    v_mfma_f32_32x32x16_bf16 v[212:227], a[92:95], v[72:75], v[212:227]
    v_cvt_pk_bf16_f32 v71, v58, v59
    v_exp_f32 v61, v61
    v_exp_f32 v62, v62
    v_cvt_pk_bf16_f32 v72, v60, v61
    v_exp_f32 v63, v63
    v_exp_f32 v64, v64
    v_mfma_f32_32x32x16_bf16 v[76:91], a[88:91], v[68:71], v[76:91]
    v_cvt_pk_bf16_f32 v73, v62, v63
    v_exp_f32 v65, v65
    v_exp_f32 v66, v66
    v_cvt_pk_bf16_f32 v74, v64, v65
    v_exp_f32 v67, v67
    v_exp_f32 v36, v36
    v_cvt_pk_bf16_f32 v75, v66, v67
    v_mfma_f32_32x32x8_bf16 v[52:67], v[116:117], v[32:33], 0
    v_exp_f32 v37, v37
    v_exp_f32 v38, v38
    v_cvt_pk_bf16_f32 v68, v36, v37
    v_exp_f32 v39, v39
    v_exp_f32 v40, v40
    v_cvt_pk_bf16_f32 v69, v38, v39
    v_mfma_f32_32x32x16_bf16 v[52:67], a[16:19], v[28:31], v[52:67]
    buffer_load_dwordx4 a[32:35], v2, s[12:15], s30 offen offset:0 sc1
    buffer_load_dwordx2 v[124:125], v3, s[12:15], s31 offen offset:0 sc1
    v_exp_f32 v41, v41
    v_exp_f32 v42, v42
    v_cvt_pk_bf16_f32 v70, v40, v41
    v_exp_f32 v43, v43
    v_exp_f32 v44, v44
    v_mfma_f32_32x32x16_bf16 v[76:91], a[92:95], v[72:75], v[76:91]
    v_cvt_pk_bf16_f32 v71, v42, v43
    v_exp_f32 v45, v45
    v_exp_f32 v46, v46
    v_cvt_pk_bf16_f32 v72, v44, v45
    v_exp_f32 v47, v47
    v_exp_f32 v48, v48
    s_waitcnt vmcnt(14)
    v_mfma_f32_32x32x16_bf16 v[212:227], a[96:99], v[68:71], v[212:227]
    v_cvt_pk_bf16_f32 v73, v46, v47
    v_exp_f32 v49, v49
    v_exp_f32 v50, v50
    v_cvt_pk_bf16_f32 v74, v48, v49
    v_exp_f32 v51, v51
    s_waitcnt vmcnt(12)
    v_cndmask_b32 v119, v119, v17, s[66:67]
    v_exp_f32 v52, v52
    v_cvt_pk_bf16_f32 v75, v50, v51
    v_mfma_f32_32x32x8_bf16 v[36:51], v[118:119], v[208:209], 0
    v_exp_f32 v53, v53
    v_exp_f32 v54, v54
    v_cvt_pk_bf16_f32 v68, v52, v53
    v_exp_f32 v55, v55
    v_exp_f32 v56, v56
    v_cvt_pk_bf16_f32 v69, v54, v55
    v_mfma_f32_32x32x16_bf16 v[36:51], a[20:23], v[204:207], v[36:51]
    buffer_load_dwordx4 a[128:131], v4, s[12:15], s32 offen sc1
    buffer_load_dwordx4 a[132:135], v12, s[12:15], s32 offen sc1
    s_add_u32 s32, s32, 37376
    v_exp_f32 v57, v57
    v_exp_f32 v58, v58
    v_cvt_pk_bf16_f32 v70, v56, v57
    v_exp_f32 v59, v59
    v_exp_f32 v60, v60
    v_mfma_f32_32x32x16_bf16 v[212:227], a[100:103], v[72:75], v[212:227]
    v_cvt_pk_bf16_f32 v71, v58, v59
    v_exp_f32 v61, v61
    v_exp_f32 v62, v62
    v_cvt_pk_bf16_f32 v72, v60, v61
    v_exp_f32 v63, v63
    v_exp_f32 v64, v64
    v_mfma_f32_32x32x16_bf16 v[76:91], a[96:99], v[68:71], v[76:91]
    v_cvt_pk_bf16_f32 v73, v62, v63
    v_exp_f32 v65, v65
    v_exp_f32 v66, v66
    v_cvt_pk_bf16_f32 v74, v64, v65
    v_exp_f32 v67, v67
    v_exp_f32 v36, v36
    v_cvt_pk_bf16_f32 v75, v66, v67
    v_mfma_f32_32x32x8_bf16 v[52:67], v[118:119], v[32:33], 0
    v_exp_f32 v37, v37
    v_exp_f32 v38, v38
    v_cvt_pk_bf16_f32 v68, v36, v37
    v_exp_f32 v39, v39
    v_exp_f32 v40, v40
    v_cvt_pk_bf16_f32 v69, v38, v39
    v_mfma_f32_32x32x16_bf16 v[52:67], a[20:23], v[28:31], v[52:67]
    buffer_load_dwordx4 a[36:39], v2, s[12:15], s30 offen offset:512 sc1
    buffer_load_dwordx2 v[126:127], v3, s[12:15], s31 offen offset:512 sc1
    v_exp_f32 v41, v41
    v_exp_f32 v42, v42
    v_cvt_pk_bf16_f32 v70, v40, v41
    v_exp_f32 v43, v43
    v_exp_f32 v44, v44
    v_mfma_f32_32x32x16_bf16 v[76:91], a[100:103], v[72:75], v[76:91]
    v_cvt_pk_bf16_f32 v71, v42, v43
    v_exp_f32 v45, v45
    v_exp_f32 v46, v46
    v_cvt_pk_bf16_f32 v72, v44, v45
    v_exp_f32 v47, v47
    v_exp_f32 v48, v48
    s_waitcnt vmcnt(14)
    v_mfma_f32_32x32x16_bf16 v[212:227], a[104:107], v[68:71], v[212:227]
    v_cvt_pk_bf16_f32 v73, v46, v47
    v_exp_f32 v49, v49
    v_exp_f32 v50, v50
    v_cvt_pk_bf16_f32 v74, v48, v49
    v_exp_f32 v51, v51
    s_waitcnt vmcnt(12)
    v_cndmask_b32 v121, v121, v17, s[66:67]
    v_exp_f32 v52, v52
    v_cvt_pk_bf16_f32 v75, v50, v51
    v_mfma_f32_32x32x8_bf16 v[36:51], v[120:121], v[208:209], 0
    v_exp_f32 v53, v53
    v_exp_f32 v54, v54
    v_cvt_pk_bf16_f32 v68, v52, v53
    v_exp_f32 v55, v55
    v_exp_f32 v56, v56
    v_cvt_pk_bf16_f32 v69, v54, v55
    v_mfma_f32_32x32x16_bf16 v[36:51], a[24:27], v[204:207], v[36:51]
    buffer_load_dwordx4 a[136:139], v4, s[12:15], s32 offen sc1
    buffer_load_dwordx4 a[140:143], v12, s[12:15], s32 offen sc1
    s_add_u32 s32, s32, 37376
    v_exp_f32 v57, v57
    v_exp_f32 v58, v58
    v_cvt_pk_bf16_f32 v70, v56, v57
    v_exp_f32 v59, v59
    v_exp_f32 v60, v60
    v_mfma_f32_32x32x16_bf16 v[212:227], a[108:111], v[72:75], v[212:227]
    v_cvt_pk_bf16_f32 v71, v58, v59
    v_exp_f32 v61, v61
    v_exp_f32 v62, v62
    v_cvt_pk_bf16_f32 v72, v60, v61
    v_exp_f32 v63, v63
    v_exp_f32 v64, v64
    v_mfma_f32_32x32x16_bf16 v[76:91], a[104:107], v[68:71], v[76:91]
    v_cvt_pk_bf16_f32 v73, v62, v63
    v_exp_f32 v65, v65
    v_exp_f32 v66, v66
    v_cvt_pk_bf16_f32 v74, v64, v65
    v_exp_f32 v67, v67
    v_exp_f32 v36, v36
    v_cvt_pk_bf16_f32 v75, v66, v67
    v_mfma_f32_32x32x8_bf16 v[52:67], v[120:121], v[32:33], 0
    v_exp_f32 v37, v37
    v_exp_f32 v38, v38
    v_cvt_pk_bf16_f32 v68, v36, v37
    v_exp_f32 v39, v39
    v_exp_f32 v40, v40
    v_cvt_pk_bf16_f32 v69, v38, v39
    v_mfma_f32_32x32x16_bf16 v[52:67], a[24:27], v[28:31], v[52:67]
    buffer_load_dwordx4 a[40:43], v2, s[12:15], s30 offen offset:1024 sc1
    buffer_load_dwordx2 v[128:129], v3, s[12:15], s31 offen offset:1024 sc1
    v_exp_f32 v41, v41
    v_exp_f32 v42, v42
    v_cvt_pk_bf16_f32 v70, v40, v41
    v_exp_f32 v43, v43
    v_exp_f32 v44, v44
    v_mfma_f32_32x32x16_bf16 v[76:91], a[108:111], v[72:75], v[76:91]
    v_cvt_pk_bf16_f32 v71, v42, v43
    v_exp_f32 v45, v45
    v_exp_f32 v46, v46
    v_cvt_pk_bf16_f32 v72, v44, v45
    v_exp_f32 v47, v47
    v_exp_f32 v48, v48
    s_waitcnt vmcnt(14)
    v_mfma_f32_32x32x16_bf16 v[212:227], a[112:115], v[68:71], v[212:227]
    v_cvt_pk_bf16_f32 v73, v46, v47
    v_exp_f32 v49, v49
    v_exp_f32 v50, v50
    v_cvt_pk_bf16_f32 v74, v48, v49
    v_exp_f32 v51, v51
    s_waitcnt vmcnt(12)
    v_cndmask_b32 v123, v123, v17, s[66:67]
    v_exp_f32 v52, v52
    v_cvt_pk_bf16_f32 v75, v50, v51
    v_mfma_f32_32x32x8_bf16 v[36:51], v[122:123], v[208:209], 0
    v_exp_f32 v53, v53
    v_exp_f32 v54, v54
    v_cvt_pk_bf16_f32 v68, v52, v53
    v_exp_f32 v55, v55
    v_exp_f32 v56, v56
    v_cvt_pk_bf16_f32 v69, v54, v55
    v_mfma_f32_32x32x16_bf16 v[36:51], a[28:31], v[204:207], v[36:51]
    buffer_load_dwordx4 a[144:147], v4, s[12:15], s32 offen sc1
    buffer_load_dwordx4 a[148:151], v12, s[12:15], s32 offen sc1
    s_add_u32 s32, s32, 37376
    v_exp_f32 v57, v57
    v_exp_f32 v58, v58
    v_cvt_pk_bf16_f32 v70, v56, v57
    v_exp_f32 v59, v59
    v_exp_f32 v60, v60
    v_mfma_f32_32x32x16_bf16 v[212:227], a[116:119], v[72:75], v[212:227]
    v_cvt_pk_bf16_f32 v71, v58, v59
    v_exp_f32 v61, v61
    v_exp_f32 v62, v62
    v_cvt_pk_bf16_f32 v72, v60, v61
    v_exp_f32 v63, v63
    v_exp_f32 v64, v64
    v_mfma_f32_32x32x16_bf16 v[76:91], a[112:115], v[68:71], v[76:91]
    v_cvt_pk_bf16_f32 v73, v62, v63
    v_exp_f32 v65, v65
    v_exp_f32 v66, v66
    v_cvt_pk_bf16_f32 v74, v64, v65
    v_exp_f32 v67, v67
    v_exp_f32 v36, v36
    v_cvt_pk_bf16_f32 v75, v66, v67
    v_mfma_f32_32x32x8_bf16 v[52:67], v[122:123], v[32:33], 0
    v_exp_f32 v37, v37
    v_exp_f32 v38, v38
    v_cvt_pk_bf16_f32 v68, v36, v37
    v_exp_f32 v39, v39
    v_exp_f32 v40, v40
    v_cvt_pk_bf16_f32 v69, v38, v39
    v_mfma_f32_32x32x16_bf16 v[52:67], a[28:31], v[28:31], v[52:67]
    buffer_load_dwordx4 a[44:47], v2, s[12:15], s30 offen offset:1536 sc1
    buffer_load_dwordx2 v[130:131], v3, s[12:15], s31 offen offset:1536 sc1
    v_exp_f32 v41, v41
    v_exp_f32 v42, v42
    v_cvt_pk_bf16_f32 v70, v40, v41
    v_exp_f32 v43, v43
    v_exp_f32 v44, v44
    v_mfma_f32_32x32x16_bf16 v[76:91], a[116:119], v[72:75], v[76:91]
    v_cvt_pk_bf16_f32 v71, v42, v43
    v_exp_f32 v45, v45
    v_exp_f32 v46, v46
    v_cvt_pk_bf16_f32 v72, v44, v45
    v_exp_f32 v47, v47
    v_exp_f32 v48, v48
    s_waitcnt vmcnt(14)
    v_mfma_f32_32x32x16_bf16 v[212:227], a[120:123], v[68:71], v[212:227]
    v_cvt_pk_bf16_f32 v73, v46, v47
    v_exp_f32 v49, v49
    v_exp_f32 v50, v50
    v_cvt_pk_bf16_f32 v74, v48, v49
    v_exp_f32 v51, v51
    s_waitcnt vmcnt(12)
    v_cndmask_b32 v125, v125, v17, s[66:67]
    v_exp_f32 v52, v52
    v_cvt_pk_bf16_f32 v75, v50, v51
    v_mfma_f32_32x32x8_bf16 v[36:51], v[124:125], v[208:209], 0
    v_exp_f32 v53, v53
    v_exp_f32 v54, v54
    v_cvt_pk_bf16_f32 v68, v52, v53
    v_exp_f32 v55, v55
    v_exp_f32 v56, v56
    v_cvt_pk_bf16_f32 v69, v54, v55
    v_mfma_f32_32x32x16_bf16 v[36:51], a[32:35], v[204:207], v[36:51]
    buffer_load_dwordx4 a[152:155], v4, s[12:15], s32 offen sc1
    buffer_load_dwordx4 a[156:159], v12, s[12:15], s32 offen sc1
    s_add_u32 s32, s32, 37376
    v_exp_f32 v57, v57
    v_exp_f32 v58, v58
    v_cvt_pk_bf16_f32 v70, v56, v57
    v_exp_f32 v59, v59
    v_exp_f32 v60, v60
    v_mfma_f32_32x32x16_bf16 v[212:227], a[124:127], v[72:75], v[212:227]
    v_cvt_pk_bf16_f32 v71, v58, v59
    v_exp_f32 v61, v61
    v_exp_f32 v62, v62
    v_cvt_pk_bf16_f32 v72, v60, v61
    v_exp_f32 v63, v63
    v_exp_f32 v64, v64
    v_mfma_f32_32x32x16_bf16 v[76:91], a[120:123], v[68:71], v[76:91]
    v_cvt_pk_bf16_f32 v73, v62, v63
    v_exp_f32 v65, v65
    v_exp_f32 v66, v66
    v_cvt_pk_bf16_f32 v74, v64, v65
    v_exp_f32 v67, v67
    v_exp_f32 v36, v36
    v_cvt_pk_bf16_f32 v75, v66, v67
    v_mfma_f32_32x32x8_bf16 v[52:67], v[124:125], v[32:33], 0
    v_exp_f32 v37, v37
    v_exp_f32 v38, v38
    v_cvt_pk_bf16_f32 v68, v36, v37
    v_exp_f32 v39, v39
    v_exp_f32 v40, v40
    v_cvt_pk_bf16_f32 v69, v38, v39
    v_mfma_f32_32x32x16_bf16 v[52:67], a[32:35], v[28:31], v[52:67]
    buffer_load_dwordx4 a[48:51], v2, s[12:15], s30 offen offset:2048 sc1
    buffer_load_dwordx2 v[132:133], v3, s[12:15], s31 offen offset:2048 sc1
    v_exp_f32 v41, v41
    v_exp_f32 v42, v42
    v_cvt_pk_bf16_f32 v70, v40, v41
    v_exp_f32 v43, v43
    v_exp_f32 v44, v44
    v_mfma_f32_32x32x16_bf16 v[76:91], a[124:127], v[72:75], v[76:91]
    v_cvt_pk_bf16_f32 v71, v42, v43
    v_exp_f32 v45, v45
    v_exp_f32 v46, v46
    v_cvt_pk_bf16_f32 v72, v44, v45
    v_exp_f32 v47, v47
    v_exp_f32 v48, v48
    s_waitcnt vmcnt(14)
    v_mfma_f32_32x32x16_bf16 v[212:227], a[128:131], v[68:71], v[212:227]
    v_cvt_pk_bf16_f32 v73, v46, v47
    v_exp_f32 v49, v49
    v_exp_f32 v50, v50
    v_cvt_pk_bf16_f32 v74, v48, v49
    v_exp_f32 v51, v51
    s_waitcnt vmcnt(12)
    v_cndmask_b32 v127, v127, v17, s[66:67]
    v_exp_f32 v52, v52
    v_cvt_pk_bf16_f32 v75, v50, v51
    v_mfma_f32_32x32x8_bf16 v[36:51], v[126:127], v[208:209], 0
    v_exp_f32 v53, v53
    v_exp_f32 v54, v54
    v_cvt_pk_bf16_f32 v68, v52, v53
    v_exp_f32 v55, v55
    v_exp_f32 v56, v56
    v_cvt_pk_bf16_f32 v69, v54, v55
    v_mfma_f32_32x32x16_bf16 v[36:51], a[36:39], v[204:207], v[36:51]
    buffer_load_dwordx4 a[160:163], v4, s[12:15], s32 offen sc1
    buffer_load_dwordx4 a[164:167], v12, s[12:15], s32 offen sc1
    s_add_u32 s32, s32, 37376
    v_exp_f32 v57, v57
    v_exp_f32 v58, v58
    v_cvt_pk_bf16_f32 v70, v56, v57
    v_exp_f32 v59, v59
    v_exp_f32 v60, v60
    v_mfma_f32_32x32x16_bf16 v[212:227], a[132:135], v[72:75], v[212:227]
    v_cvt_pk_bf16_f32 v71, v58, v59
    v_exp_f32 v61, v61
    v_exp_f32 v62, v62
    v_cvt_pk_bf16_f32 v72, v60, v61
    v_exp_f32 v63, v63
    v_exp_f32 v64, v64
    v_mfma_f32_32x32x16_bf16 v[76:91], a[128:131], v[68:71], v[76:91]
    v_cvt_pk_bf16_f32 v73, v62, v63
    v_exp_f32 v65, v65
    v_exp_f32 v66, v66
    v_cvt_pk_bf16_f32 v74, v64, v65
    v_exp_f32 v67, v67
    v_exp_f32 v36, v36
    v_cvt_pk_bf16_f32 v75, v66, v67
    v_mfma_f32_32x32x8_bf16 v[52:67], v[126:127], v[32:33], 0
    v_exp_f32 v37, v37
    v_exp_f32 v38, v38
    v_cvt_pk_bf16_f32 v68, v36, v37
    v_exp_f32 v39, v39
    v_exp_f32 v40, v40
    v_cvt_pk_bf16_f32 v69, v38, v39
    v_mfma_f32_32x32x16_bf16 v[52:67], a[36:39], v[28:31], v[52:67]
    buffer_load_dwordx4 a[52:55], v2, s[12:15], s30 offen offset:2560 sc1
    buffer_load_dwordx2 v[134:135], v3, s[12:15], s31 offen offset:2560 sc1
    v_exp_f32 v41, v41
    v_exp_f32 v42, v42
    v_cvt_pk_bf16_f32 v70, v40, v41
    v_exp_f32 v43, v43
    v_exp_f32 v44, v44
    v_mfma_f32_32x32x16_bf16 v[76:91], a[132:135], v[72:75], v[76:91]
    v_cvt_pk_bf16_f32 v71, v42, v43
    v_exp_f32 v45, v45
    v_exp_f32 v46, v46
    v_cvt_pk_bf16_f32 v72, v44, v45
    v_exp_f32 v47, v47
    v_exp_f32 v48, v48
    s_waitcnt vmcnt(14)
    v_mfma_f32_32x32x16_bf16 v[212:227], a[136:139], v[68:71], v[212:227]
    v_cvt_pk_bf16_f32 v73, v46, v47
    v_exp_f32 v49, v49
    v_exp_f32 v50, v50
    v_cvt_pk_bf16_f32 v74, v48, v49
    v_exp_f32 v51, v51
    s_waitcnt vmcnt(12)
    v_cndmask_b32 v129, v129, v17, s[66:67]
    v_exp_f32 v52, v52
    v_cvt_pk_bf16_f32 v75, v50, v51
    v_mfma_f32_32x32x8_bf16 v[36:51], v[128:129], v[208:209], 0
    v_exp_f32 v53, v53
    v_exp_f32 v54, v54
    v_cvt_pk_bf16_f32 v68, v52, v53
    v_exp_f32 v55, v55
    v_exp_f32 v56, v56
    v_cvt_pk_bf16_f32 v69, v54, v55
    v_mfma_f32_32x32x16_bf16 v[36:51], a[40:43], v[204:207], v[36:51]
    buffer_load_dwordx4 a[168:171], v4, s[12:15], s32 offen sc1
    buffer_load_dwordx4 a[172:175], v12, s[12:15], s32 offen sc1
    s_add_u32 s32, s32, 37376
    v_exp_f32 v57, v57
    v_exp_f32 v58, v58
    v_cvt_pk_bf16_f32 v70, v56, v57
    v_exp_f32 v59, v59
    v_exp_f32 v60, v60
    v_mfma_f32_32x32x16_bf16 v[212:227], a[140:143], v[72:75], v[212:227]
    v_cvt_pk_bf16_f32 v71, v58, v59
    v_exp_f32 v61, v61
    v_exp_f32 v62, v62
    v_cvt_pk_bf16_f32 v72, v60, v61
    v_exp_f32 v63, v63
    v_exp_f32 v64, v64
    v_mfma_f32_32x32x16_bf16 v[76:91], a[136:139], v[68:71], v[76:91]
    v_cvt_pk_bf16_f32 v73, v62, v63
    v_exp_f32 v65, v65
    v_exp_f32 v66, v66
    v_cvt_pk_bf16_f32 v74, v64, v65
    v_exp_f32 v67, v67
    v_exp_f32 v36, v36
    v_cvt_pk_bf16_f32 v75, v66, v67
    v_mfma_f32_32x32x8_bf16 v[52:67], v[128:129], v[32:33], 0
    v_exp_f32 v37, v37
    v_exp_f32 v38, v38
    v_cvt_pk_bf16_f32 v68, v36, v37
    v_exp_f32 v39, v39
    v_exp_f32 v40, v40
    v_cvt_pk_bf16_f32 v69, v38, v39
    v_mfma_f32_32x32x16_bf16 v[52:67], a[40:43], v[28:31], v[52:67]
    buffer_load_dwordx4 a[56:59], v2, s[12:15], s30 offen offset:3072 sc1
    buffer_load_dwordx2 v[136:137], v3, s[12:15], s31 offen offset:3072 sc1
    v_exp_f32 v41, v41
    v_exp_f32 v42, v42
    v_cvt_pk_bf16_f32 v70, v40, v41
    v_exp_f32 v43, v43
    v_exp_f32 v44, v44
    v_mfma_f32_32x32x16_bf16 v[76:91], a[140:143], v[72:75], v[76:91]
    v_cvt_pk_bf16_f32 v71, v42, v43
    v_exp_f32 v45, v45
    v_exp_f32 v46, v46
    v_cvt_pk_bf16_f32 v72, v44, v45
    v_exp_f32 v47, v47
    v_exp_f32 v48, v48
    s_waitcnt vmcnt(14)
    v_mfma_f32_32x32x16_bf16 v[212:227], a[144:147], v[68:71], v[212:227]
    v_cvt_pk_bf16_f32 v73, v46, v47
    v_exp_f32 v49, v49
    v_exp_f32 v50, v50
    v_cvt_pk_bf16_f32 v74, v48, v49
    v_exp_f32 v51, v51
    s_waitcnt vmcnt(12)
    v_cndmask_b32 v131, v131, v17, s[66:67]
    v_exp_f32 v52, v52
    v_cvt_pk_bf16_f32 v75, v50, v51
    v_mfma_f32_32x32x8_bf16 v[36:51], v[130:131], v[208:209], 0
    v_exp_f32 v53, v53
    v_exp_f32 v54, v54
    v_cvt_pk_bf16_f32 v68, v52, v53
    v_exp_f32 v55, v55
    v_exp_f32 v56, v56
    v_cvt_pk_bf16_f32 v69, v54, v55
    v_mfma_f32_32x32x16_bf16 v[36:51], a[44:47], v[204:207], v[36:51]
    buffer_load_dwordx4 a[176:179], v4, s[12:15], s32 offen sc1
    buffer_load_dwordx4 a[180:183], v12, s[12:15], s32 offen sc1
    s_add_u32 s32, s32, 37376
    v_exp_f32 v57, v57
    v_exp_f32 v58, v58
    v_cvt_pk_bf16_f32 v70, v56, v57
    v_exp_f32 v59, v59
    v_exp_f32 v60, v60
    v_mfma_f32_32x32x16_bf16 v[212:227], a[148:151], v[72:75], v[212:227]
    v_cvt_pk_bf16_f32 v71, v58, v59
    v_exp_f32 v61, v61
    v_exp_f32 v62, v62
    v_cvt_pk_bf16_f32 v72, v60, v61
    v_exp_f32 v63, v63
    v_exp_f32 v64, v64
    v_mfma_f32_32x32x16_bf16 v[76:91], a[144:147], v[68:71], v[76:91]
    v_cvt_pk_bf16_f32 v73, v62, v63
    v_exp_f32 v65, v65
    v_exp_f32 v66, v66
    v_cvt_pk_bf16_f32 v74, v64, v65
    v_exp_f32 v67, v67
    v_exp_f32 v36, v36
    v_cvt_pk_bf16_f32 v75, v66, v67
    v_mfma_f32_32x32x8_bf16 v[52:67], v[130:131], v[32:33], 0
    v_exp_f32 v37, v37
    v_exp_f32 v38, v38
    v_cvt_pk_bf16_f32 v68, v36, v37
    v_exp_f32 v39, v39
    v_exp_f32 v40, v40
    v_cvt_pk_bf16_f32 v69, v38, v39
    v_mfma_f32_32x32x16_bf16 v[52:67], a[44:47], v[28:31], v[52:67]
    buffer_load_dwordx4 a[60:63], v2, s[12:15], s30 offen offset:3584 sc1
    buffer_load_dwordx2 v[138:139], v3, s[12:15], s31 offen offset:3584 sc1
    v_exp_f32 v41, v41
    v_exp_f32 v42, v42
    v_cvt_pk_bf16_f32 v70, v40, v41
    v_exp_f32 v43, v43
    v_exp_f32 v44, v44
    v_mfma_f32_32x32x16_bf16 v[76:91], a[148:151], v[72:75], v[76:91]
    v_cvt_pk_bf16_f32 v71, v42, v43
    v_exp_f32 v45, v45
    v_exp_f32 v46, v46
    v_cvt_pk_bf16_f32 v72, v44, v45
    v_exp_f32 v47, v47
    v_exp_f32 v48, v48
    s_waitcnt vmcnt(14)
    v_mfma_f32_32x32x16_bf16 v[212:227], a[152:155], v[68:71], v[212:227]
    v_cvt_pk_bf16_f32 v73, v46, v47
    v_exp_f32 v49, v49
    v_exp_f32 v50, v50
    v_cvt_pk_bf16_f32 v74, v48, v49
    v_exp_f32 v51, v51
    s_waitcnt vmcnt(12)
    v_cndmask_b32 v133, v133, v17, s[66:67]
    v_exp_f32 v52, v52
    v_cvt_pk_bf16_f32 v75, v50, v51
    v_mfma_f32_32x32x8_bf16 v[36:51], v[132:133], v[208:209], 0
    v_exp_f32 v53, v53
    v_exp_f32 v54, v54
    v_cvt_pk_bf16_f32 v68, v52, v53
    v_exp_f32 v55, v55
    v_exp_f32 v56, v56
    v_cvt_pk_bf16_f32 v69, v54, v55
    v_mfma_f32_32x32x16_bf16 v[36:51], a[48:51], v[204:207], v[36:51]
    buffer_load_dwordx4 a[184:187], v4, s[12:15], s32 offen sc1
    buffer_load_dwordx4 a[188:191], v12, s[12:15], s32 offen sc1
    s_add_u32 s32, s32, 37376
    v_exp_f32 v57, v57
    v_exp_f32 v58, v58
    v_cvt_pk_bf16_f32 v70, v56, v57
    v_exp_f32 v59, v59
    v_exp_f32 v60, v60
    v_mfma_f32_32x32x16_bf16 v[212:227], a[156:159], v[72:75], v[212:227]
    v_cvt_pk_bf16_f32 v71, v58, v59
    v_exp_f32 v61, v61
    v_exp_f32 v62, v62
    v_cvt_pk_bf16_f32 v72, v60, v61
    v_exp_f32 v63, v63
    v_exp_f32 v64, v64
    v_mfma_f32_32x32x16_bf16 v[76:91], a[152:155], v[68:71], v[76:91]
    v_cvt_pk_bf16_f32 v73, v62, v63
    v_exp_f32 v65, v65
    v_exp_f32 v66, v66
    v_cvt_pk_bf16_f32 v74, v64, v65
    v_exp_f32 v67, v67
    v_exp_f32 v36, v36
    v_cvt_pk_bf16_f32 v75, v66, v67
    v_mfma_f32_32x32x8_bf16 v[52:67], v[132:133], v[32:33], 0
    v_exp_f32 v37, v37
    v_exp_f32 v38, v38
    v_cvt_pk_bf16_f32 v68, v36, v37
    v_exp_f32 v39, v39
    v_exp_f32 v40, v40
    v_cvt_pk_bf16_f32 v69, v38, v39
    v_mfma_f32_32x32x16_bf16 v[52:67], a[48:51], v[28:31], v[52:67]
    v_exp_f32 v41, v41
    v_exp_f32 v42, v42
    v_cvt_pk_bf16_f32 v70, v40, v41
    v_exp_f32 v43, v43
    v_exp_f32 v44, v44
    v_mfma_f32_32x32x16_bf16 v[76:91], a[156:159], v[72:75], v[76:91]
    v_cvt_pk_bf16_f32 v71, v42, v43
    v_exp_f32 v45, v45
    v_exp_f32 v46, v46
    v_cvt_pk_bf16_f32 v72, v44, v45
    v_exp_f32 v47, v47
    v_exp_f32 v48, v48
    s_waitcnt vmcnt(12)
    v_mfma_f32_32x32x16_bf16 v[212:227], a[160:163], v[68:71], v[212:227]
    v_cvt_pk_bf16_f32 v73, v46, v47
    v_exp_f32 v49, v49
    v_exp_f32 v50, v50
    v_cvt_pk_bf16_f32 v74, v48, v49
    v_exp_f32 v51, v51
    s_waitcnt vmcnt(10)
    v_cndmask_b32 v135, v135, v17, s[66:67]
    v_exp_f32 v52, v52
    v_cvt_pk_bf16_f32 v75, v50, v51
    v_mfma_f32_32x32x8_bf16 v[36:51], v[134:135], v[208:209], 0
    v_exp_f32 v53, v53
    v_exp_f32 v54, v54
    v_cvt_pk_bf16_f32 v68, v52, v53
    v_exp_f32 v55, v55
    v_exp_f32 v56, v56
    v_cvt_pk_bf16_f32 v69, v54, v55
    v_mfma_f32_32x32x16_bf16 v[36:51], a[52:55], v[204:207], v[36:51]
    v_exp_f32 v57, v57
    v_exp_f32 v58, v58
    v_cvt_pk_bf16_f32 v70, v56, v57
    v_exp_f32 v59, v59
    v_exp_f32 v60, v60
    v_mfma_f32_32x32x16_bf16 v[212:227], a[164:167], v[72:75], v[212:227]
    v_cvt_pk_bf16_f32 v71, v58, v59
    v_exp_f32 v61, v61
    v_exp_f32 v62, v62
    v_cvt_pk_bf16_f32 v72, v60, v61
    v_exp_f32 v63, v63
    v_exp_f32 v64, v64
    v_mfma_f32_32x32x16_bf16 v[76:91], a[160:163], v[68:71], v[76:91]
    v_cvt_pk_bf16_f32 v73, v62, v63
    v_exp_f32 v65, v65
    v_exp_f32 v66, v66
    v_cvt_pk_bf16_f32 v74, v64, v65
    v_exp_f32 v67, v67
    v_exp_f32 v36, v36
    v_cvt_pk_bf16_f32 v75, v66, v67
    v_mfma_f32_32x32x8_bf16 v[52:67], v[134:135], v[32:33], 0
    v_exp_f32 v37, v37
    v_exp_f32 v38, v38
    v_cvt_pk_bf16_f32 v68, v36, v37
    v_exp_f32 v39, v39
    v_exp_f32 v40, v40
    v_cvt_pk_bf16_f32 v69, v38, v39
    v_mfma_f32_32x32x16_bf16 v[52:67], a[52:55], v[28:31], v[52:67]
    v_exp_f32 v41, v41
    v_exp_f32 v42, v42
    v_cvt_pk_bf16_f32 v70, v40, v41
    v_exp_f32 v43, v43
    v_exp_f32 v44, v44
    v_mfma_f32_32x32x16_bf16 v[76:91], a[164:167], v[72:75], v[76:91]
    v_cvt_pk_bf16_f32 v71, v42, v43
    v_exp_f32 v45, v45
    v_exp_f32 v46, v46
    v_cvt_pk_bf16_f32 v72, v44, v45
    v_exp_f32 v47, v47
    v_exp_f32 v48, v48
    s_waitcnt vmcnt(8)
    s_add_u32 m0, s41, 0
    v_mfma_f32_32x32x16_bf16 v[212:227], a[168:171], v[68:71], v[212:227]
    buffer_load_dwordx4 v6, s[16:19], s36 offen offset:0 lds
    buffer_load_dwordx4 v7, s[16:19], s36 offen offset:1024 lds
    v_cvt_pk_bf16_f32 v73, v46, v47
    v_exp_f32 v49, v49
    v_exp_f32 v50, v50
    v_cvt_pk_bf16_f32 v74, v48, v49
    v_exp_f32 v51, v51
    s_waitcnt vmcnt(8)
    v_cndmask_b32 v137, v137, v17, s[66:67]
    v_exp_f32 v52, v52
    v_cvt_pk_bf16_f32 v75, v50, v51
    v_mfma_f32_32x32x8_bf16 v[36:51], v[136:137], v[208:209], 0
    v_exp_f32 v53, v53
    v_exp_f32 v54, v54
    v_cvt_pk_bf16_f32 v68, v52, v53
    v_exp_f32 v55, v55
    v_exp_f32 v56, v56
    v_cvt_pk_bf16_f32 v69, v54, v55
    v_mfma_f32_32x32x16_bf16 v[36:51], a[56:59], v[204:207], v[36:51]
    v_exp_f32 v57, v57
    v_exp_f32 v58, v58
    v_cvt_pk_bf16_f32 v70, v56, v57
    v_exp_f32 v59, v59
    v_exp_f32 v60, v60
    v_mfma_f32_32x32x16_bf16 v[212:227], a[172:175], v[72:75], v[212:227]
    v_cvt_pk_bf16_f32 v71, v58, v59
    v_exp_f32 v61, v61
    v_exp_f32 v62, v62
    v_cvt_pk_bf16_f32 v72, v60, v61
    v_exp_f32 v63, v63
    v_exp_f32 v64, v64
    v_mfma_f32_32x32x16_bf16 v[76:91], a[168:171], v[68:71], v[76:91]
    buffer_load_dwordx2 v[228:229], v247, s[56:59], s49 offen offset:0
    v_cvt_pk_bf16_f32 v73, v62, v63
    v_exp_f32 v65, v65
    v_exp_f32 v66, v66
    v_cvt_pk_bf16_f32 v74, v64, v65
    v_exp_f32 v67, v67
    v_exp_f32 v36, v36
    v_cvt_pk_bf16_f32 v75, v66, v67
    v_mfma_f32_32x32x8_bf16 v[52:67], v[136:137], v[32:33], 0
    v_exp_f32 v37, v37
    v_exp_f32 v38, v38
    v_cvt_pk_bf16_f32 v68, v36, v37
    v_exp_f32 v39, v39
    v_exp_f32 v40, v40
    v_cvt_pk_bf16_f32 v69, v38, v39
    v_mfma_f32_32x32x16_bf16 v[52:67], a[56:59], v[28:31], v[52:67]
    v_exp_f32 v41, v41
    v_exp_f32 v42, v42
    v_cvt_pk_bf16_f32 v70, v40, v41
    v_exp_f32 v43, v43
    v_exp_f32 v44, v44
    v_mfma_f32_32x32x16_bf16 v[76:91], a[172:175], v[72:75], v[76:91]
    v_cvt_pk_bf16_f32 v71, v42, v43
    v_exp_f32 v45, v45
    v_exp_f32 v46, v46
    v_cvt_pk_bf16_f32 v72, v44, v45
    v_exp_f32 v47, v47
    v_exp_f32 v48, v48
    s_waitcnt vmcnt(7)
    v_mfma_f32_32x32x16_bf16 v[212:227], a[176:179], v[68:71], v[212:227]
    buffer_load_dwordx2 v[230:231], v247, s[56:59], s49 offen offset:32
    buffer_load_dwordx2 v[232:233], v247, s[56:59], s49 offen offset:64
    v_cvt_pk_bf16_f32 v73, v46, v47
    v_exp_f32 v49, v49
    v_exp_f32 v50, v50
    v_cvt_pk_bf16_f32 v74, v48, v49
    v_exp_f32 v51, v51
    s_waitcnt vmcnt(7)
    v_cndmask_b32 v139, v139, v17, s[66:67]
    v_exp_f32 v52, v52
    v_cvt_pk_bf16_f32 v75, v50, v51
    v_mfma_f32_32x32x8_bf16 v[36:51], v[138:139], v[208:209], 0
    v_exp_f32 v53, v53
    v_exp_f32 v54, v54
    v_cvt_pk_bf16_f32 v68, v52, v53
    v_exp_f32 v55, v55
    v_exp_f32 v56, v56
    v_cvt_pk_bf16_f32 v69, v54, v55
    v_mfma_f32_32x32x16_bf16 v[36:51], a[60:63], v[204:207], v[36:51]
    v_exp_f32 v57, v57
    v_exp_f32 v58, v58
    v_cvt_pk_bf16_f32 v70, v56, v57
    v_exp_f32 v59, v59
    v_exp_f32 v60, v60
    v_mfma_f32_32x32x16_bf16 v[212:227], a[180:183], v[72:75], v[212:227]
    v_cvt_pk_bf16_f32 v71, v58, v59
    v_exp_f32 v61, v61
    v_exp_f32 v62, v62
    v_cvt_pk_bf16_f32 v72, v60, v61
    v_exp_f32 v63, v63
    v_exp_f32 v64, v64
    v_mfma_f32_32x32x16_bf16 v[76:91], a[176:179], v[68:71], v[76:91]
    v_cvt_pk_bf16_f32 v73, v62, v63
    v_exp_f32 v65, v65
    v_exp_f32 v66, v66
    v_cvt_pk_bf16_f32 v74, v64, v65
    v_exp_f32 v67, v67
    v_exp_f32 v36, v36
    v_cvt_pk_bf16_f32 v75, v66, v67
    v_mfma_f32_32x32x8_bf16 v[52:67], v[138:139], v[32:33], 0
    v_exp_f32 v37, v37
    v_exp_f32 v38, v38
    v_cvt_pk_bf16_f32 v68, v36, v37
    v_exp_f32 v39, v39
    v_exp_f32 v40, v40
    v_cvt_pk_bf16_f32 v69, v38, v39
    v_mfma_f32_32x32x16_bf16 v[52:67], a[60:63], v[28:31], v[52:67]
    v_exp_f32 v41, v41
    v_exp_f32 v42, v42
    v_cvt_pk_bf16_f32 v70, v40, v41
    v_exp_f32 v43, v43
    v_exp_f32 v44, v44
    v_mfma_f32_32x32x16_bf16 v[76:91], a[180:183], v[72:75], v[76:91]
    v_cvt_pk_bf16_f32 v71, v42, v43
    v_exp_f32 v45, v45
    v_exp_f32 v46, v46
    v_cvt_pk_bf16_f32 v72, v44, v45
    v_exp_f32 v47, v47
    v_exp_f32 v48, v48
    s_waitcnt vmcnt(5)
    s_add_u32 m0, s41, 2048
    v_mfma_f32_32x32x16_bf16 v[212:227], a[184:187], v[68:71], v[212:227]
    buffer_load_dwordx4 v6, s[20:23], s37 offen offset:0 lds
    buffer_load_dwordx4 v7, s[20:23], s37 offen offset:1024 lds
    s_add_u32 s36, s36, s38
    s_add_u32 s37, s37, s38
    s_add_u32 s41, s41, 4096
    v_cvt_pk_bf16_f32 v73, v46, v47
    v_exp_f32 v49, v49
    v_exp_f32 v50, v50
    v_cvt_pk_bf16_f32 v74, v48, v49
    v_exp_f32 v51, v51
    v_exp_f32 v52, v52
    v_cvt_pk_bf16_f32 v75, v50, v51
    s_waitcnt lgkmcnt(0)
    v_mfma_f32_32x32x8_bf16 v[36:51], v[108:109], v[24:25], 0
    v_exp_f32 v53, v53
    v_exp_f32 v54, v54
    v_cvt_pk_bf16_f32 v68, v52, v53
    v_exp_f32 v55, v55
    v_exp_f32 v56, v56
    v_cvt_pk_bf16_f32 v69, v54, v55
    v_mfma_f32_32x32x16_bf16 v[36:51], a[0:3], v[20:23], v[36:51]
    ds_read_b128 v[28:31], v9 offset:1536
    ds_read_b64 v[32:33], v10 offset:2560
    v_exp_f32 v57, v57
    v_exp_f32 v58, v58
    v_cvt_pk_bf16_f32 v70, v56, v57
    v_exp_f32 v59, v59
    v_exp_f32 v60, v60
    v_mfma_f32_32x32x16_bf16 v[212:227], a[188:191], v[72:75], v[212:227]
    v_cvt_pk_bf16_f32 v71, v58, v59
    v_exp_f32 v61, v61
    v_add_u32 v9, 1536, v9
    v_add_u32 v10, 1536, v10
    v_exp_f32 v62, v62
    v_cvt_pk_bf16_f32 v72, v60, v61
    v_exp_f32 v63, v63
    v_exp_f32 v64, v64
    v_mfma_f32_32x32x16_bf16 v[76:91], a[184:187], v[68:71], v[76:91]
    buffer_load_dwordx2 v[234:235], v247, s[56:59], s49 offen offset:96
    buffer_load_dwordx2 v[236:237], v247, s[56:59], s49 offen offset:128
    v_cvt_pk_bf16_f32 v73, v62, v63
    v_exp_f32 v65, v65
    v_exp_f32 v66, v66
    v_cvt_pk_bf16_f32 v74, v64, v65
    v_exp_f32 v67, v67
    ds_write_b128 v11, v[212:215] offset:0
    ds_write_b128 v11, v[216:219] offset:1024
    s_mov_b32 exec_hi, 0
    ds_write_b128 v11, v[220:223] offset:2048
    s_mov_b32 exec_hi, -1
    v_add_u32 v11, 2560, v11
    s_mov_b32 s33, 3
Lloop23:
    v_exp_f32 v36, v36
    v_cvt_pk_bf16_f32 v75, v66, v67
    s_waitcnt lgkmcnt(0)
    v_mfma_f32_32x32x8_bf16 v[52:67], v[110:111], v[32:33], 0
    v_exp_f32 v37, v37
    v_exp_f32 v38, v38
    v_cvt_pk_bf16_f32 v68, v36, v37
    v_exp_f32 v39, v39
    v_exp_f32 v40, v40
    v_cvt_pk_bf16_f32 v69, v38, v39
    v_mfma_f32_32x32x16_bf16 v[52:67], a[4:7], v[28:31], v[52:67]
    v_exp_f32 v41, v41
    v_exp_f32 v42, v42
    v_cvt_pk_bf16_f32 v70, v40, v41
    v_exp_f32 v43, v43
    v_exp_f32 v44, v44
    v_mfma_f32_32x32x16_bf16 v[76:91], a[188:191], v[72:75], v[76:91]
    v_cvt_pk_bf16_f32 v71, v42, v43
    v_exp_f32 v45, v45
    v_exp_f32 v46, v46
    v_cvt_pk_bf16_f32 v72, v44, v45
    v_exp_f32 v47, v47
    v_exp_f32 v48, v48
    v_mfma_f32_32x32x16_bf16 v[92:107], a[64:67], v[68:71], 0
    v_cvt_pk_bf16_f32 v73, v46, v47
    v_exp_f32 v49, v49
    v_exp_f32 v50, v50
    v_cvt_pk_bf16_f32 v74, v48, v49
    v_exp_f32 v51, v51
    v_exp_f32 v52, v52
    v_cvt_pk_bf16_f32 v75, v50, v51
    v_mfma_f32_32x32x8_bf16 v[36:51], v[112:113], v[32:33], 0
    ds_write_b128 v11, v[76:79] offset:0
    v_exp_f32 v53, v53
    v_exp_f32 v54, v54
    v_cvt_pk_bf16_f32 v68, v52, v53
    v_exp_f32 v55, v55
    v_exp_f32 v56, v56
    v_cvt_pk_bf16_f32 v69, v54, v55
    v_mfma_f32_32x32x16_bf16 v[36:51], a[8:11], v[28:31], v[36:51]
    ds_write_b128 v11, v[80:83] offset:1024
    v_exp_f32 v57, v57
    v_exp_f32 v58, v58
    v_cvt_pk_bf16_f32 v70, v56, v57
    v_exp_f32 v59, v59
    v_exp_f32 v60, v60
    v_mfma_f32_32x32x16_bf16 v[92:107], a[68:71], v[72:75], v[92:107]
    s_mov_b32 exec_hi, 0
    ds_write_b128 v11, v[84:87] offset:2048
    s_mov_b32 exec_hi, -1
    v_cvt_pk_bf16_f32 v71, v58, v59
    v_exp_f32 v61, v61
    v_add_u32 v11, 2560, v11
    v_exp_f32 v62, v62
    v_cvt_pk_bf16_f32 v72, v60, v61
    v_exp_f32 v63, v63
    v_exp_f32 v64, v64
    s_waitcnt lgkmcnt(0)
    v_mfma_f32_32x32x16_bf16 v[76:91], a[72:75], v[68:71], v[92:107]
    v_cvt_pk_bf16_f32 v73, v62, v63
    v_exp_f32 v65, v65
    v_exp_f32 v66, v66
    v_cvt_pk_bf16_f32 v74, v64, v65
    v_exp_f32 v67, v67
    v_exp_f32 v36, v36
    v_cvt_pk_bf16_f32 v75, v66, v67
    v_mfma_f32_32x32x8_bf16 v[52:67], v[114:115], v[32:33], 0
    v_exp_f32 v37, v37
    v_exp_f32 v38, v38
    v_cvt_pk_bf16_f32 v68, v36, v37
    v_exp_f32 v39, v39
    v_exp_f32 v40, v40
    v_cvt_pk_bf16_f32 v69, v38, v39
    v_mfma_f32_32x32x16_bf16 v[52:67], a[12:15], v[28:31], v[52:67]
    v_exp_f32 v41, v41
    v_exp_f32 v42, v42
    v_cvt_pk_bf16_f32 v70, v40, v41
    v_exp_f32 v43, v43
    v_exp_f32 v44, v44
    v_mfma_f32_32x32x16_bf16 v[76:91], a[76:79], v[72:75], v[76:91]
    v_cvt_pk_bf16_f32 v71, v42, v43
    v_exp_f32 v45, v45
    v_exp_f32 v46, v46
    v_cvt_pk_bf16_f32 v72, v44, v45
    v_exp_f32 v47, v47
    v_exp_f32 v48, v48
    v_mfma_f32_32x32x16_bf16 v[76:91], a[80:83], v[68:71], v[76:91]
    v_cvt_pk_bf16_f32 v73, v46, v47
    v_exp_f32 v49, v49
    v_exp_f32 v50, v50
    v_cvt_pk_bf16_f32 v74, v48, v49
    v_exp_f32 v51, v51
    v_exp_f32 v52, v52
    v_cvt_pk_bf16_f32 v75, v50, v51
    v_mfma_f32_32x32x8_bf16 v[36:51], v[116:117], v[32:33], 0
    v_exp_f32 v53, v53
    v_exp_f32 v54, v54
    v_cvt_pk_bf16_f32 v68, v52, v53
    v_exp_f32 v55, v55
    v_exp_f32 v56, v56
    v_cvt_pk_bf16_f32 v69, v54, v55
    v_mfma_f32_32x32x16_bf16 v[36:51], a[16:19], v[28:31], v[36:51]
    v_exp_f32 v57, v57
    v_exp_f32 v58, v58
    v_cvt_pk_bf16_f32 v70, v56, v57
    v_exp_f32 v59, v59
    v_exp_f32 v60, v60
    v_mfma_f32_32x32x16_bf16 v[76:91], a[84:87], v[72:75], v[76:91]
    ds_read_b128 v[20:23], v9 offset:1536
    ds_read_b64 v[24:25], v10 offset:2560
    v_cvt_pk_bf16_f32 v71, v58, v59
    v_exp_f32 v61, v61
    v_exp_f32 v62, v62
    v_cvt_pk_bf16_f32 v72, v60, v61
    v_exp_f32 v63, v63
    v_exp_f32 v64, v64
    v_mfma_f32_32x32x16_bf16 v[76:91], a[88:91], v[68:71], v[76:91]
    v_cvt_pk_bf16_f32 v73, v62, v63
    v_exp_f32 v65, v65
    v_exp_f32 v66, v66
    v_cvt_pk_bf16_f32 v74, v64, v65
    v_exp_f32 v67, v67
    v_exp_f32 v36, v36
    v_cvt_pk_bf16_f32 v75, v66, v67
    v_mfma_f32_32x32x8_bf16 v[52:67], v[118:119], v[32:33], 0
    v_exp_f32 v37, v37
    v_exp_f32 v38, v38
    v_cvt_pk_bf16_f32 v68, v36, v37
    v_exp_f32 v39, v39
    v_exp_f32 v40, v40
    v_cvt_pk_bf16_f32 v69, v38, v39
    v_mfma_f32_32x32x16_bf16 v[52:67], a[20:23], v[28:31], v[52:67]
    v_exp_f32 v41, v41
    v_exp_f32 v42, v42
    v_cvt_pk_bf16_f32 v70, v40, v41
    v_exp_f32 v43, v43
    v_exp_f32 v44, v44
    s_add_u32 m0, s41, 0
    v_mfma_f32_32x32x16_bf16 v[76:91], a[92:95], v[72:75], v[76:91]
    buffer_load_dwordx4 v6, s[16:19], s36 offen offset:0 lds
    buffer_load_dwordx4 v7, s[16:19], s36 offen offset:1024 lds
    v_cvt_pk_bf16_f32 v71, v42, v43
    v_exp_f32 v45, v45
    v_exp_f32 v46, v46
    v_cvt_pk_bf16_f32 v72, v44, v45
    v_exp_f32 v47, v47
    v_exp_f32 v48, v48
    v_mfma_f32_32x32x16_bf16 v[76:91], a[96:99], v[68:71], v[76:91]
    v_cvt_pk_bf16_f32 v73, v46, v47
    v_exp_f32 v49, v49
    v_exp_f32 v50, v50
    v_cvt_pk_bf16_f32 v74, v48, v49
    v_exp_f32 v51, v51
    v_exp_f32 v52, v52
    v_cvt_pk_bf16_f32 v75, v50, v51
    v_mfma_f32_32x32x8_bf16 v[36:51], v[120:121], v[32:33], 0
    v_exp_f32 v53, v53
    v_exp_f32 v54, v54
    v_cvt_pk_bf16_f32 v68, v52, v53
    v_exp_f32 v55, v55
    v_exp_f32 v56, v56
    v_cvt_pk_bf16_f32 v69, v54, v55
    v_mfma_f32_32x32x16_bf16 v[36:51], a[24:27], v[28:31], v[36:51]
    v_exp_f32 v57, v57
    v_exp_f32 v58, v58
    v_cvt_pk_bf16_f32 v70, v56, v57
    v_exp_f32 v59, v59
    v_exp_f32 v60, v60
    v_mfma_f32_32x32x16_bf16 v[76:91], a[100:103], v[72:75], v[76:91]
    v_cvt_pk_bf16_f32 v71, v58, v59
    v_exp_f32 v61, v61
    v_exp_f32 v62, v62
    v_cvt_pk_bf16_f32 v72, v60, v61
    v_exp_f32 v63, v63
    v_exp_f32 v64, v64
    v_mfma_f32_32x32x16_bf16 v[76:91], a[104:107], v[68:71], v[76:91]
    v_cvt_pk_bf16_f32 v73, v62, v63
    v_exp_f32 v65, v65
    v_exp_f32 v66, v66
    v_cvt_pk_bf16_f32 v74, v64, v65
    v_exp_f32 v67, v67
    v_exp_f32 v36, v36
    v_cvt_pk_bf16_f32 v75, v66, v67
    v_mfma_f32_32x32x8_bf16 v[52:67], v[122:123], v[32:33], 0
    v_exp_f32 v37, v37
    v_exp_f32 v38, v38
    v_cvt_pk_bf16_f32 v68, v36, v37
    v_exp_f32 v39, v39
    v_exp_f32 v40, v40
    v_cvt_pk_bf16_f32 v69, v38, v39
    v_mfma_f32_32x32x16_bf16 v[52:67], a[28:31], v[28:31], v[52:67]
    v_exp_f32 v41, v41
    v_exp_f32 v42, v42
    v_cvt_pk_bf16_f32 v70, v40, v41
    v_exp_f32 v43, v43
    v_exp_f32 v44, v44
    v_mfma_f32_32x32x16_bf16 v[76:91], a[108:111], v[72:75], v[76:91]
    v_cvt_pk_bf16_f32 v71, v42, v43
    v_exp_f32 v45, v45
    buffer_store_dwordx4 v[240:243], v5, s[12:15], s11 offen offset:0 sc1
    v_exp_f32 v46, v46
    v_cvt_pk_bf16_f32 v72, v44, v45
    v_exp_f32 v47, v47
    v_exp_f32 v48, v48
    v_mfma_f32_32x32x16_bf16 v[76:91], a[112:115], v[68:71], v[76:91]
    v_cvt_pk_bf16_f32 v73, v46, v47
    v_exp_f32 v49, v49
    v_exp_f32 v50, v50
    v_cvt_pk_bf16_f32 v74, v48, v49
    v_exp_f32 v51, v51
    v_exp_f32 v52, v52
    v_cvt_pk_bf16_f32 v75, v50, v51
    v_mfma_f32_32x32x8_bf16 v[36:51], v[124:125], v[32:33], 0
    v_exp_f32 v53, v53
    v_exp_f32 v54, v54
    v_cvt_pk_bf16_f32 v68, v52, v53
    v_exp_f32 v55, v55
    v_exp_f32 v56, v56
    v_cvt_pk_bf16_f32 v69, v54, v55
    v_mfma_f32_32x32x16_bf16 v[36:51], a[32:35], v[28:31], v[36:51]
    v_exp_f32 v57, v57
    v_exp_f32 v58, v58
    v_cvt_pk_bf16_f32 v70, v56, v57
    v_exp_f32 v59, v59
    v_exp_f32 v60, v60
    v_mfma_f32_32x32x16_bf16 v[76:91], a[116:119], v[72:75], v[76:91]
    v_cvt_pk_bf16_f32 v71, v58, v59
    v_exp_f32 v61, v61
    v_exp_f32 v62, v62
    v_cvt_pk_bf16_f32 v72, v60, v61
    v_exp_f32 v63, v63
    v_exp_f32 v64, v64
    v_mfma_f32_32x32x16_bf16 v[76:91], a[120:123], v[68:71], v[76:91]
    v_cvt_pk_bf16_f32 v73, v62, v63
    v_exp_f32 v65, v65
    v_exp_f32 v66, v66
    v_cvt_pk_bf16_f32 v74, v64, v65
    v_exp_f32 v67, v67
    v_exp_f32 v36, v36
    v_cvt_pk_bf16_f32 v75, v66, v67
    v_mfma_f32_32x32x8_bf16 v[52:67], v[126:127], v[32:33], 0
    v_exp_f32 v37, v37
    v_exp_f32 v38, v38
    v_cvt_pk_bf16_f32 v68, v36, v37
    v_exp_f32 v39, v39
    v_exp_f32 v40, v40
    v_cvt_pk_bf16_f32 v69, v38, v39
    v_mfma_f32_32x32x16_bf16 v[52:67], a[36:39], v[28:31], v[52:67]
    v_exp_f32 v41, v41
    v_exp_f32 v42, v42
    v_cvt_pk_bf16_f32 v70, v40, v41
    v_exp_f32 v43, v43
    v_exp_f32 v44, v44
    v_mfma_f32_32x32x16_bf16 v[76:91], a[124:127], v[72:75], v[76:91]
    v_cvt_pk_bf16_f32 v71, v42, v43
    v_exp_f32 v45, v45
    buffer_store_dwordx4 v[240:243], v5, s[12:15], s11 offen offset:1024 sc1
    v_exp_f32 v46, v46
    v_cvt_pk_bf16_f32 v72, v44, v45
    v_exp_f32 v47, v47
    v_exp_f32 v48, v48
    v_mfma_f32_32x32x16_bf16 v[76:91], a[128:131], v[68:71], v[76:91]
    v_cvt_pk_bf16_f32 v73, v46, v47
    v_exp_f32 v49, v49
    v_exp_f32 v50, v50
    v_cvt_pk_bf16_f32 v74, v48, v49
    v_exp_f32 v51, v51
    v_exp_f32 v52, v52
    v_cvt_pk_bf16_f32 v75, v50, v51
    v_mfma_f32_32x32x8_bf16 v[36:51], v[128:129], v[32:33], 0
    v_exp_f32 v53, v53
    v_exp_f32 v54, v54
    v_cvt_pk_bf16_f32 v68, v52, v53
    v_exp_f32 v55, v55
    v_exp_f32 v56, v56
    v_cvt_pk_bf16_f32 v69, v54, v55
    v_mfma_f32_32x32x16_bf16 v[36:51], a[40:43], v[28:31], v[36:51]
    v_exp_f32 v57, v57
    v_exp_f32 v58, v58
    v_cvt_pk_bf16_f32 v70, v56, v57
    v_exp_f32 v59, v59
    v_exp_f32 v60, v60
    v_mfma_f32_32x32x16_bf16 v[76:91], a[132:135], v[72:75], v[76:91]
    v_cvt_pk_bf16_f32 v71, v58, v59
    v_exp_f32 v61, v61
    v_exp_f32 v62, v62
    v_cvt_pk_bf16_f32 v72, v60, v61
    v_exp_f32 v63, v63
    v_exp_f32 v64, v64
    v_mfma_f32_32x32x16_bf16 v[76:91], a[136:139], v[68:71], v[76:91]
    v_cvt_pk_bf16_f32 v73, v62, v63
    v_exp_f32 v65, v65
    v_exp_f32 v66, v66
    v_cvt_pk_bf16_f32 v74, v64, v65
    v_exp_f32 v67, v67
    v_exp_f32 v36, v36
    v_cvt_pk_bf16_f32 v75, v66, v67
    v_mfma_f32_32x32x8_bf16 v[52:67], v[130:131], v[32:33], 0
    v_exp_f32 v37, v37
    v_exp_f32 v38, v38
    v_cvt_pk_bf16_f32 v68, v36, v37
    v_exp_f32 v39, v39
    v_exp_f32 v40, v40
    v_cvt_pk_bf16_f32 v69, v38, v39
    v_mfma_f32_32x32x16_bf16 v[52:67], a[44:47], v[28:31], v[52:67]
    v_exp_f32 v41, v41
    v_exp_f32 v42, v42
    v_cvt_pk_bf16_f32 v70, v40, v41
    v_exp_f32 v43, v43
    v_exp_f32 v44, v44
    v_mfma_f32_32x32x16_bf16 v[76:91], a[140:143], v[72:75], v[76:91]
    v_cvt_pk_bf16_f32 v71, v42, v43
    v_exp_f32 v45, v45
    buffer_store_dwordx4 v[240:243], v244, s[12:15], s11 offen offset:2048 sc1
    s_add_u32 s11, s11, 9216
    v_exp_f32 v46, v46
    v_cvt_pk_bf16_f32 v72, v44, v45
    v_exp_f32 v47, v47
    v_exp_f32 v48, v48
    v_mfma_f32_32x32x16_bf16 v[76:91], a[144:147], v[68:71], v[76:91]
    v_cvt_pk_bf16_f32 v73, v46, v47
    v_exp_f32 v49, v49
    v_exp_f32 v50, v50
    v_cvt_pk_bf16_f32 v74, v48, v49
    v_exp_f32 v51, v51
    v_exp_f32 v52, v52
    v_cvt_pk_bf16_f32 v75, v50, v51
    v_mfma_f32_32x32x8_bf16 v[36:51], v[132:133], v[32:33], 0
    v_exp_f32 v53, v53
    v_exp_f32 v54, v54
    v_cvt_pk_bf16_f32 v68, v52, v53
    v_exp_f32 v55, v55
    v_exp_f32 v56, v56
    v_cvt_pk_bf16_f32 v69, v54, v55
    v_mfma_f32_32x32x16_bf16 v[36:51], a[48:51], v[28:31], v[36:51]
    v_exp_f32 v57, v57
    v_exp_f32 v58, v58
    v_cvt_pk_bf16_f32 v70, v56, v57
    v_exp_f32 v59, v59
    v_exp_f32 v60, v60
    v_mfma_f32_32x32x16_bf16 v[76:91], a[148:151], v[72:75], v[76:91]
    v_cvt_pk_bf16_f32 v71, v58, v59
    v_exp_f32 v61, v61
    v_exp_f32 v62, v62
    v_cvt_pk_bf16_f32 v72, v60, v61
    v_exp_f32 v63, v63
    v_exp_f32 v64, v64
    v_mfma_f32_32x32x16_bf16 v[76:91], a[152:155], v[68:71], v[76:91]
    v_cvt_pk_bf16_f32 v73, v62, v63
    v_exp_f32 v65, v65
    v_exp_f32 v66, v66
    v_cvt_pk_bf16_f32 v74, v64, v65
    v_exp_f32 v67, v67
    v_exp_f32 v36, v36
    v_cvt_pk_bf16_f32 v75, v66, v67
    v_mfma_f32_32x32x8_bf16 v[52:67], v[134:135], v[32:33], 0
    v_exp_f32 v37, v37
    v_exp_f32 v38, v38
    v_cvt_pk_bf16_f32 v68, v36, v37
    v_exp_f32 v39, v39
    v_exp_f32 v40, v40
    v_cvt_pk_bf16_f32 v69, v38, v39
    v_mfma_f32_32x32x16_bf16 v[52:67], a[52:55], v[28:31], v[52:67]
    v_exp_f32 v41, v41
    v_exp_f32 v42, v42
    v_cvt_pk_bf16_f32 v70, v40, v41
    v_exp_f32 v43, v43
    v_exp_f32 v44, v44
    s_add_u32 m0, s41, 2048
    v_mfma_f32_32x32x16_bf16 v[76:91], a[156:159], v[72:75], v[76:91]
    buffer_load_dwordx4 v6, s[20:23], s37 offen offset:0 lds
    buffer_load_dwordx4 v7, s[20:23], s37 offen offset:1024 lds
    s_add_u32 s36, s36, s38
    s_add_u32 s37, s37, s38
    s_add_u32 s41, s41, 4096
    v_cvt_pk_bf16_f32 v71, v42, v43
    v_exp_f32 v45, v45
    v_exp_f32 v46, v46
    v_cvt_pk_bf16_f32 v72, v44, v45
    v_exp_f32 v47, v47
    v_exp_f32 v48, v48
    v_mfma_f32_32x32x16_bf16 v[76:91], a[160:163], v[68:71], v[76:91]
    v_cvt_pk_bf16_f32 v73, v46, v47
    v_exp_f32 v49, v49
    v_exp_f32 v50, v50
    v_cvt_pk_bf16_f32 v74, v48, v49
    v_exp_f32 v51, v51
    v_exp_f32 v52, v52
    v_cvt_pk_bf16_f32 v75, v50, v51
    v_mfma_f32_32x32x8_bf16 v[36:51], v[136:137], v[32:33], 0
    v_exp_f32 v53, v53
    v_exp_f32 v54, v54
    v_cvt_pk_bf16_f32 v68, v52, v53
    v_exp_f32 v55, v55
    v_exp_f32 v56, v56
    v_cvt_pk_bf16_f32 v69, v54, v55
    v_mfma_f32_32x32x16_bf16 v[36:51], a[56:59], v[28:31], v[36:51]
    v_exp_f32 v57, v57
    v_exp_f32 v58, v58
    v_cvt_pk_bf16_f32 v70, v56, v57
    v_exp_f32 v59, v59
    v_exp_f32 v60, v60
    v_mfma_f32_32x32x16_bf16 v[76:91], a[164:167], v[72:75], v[76:91]
    v_cvt_pk_bf16_f32 v71, v58, v59
    v_exp_f32 v61, v61
    v_exp_f32 v62, v62
    v_cvt_pk_bf16_f32 v72, v60, v61
    v_exp_f32 v63, v63
    v_exp_f32 v64, v64
    v_mfma_f32_32x32x16_bf16 v[76:91], a[168:171], v[68:71], v[76:91]
    v_cvt_pk_bf16_f32 v73, v62, v63
    v_exp_f32 v65, v65
    v_exp_f32 v66, v66
    v_cvt_pk_bf16_f32 v74, v64, v65
    v_exp_f32 v67, v67
    v_exp_f32 v36, v36
    v_cvt_pk_bf16_f32 v75, v66, v67
    v_mfma_f32_32x32x8_bf16 v[52:67], v[138:139], v[32:33], 0
    v_exp_f32 v37, v37
    v_exp_f32 v38, v38
    v_cvt_pk_bf16_f32 v68, v36, v37
    v_exp_f32 v39, v39
    v_exp_f32 v40, v40
    v_cvt_pk_bf16_f32 v69, v38, v39
    v_mfma_f32_32x32x16_bf16 v[52:67], a[60:63], v[28:31], v[52:67]
    v_exp_f32 v41, v41
    v_exp_f32 v42, v42
    v_cvt_pk_bf16_f32 v70, v40, v41
    v_exp_f32 v43, v43
    v_exp_f32 v44, v44
    v_mfma_f32_32x32x16_bf16 v[76:91], a[172:175], v[72:75], v[76:91]
    v_cvt_pk_bf16_f32 v71, v42, v43
    v_exp_f32 v45, v45
    v_exp_f32 v46, v46
    v_cvt_pk_bf16_f32 v72, v44, v45
    v_exp_f32 v47, v47
    v_exp_f32 v48, v48
    v_mfma_f32_32x32x16_bf16 v[76:91], a[176:179], v[68:71], v[76:91]
    v_cvt_pk_bf16_f32 v73, v46, v47
    v_exp_f32 v49, v49
    v_exp_f32 v50, v50
    v_cvt_pk_bf16_f32 v74, v48, v49
    v_exp_f32 v51, v51
    v_exp_f32 v52, v52
    v_cvt_pk_bf16_f32 v75, v50, v51
    s_waitcnt lgkmcnt(0)
    v_mfma_f32_32x32x8_bf16 v[36:51], v[108:109], v[24:25], 0
    v_exp_f32 v53, v53
    v_exp_f32 v54, v54
    v_cvt_pk_bf16_f32 v68, v52, v53
    v_exp_f32 v55, v55
    v_exp_f32 v56, v56
    v_cvt_pk_bf16_f32 v69, v54, v55
    v_mfma_f32_32x32x16_bf16 v[36:51], a[0:3], v[20:23], v[36:51]
    ds_read_b128 v[28:31], v9 offset:1536
    ds_read_b64 v[32:33], v10 offset:2560
    v_exp_f32 v57, v57
    v_exp_f32 v58, v58
    v_cvt_pk_bf16_f32 v70, v56, v57
    v_exp_f32 v59, v59
    v_exp_f32 v60, v60
    v_mfma_f32_32x32x16_bf16 v[76:91], a[180:183], v[72:75], v[76:91]
    v_cvt_pk_bf16_f32 v71, v58, v59
    v_exp_f32 v61, v61
    v_add_u32 v9, 1536, v9
    v_add_u32 v10, 1536, v10
    v_exp_f32 v62, v62
    v_cvt_pk_bf16_f32 v72, v60, v61
    v_exp_f32 v63, v63
    v_exp_f32 v64, v64
    v_mfma_f32_32x32x16_bf16 v[76:91], a[184:187], v[68:71], v[76:91]
    v_cvt_pk_bf16_f32 v73, v62, v63
    v_exp_f32 v65, v65
    v_exp_f32 v66, v66
    v_cvt_pk_bf16_f32 v74, v64, v65
    v_exp_f32 v67, v67
    s_sub_u32 s33, s33, 1
    s_cmp_lg_u32 s33, 0
    s_cbranch_scc1 Lloop23
    buffer_load_dword v239, v238, s[12:15], 0 offen sc1
    buffer_load_dword v246, v245, s[12:15], s48 offen sc1
    s_getpc_b64 s[60:61]
Lpc24:
    s_lshr_b32 s27, s2, 3
    s_lshl_b32 s27, s27, 2
    s_add_u32 s27, s27, s3
    s_mul_i32 s27, s27, 256
    s_add_u32 s27, s27, p3_start-Lpc24
    v_and_b32 v204, 1, v0
    v_lshl_add_u32 v204, v204, 7, s27
    v_min_u32 v204, p5_start-Lpc24-4, v204
    global_load_dword v205, v204, s[60:61]
    s_mov_b32 s33, 3
Lloop25:
    v_exp_f32 v36, v36
    v_cvt_pk_bf16_f32 v75, v66, v67
    s_waitcnt lgkmcnt(0)
    v_mfma_f32_32x32x8_bf16 v[52:67], v[110:111], v[32:33], 0
    v_exp_f32 v37, v37
    v_exp_f32 v38, v38
    v_cvt_pk_bf16_f32 v68, v36, v37
    v_exp_f32 v39, v39
    v_exp_f32 v40, v40
    v_cvt_pk_bf16_f32 v69, v38, v39
    v_mfma_f32_32x32x16_bf16 v[52:67], a[4:7], v[28:31], v[52:67]
    v_exp_f32 v41, v41
    v_exp_f32 v42, v42
    v_cvt_pk_bf16_f32 v70, v40, v41
    v_exp_f32 v43, v43
    v_exp_f32 v44, v44
    v_mfma_f32_32x32x16_bf16 v[76:91], a[188:191], v[72:75], v[76:91]
    v_cvt_pk_bf16_f32 v71, v42, v43
    v_exp_f32 v45, v45
    v_exp_f32 v46, v46
    v_cvt_pk_bf16_f32 v72, v44, v45
    v_exp_f32 v47, v47
    v_exp_f32 v48, v48
    v_mfma_f32_32x32x16_bf16 v[92:107], a[64:67], v[68:71], 0
    v_cvt_pk_bf16_f32 v73, v46, v47
    v_exp_f32 v49, v49
    v_exp_f32 v50, v50
    v_cvt_pk_bf16_f32 v74, v48, v49
    v_exp_f32 v51, v51
    v_exp_f32 v52, v52
    v_cvt_pk_bf16_f32 v75, v50, v51
    v_mfma_f32_32x32x8_bf16 v[36:51], v[112:113], v[32:33], 0
    ds_write_b128 v11, v[76:79] offset:0
    v_exp_f32 v53, v53
    v_exp_f32 v54, v54
    v_cvt_pk_bf16_f32 v68, v52, v53
    v_exp_f32 v55, v55
    v_exp_f32 v56, v56
    v_cvt_pk_bf16_f32 v69, v54, v55
    v_mfma_f32_32x32x16_bf16 v[36:51], a[8:11], v[28:31], v[36:51]
    ds_write_b128 v11, v[80:83] offset:1024
    v_exp_f32 v57, v57
    v_exp_f32 v58, v58
    v_cvt_pk_bf16_f32 v70, v56, v57
    v_exp_f32 v59, v59
    v_exp_f32 v60, v60
    v_mfma_f32_32x32x16_bf16 v[92:107], a[68:71], v[72:75], v[92:107]
    s_mov_b32 exec_hi, 0
    ds_write_b128 v11, v[84:87] offset:2048
    s_mov_b32 exec_hi, -1
    v_cvt_pk_bf16_f32 v71, v58, v59
    v_exp_f32 v61, v61
    v_add_u32 v11, 2560, v11
    v_exp_f32 v62, v62
    v_cvt_pk_bf16_f32 v72, v60, v61
    v_exp_f32 v63, v63
    v_exp_f32 v64, v64
    s_waitcnt lgkmcnt(0)
    v_mfma_f32_32x32x16_bf16 v[76:91], a[72:75], v[68:71], v[92:107]
    v_cvt_pk_bf16_f32 v73, v62, v63
    v_exp_f32 v65, v65
    v_exp_f32 v66, v66
    v_cvt_pk_bf16_f32 v74, v64, v65
    v_exp_f32 v67, v67
    v_exp_f32 v36, v36
    v_cvt_pk_bf16_f32 v75, v66, v67
    v_mfma_f32_32x32x8_bf16 v[52:67], v[114:115], v[32:33], 0
    v_exp_f32 v37, v37
    v_exp_f32 v38, v38
    v_cvt_pk_bf16_f32 v68, v36, v37
    v_exp_f32 v39, v39
    v_exp_f32 v40, v40
    v_cvt_pk_bf16_f32 v69, v38, v39
    v_mfma_f32_32x32x16_bf16 v[52:67], a[12:15], v[28:31], v[52:67]
    v_exp_f32 v41, v41
    v_exp_f32 v42, v42
    v_cvt_pk_bf16_f32 v70, v40, v41
    v_exp_f32 v43, v43
    v_exp_f32 v44, v44
    v_mfma_f32_32x32x16_bf16 v[76:91], a[76:79], v[72:75], v[76:91]
    v_cvt_pk_bf16_f32 v71, v42, v43
    v_exp_f32 v45, v45
    v_exp_f32 v46, v46
    v_cvt_pk_bf16_f32 v72, v44, v45
    v_exp_f32 v47, v47
    v_exp_f32 v48, v48
    v_mfma_f32_32x32x16_bf16 v[76:91], a[80:83], v[68:71], v[76:91]
    v_cvt_pk_bf16_f32 v73, v46, v47
    v_exp_f32 v49, v49
    v_exp_f32 v50, v50
    v_cvt_pk_bf16_f32 v74, v48, v49
    v_exp_f32 v51, v51
    v_exp_f32 v52, v52
    v_cvt_pk_bf16_f32 v75, v50, v51
    v_mfma_f32_32x32x8_bf16 v[36:51], v[116:117], v[32:33], 0
    v_exp_f32 v53, v53
    v_exp_f32 v54, v54
    v_cvt_pk_bf16_f32 v68, v52, v53
    v_exp_f32 v55, v55
    v_exp_f32 v56, v56
    v_cvt_pk_bf16_f32 v69, v54, v55
    v_mfma_f32_32x32x16_bf16 v[36:51], a[16:19], v[28:31], v[36:51]
    v_exp_f32 v57, v57
    v_exp_f32 v58, v58
    v_cvt_pk_bf16_f32 v70, v56, v57
    v_exp_f32 v59, v59
    v_exp_f32 v60, v60
    v_mfma_f32_32x32x16_bf16 v[76:91], a[84:87], v[72:75], v[76:91]
    ds_read_b128 v[20:23], v9 offset:1536
    ds_read_b64 v[24:25], v10 offset:2560
    v_cvt_pk_bf16_f32 v71, v58, v59
    v_exp_f32 v61, v61
    v_exp_f32 v62, v62
    v_cvt_pk_bf16_f32 v72, v60, v61
    v_exp_f32 v63, v63
    v_exp_f32 v64, v64
    v_mfma_f32_32x32x16_bf16 v[76:91], a[88:91], v[68:71], v[76:91]
    v_cvt_pk_bf16_f32 v73, v62, v63
    v_exp_f32 v65, v65
    v_exp_f32 v66, v66
    v_cvt_pk_bf16_f32 v74, v64, v65
    v_exp_f32 v67, v67
    v_exp_f32 v36, v36
    v_cvt_pk_bf16_f32 v75, v66, v67
    v_mfma_f32_32x32x8_bf16 v[52:67], v[118:119], v[32:33], 0
    v_exp_f32 v37, v37
    v_exp_f32 v38, v38
    v_cvt_pk_bf16_f32 v68, v36, v37
    v_exp_f32 v39, v39
    v_exp_f32 v40, v40
    v_cvt_pk_bf16_f32 v69, v38, v39
    s_waitcnt vmcnt(8)
    v_mfma_f32_32x32x16_bf16 v[52:67], a[20:23], v[28:31], v[52:67]
    ds_read_b64_tr_b16 v[140:141], v8 offset:0
    v_exp_f32 v41, v41
    v_exp_f32 v42, v42
    v_cvt_pk_bf16_f32 v70, v40, v41
    v_exp_f32 v43, v43
    v_exp_f32 v44, v44
    v_mfma_f32_32x32x16_bf16 v[76:91], a[92:95], v[72:75], v[76:91]
    ds_read_b64_tr_b16 v[142:143], v8 offset:512
    v_cvt_pk_bf16_f32 v71, v42, v43
    v_exp_f32 v45, v45
    v_exp_f32 v46, v46
    v_cvt_pk_bf16_f32 v72, v44, v45
    v_exp_f32 v47, v47
    v_exp_f32 v48, v48
    v_mfma_f32_32x32x16_bf16 v[76:91], a[96:99], v[68:71], v[76:91]
    ds_read_b64_tr_b16 v[144:145], v8 offset:32
    v_cvt_pk_bf16_f32 v73, v46, v47
    v_exp_f32 v49, v49
    v_exp_f32 v50, v50
    v_cvt_pk_bf16_f32 v74, v48, v49
    v_exp_f32 v51, v51
    v_exp_f32 v52, v52
    v_cvt_pk_bf16_f32 v75, v50, v51
    v_mfma_f32_32x32x8_bf16 v[36:51], v[120:121], v[32:33], 0
    v_exp_f32 v53, v53
    v_exp_f32 v54, v54
    v_cvt_pk_bf16_f32 v68, v52, v53
    v_exp_f32 v55, v55
    v_exp_f32 v56, v56
    v_cvt_pk_bf16_f32 v69, v54, v55
    v_mfma_f32_32x32x16_bf16 v[36:51], a[24:27], v[28:31], v[36:51]
    ds_read_b64_tr_b16 v[146:147], v8 offset:544
    v_exp_f32 v57, v57
    v_exp_f32 v58, v58
    v_cvt_pk_bf16_f32 v70, v56, v57
    v_exp_f32 v59, v59
    v_exp_f32 v60, v60
    v_mfma_f32_32x32x16_bf16 v[76:91], a[100:103], v[72:75], v[76:91]
    ds_read_b64_tr_b16 v[148:149], v8 offset:64
    v_cvt_pk_bf16_f32 v71, v58, v59
    v_exp_f32 v61, v61
    v_exp_f32 v62, v62
    v_cvt_pk_bf16_f32 v72, v60, v61
    v_exp_f32 v63, v63
    v_exp_f32 v64, v64
    v_mfma_f32_32x32x16_bf16 v[76:91], a[104:107], v[68:71], v[76:91]
    ds_read_b64_tr_b16 v[150:151], v8 offset:576
    v_cvt_pk_bf16_f32 v73, v62, v63
    v_exp_f32 v65, v65
    v_exp_f32 v66, v66
    v_cvt_pk_bf16_f32 v74, v64, v65
    v_exp_f32 v67, v67
    v_exp_f32 v36, v36
    v_cvt_pk_bf16_f32 v75, v66, v67
    v_mfma_f32_32x32x8_bf16 v[52:67], v[122:123], v[32:33], 0
    v_exp_f32 v37, v37
    v_exp_f32 v38, v38
    v_cvt_pk_bf16_f32 v68, v36, v37
    v_exp_f32 v39, v39
    v_exp_f32 v40, v40
    v_cvt_pk_bf16_f32 v69, v38, v39
    v_mfma_f32_32x32x16_bf16 v[52:67], a[28:31], v[28:31], v[52:67]
    ds_read_b64_tr_b16 v[152:153], v8 offset:96
    v_exp_f32 v41, v41
    v_exp_f32 v42, v42
    v_cvt_pk_bf16_f32 v70, v40, v41
    v_exp_f32 v43, v43
    v_exp_f32 v44, v44
    v_mfma_f32_32x32x16_bf16 v[76:91], a[108:111], v[72:75], v[76:91]
    ds_read_b64_tr_b16 v[154:155], v8 offset:608
    v_cvt_pk_bf16_f32 v71, v42, v43
    v_exp_f32 v45, v45
    v_exp_f32 v46, v46
    v_cvt_pk_bf16_f32 v72, v44, v45
    v_exp_f32 v47, v47
    v_exp_f32 v48, v48
    v_mfma_f32_32x32x16_bf16 v[76:91], a[112:115], v[68:71], v[76:91]
    v_cvt_pk_bf16_f32 v73, v46, v47
    v_exp_f32 v49, v49
    v_exp_f32 v50, v50
    v_cvt_pk_bf16_f32 v74, v48, v49
    v_exp_f32 v51, v51
    v_exp_f32 v52, v52
    v_cvt_pk_bf16_f32 v75, v50, v51
    v_mfma_f32_32x32x8_bf16 v[36:51], v[124:125], v[32:33], 0
    v_exp_f32 v53, v53
    v_exp_f32 v54, v54
    v_cvt_pk_bf16_f32 v68, v52, v53
    v_exp_f32 v55, v55
    v_exp_f32 v56, v56
    v_cvt_pk_bf16_f32 v69, v54, v55
    v_mfma_f32_32x32x16_bf16 v[36:51], a[32:35], v[28:31], v[36:51]
    v_exp_f32 v57, v57
    v_exp_f32 v58, v58
    v_cvt_pk_bf16_f32 v70, v56, v57
    v_exp_f32 v59, v59
    v_exp_f32 v60, v60
    v_mfma_f32_32x32x16_bf16 v[76:91], a[116:119], v[72:75], v[76:91]
    v_cvt_pk_bf16_f32 v71, v58, v59
    v_exp_f32 v61, v61
    v_exp_f32 v62, v62
    v_cvt_pk_bf16_f32 v72, v60, v61
    v_exp_f32 v63, v63
    v_exp_f32 v64, v64
    v_mfma_f32_32x32x16_bf16 v[76:91], a[120:123], v[68:71], v[76:91]
    v_cvt_pk_bf16_f32 v73, v62, v63
    v_exp_f32 v65, v65
    v_exp_f32 v66, v66
    v_cvt_pk_bf16_f32 v74, v64, v65
    v_exp_f32 v67, v67
    v_exp_f32 v36, v36
    v_cvt_pk_bf16_f32 v75, v66, v67
    v_mfma_f32_32x32x8_bf16 v[52:67], v[126:127], v[32:33], 0
    v_exp_f32 v37, v37
    v_exp_f32 v38, v38
    v_cvt_pk_bf16_f32 v68, v36, v37
    v_exp_f32 v39, v39
    v_exp_f32 v40, v40
    v_cvt_pk_bf16_f32 v69, v38, v39
    v_mfma_f32_32x32x16_bf16 v[52:67], a[36:39], v[28:31], v[52:67]
    v_exp_f32 v41, v41
    v_exp_f32 v42, v42
    v_cvt_pk_bf16_f32 v70, v40, v41
    v_exp_f32 v43, v43
    v_exp_f32 v44, v44
    v_mfma_f32_32x32x16_bf16 v[76:91], a[124:127], v[72:75], v[76:91]
    v_cvt_pk_bf16_f32 v71, v42, v43
    s_waitcnt lgkmcnt(0)
    v_add_u32 v8, s4, v8
    s_xor_b32 s4, s4, s5
    v_exp_f32 v45, v45
    buffer_store_dwordx4 v[140:143], v5, s[12:15], s6 offen sc1
    s_add_u32 s6, s6, s10
    v_exp_f32 v46, v46
    v_cvt_pk_bf16_f32 v72, v44, v45
    v_exp_f32 v47, v47
    v_exp_f32 v48, v48
    v_mfma_f32_32x32x16_bf16 v[76:91], a[128:131], v[68:71], v[76:91]
    v_cvt_pk_bf16_f32 v73, v46, v47
    v_exp_f32 v49, v49
    v_exp_f32 v50, v50
    v_cvt_pk_bf16_f32 v74, v48, v49
    v_exp_f32 v51, v51
    v_exp_f32 v52, v52
    v_cvt_pk_bf16_f32 v75, v50, v51
    v_mfma_f32_32x32x8_bf16 v[36:51], v[128:129], v[32:33], 0
    v_exp_f32 v53, v53
    v_exp_f32 v54, v54
    v_cvt_pk_bf16_f32 v68, v52, v53
    v_exp_f32 v55, v55
    v_exp_f32 v56, v56
    v_cvt_pk_bf16_f32 v69, v54, v55
    v_mfma_f32_32x32x16_bf16 v[36:51], a[40:43], v[28:31], v[36:51]
    v_exp_f32 v57, v57
    v_exp_f32 v58, v58
    v_cvt_pk_bf16_f32 v70, v56, v57
    v_exp_f32 v59, v59
    v_exp_f32 v60, v60
    v_mfma_f32_32x32x16_bf16 v[76:91], a[132:135], v[72:75], v[76:91]
    v_cvt_pk_bf16_f32 v71, v58, v59
    v_exp_f32 v61, v61
    v_exp_f32 v62, v62
    v_cvt_pk_bf16_f32 v72, v60, v61
    v_exp_f32 v63, v63
    v_exp_f32 v64, v64
    v_mfma_f32_32x32x16_bf16 v[76:91], a[136:139], v[68:71], v[76:91]
    v_cvt_pk_bf16_f32 v73, v62, v63
    v_exp_f32 v65, v65
    v_exp_f32 v66, v66
    v_cvt_pk_bf16_f32 v74, v64, v65
    v_exp_f32 v67, v67
    v_exp_f32 v36, v36
    v_cvt_pk_bf16_f32 v75, v66, v67
    v_mfma_f32_32x32x8_bf16 v[52:67], v[130:131], v[32:33], 0
    v_exp_f32 v37, v37
    v_exp_f32 v38, v38
    v_cvt_pk_bf16_f32 v68, v36, v37
    v_exp_f32 v39, v39
    v_exp_f32 v40, v40
    v_cvt_pk_bf16_f32 v69, v38, v39
    v_mfma_f32_32x32x16_bf16 v[52:67], a[44:47], v[28:31], v[52:67]
    v_exp_f32 v41, v41
    v_exp_f32 v42, v42
    v_cvt_pk_bf16_f32 v70, v40, v41
    v_exp_f32 v43, v43
    v_exp_f32 v44, v44
    v_mfma_f32_32x32x16_bf16 v[76:91], a[140:143], v[72:75], v[76:91]
    v_cvt_pk_bf16_f32 v71, v42, v43
    v_exp_f32 v45, v45
    buffer_store_dwordx4 v[144:147], v5, s[12:15], s7 offen sc1
    s_add_u32 s7, s7, s24
    v_exp_f32 v46, v46
    v_cvt_pk_bf16_f32 v72, v44, v45
    v_exp_f32 v47, v47
    v_exp_f32 v48, v48
    v_mfma_f32_32x32x16_bf16 v[76:91], a[144:147], v[68:71], v[76:91]
    v_cvt_pk_bf16_f32 v73, v46, v47
    v_exp_f32 v49, v49
    v_exp_f32 v50, v50
    v_cvt_pk_bf16_f32 v74, v48, v49
    v_exp_f32 v51, v51
    v_exp_f32 v52, v52
    v_cvt_pk_bf16_f32 v75, v50, v51
    v_mfma_f32_32x32x8_bf16 v[36:51], v[132:133], v[32:33], 0
    v_exp_f32 v53, v53
    v_exp_f32 v54, v54
    v_cvt_pk_bf16_f32 v68, v52, v53
    v_exp_f32 v55, v55
    v_exp_f32 v56, v56
    v_cvt_pk_bf16_f32 v69, v54, v55
    v_mfma_f32_32x32x16_bf16 v[36:51], a[48:51], v[28:31], v[36:51]
    v_exp_f32 v57, v57
    v_exp_f32 v58, v58
    v_cvt_pk_bf16_f32 v70, v56, v57
    v_exp_f32 v59, v59
    v_exp_f32 v60, v60
    v_mfma_f32_32x32x16_bf16 v[76:91], a[148:151], v[72:75], v[76:91]
    v_cvt_pk_bf16_f32 v71, v58, v59
    v_exp_f32 v61, v61
    v_exp_f32 v62, v62
    v_cvt_pk_bf16_f32 v72, v60, v61
    v_exp_f32 v63, v63
    v_exp_f32 v64, v64
    v_mfma_f32_32x32x16_bf16 v[76:91], a[152:155], v[68:71], v[76:91]
    v_cvt_pk_bf16_f32 v73, v62, v63
    v_exp_f32 v65, v65
    v_exp_f32 v66, v66
    v_cvt_pk_bf16_f32 v74, v64, v65
    v_exp_f32 v67, v67
    v_exp_f32 v36, v36
    v_cvt_pk_bf16_f32 v75, v66, v67
    v_mfma_f32_32x32x8_bf16 v[52:67], v[134:135], v[32:33], 0
    v_exp_f32 v37, v37
    v_exp_f32 v38, v38
    v_cvt_pk_bf16_f32 v68, v36, v37
    v_exp_f32 v39, v39
    v_exp_f32 v40, v40
    v_cvt_pk_bf16_f32 v69, v38, v39
    v_mfma_f32_32x32x16_bf16 v[52:67], a[52:55], v[28:31], v[52:67]
    v_exp_f32 v41, v41
    v_exp_f32 v42, v42
    v_cvt_pk_bf16_f32 v70, v40, v41
    v_exp_f32 v43, v43
    v_exp_f32 v44, v44
    v_mfma_f32_32x32x16_bf16 v[76:91], a[156:159], v[72:75], v[76:91]
    v_cvt_pk_bf16_f32 v71, v42, v43
    v_exp_f32 v45, v45
    buffer_store_dwordx4 v[148:151], v5, s[12:15], s8 offen sc1
    s_add_u32 s8, s8, s39
    v_exp_f32 v46, v46
    v_cvt_pk_bf16_f32 v72, v44, v45
    v_exp_f32 v47, v47
    v_exp_f32 v48, v48
    v_mfma_f32_32x32x16_bf16 v[76:91], a[160:163], v[68:71], v[76:91]
    v_cvt_pk_bf16_f32 v73, v46, v47
    v_exp_f32 v49, v49
    v_exp_f32 v50, v50
    v_cvt_pk_bf16_f32 v74, v48, v49
    v_exp_f32 v51, v51
    v_exp_f32 v52, v52
    v_cvt_pk_bf16_f32 v75, v50, v51
    v_mfma_f32_32x32x8_bf16 v[36:51], v[136:137], v[32:33], 0
    v_exp_f32 v53, v53
    v_exp_f32 v54, v54
    v_cvt_pk_bf16_f32 v68, v52, v53
    v_exp_f32 v55, v55
    v_exp_f32 v56, v56
    v_cvt_pk_bf16_f32 v69, v54, v55
    v_mfma_f32_32x32x16_bf16 v[36:51], a[56:59], v[28:31], v[36:51]
    v_exp_f32 v57, v57
    v_exp_f32 v58, v58
    v_cvt_pk_bf16_f32 v70, v56, v57
    v_exp_f32 v59, v59
    v_exp_f32 v60, v60
    v_mfma_f32_32x32x16_bf16 v[76:91], a[164:167], v[72:75], v[76:91]
    v_cvt_pk_bf16_f32 v71, v58, v59
    v_exp_f32 v61, v61
    v_exp_f32 v62, v62
    v_cvt_pk_bf16_f32 v72, v60, v61
    v_exp_f32 v63, v63
    v_exp_f32 v64, v64
    v_mfma_f32_32x32x16_bf16 v[76:91], a[168:171], v[68:71], v[76:91]
    v_cvt_pk_bf16_f32 v73, v62, v63
    v_exp_f32 v65, v65
    v_exp_f32 v66, v66
    v_cvt_pk_bf16_f32 v74, v64, v65
    v_exp_f32 v67, v67
    v_exp_f32 v36, v36
    v_cvt_pk_bf16_f32 v75, v66, v67
    v_mfma_f32_32x32x8_bf16 v[52:67], v[138:139], v[32:33], 0
    v_exp_f32 v37, v37
    v_exp_f32 v38, v38
    v_cvt_pk_bf16_f32 v68, v36, v37
    v_exp_f32 v39, v39
    v_exp_f32 v40, v40
    v_cvt_pk_bf16_f32 v69, v38, v39
    v_mfma_f32_32x32x16_bf16 v[52:67], a[60:63], v[28:31], v[52:67]
    v_exp_f32 v41, v41
    v_exp_f32 v42, v42
    v_cvt_pk_bf16_f32 v70, v40, v41
    v_exp_f32 v43, v43
    v_exp_f32 v44, v44
    v_mfma_f32_32x32x16_bf16 v[76:91], a[172:175], v[72:75], v[76:91]
    v_cvt_pk_bf16_f32 v71, v42, v43
    v_exp_f32 v45, v45
    buffer_store_dwordx4 v[152:155], v5, s[12:15], s9 offen sc1
    s_add_u32 s9, s9, s40
    v_exp_f32 v46, v46
    v_cvt_pk_bf16_f32 v72, v44, v45
    v_exp_f32 v47, v47
    v_exp_f32 v48, v48
    v_mfma_f32_32x32x16_bf16 v[76:91], a[176:179], v[68:71], v[76:91]
    v_cvt_pk_bf16_f32 v73, v46, v47
    v_exp_f32 v49, v49
    v_exp_f32 v50, v50
    v_cvt_pk_bf16_f32 v74, v48, v49
    v_exp_f32 v51, v51
    v_exp_f32 v52, v52
    v_cvt_pk_bf16_f32 v75, v50, v51
    s_waitcnt lgkmcnt(0)
    v_mfma_f32_32x32x8_bf16 v[36:51], v[108:109], v[24:25], 0
    v_exp_f32 v53, v53
    v_exp_f32 v54, v54
    v_cvt_pk_bf16_f32 v68, v52, v53
    v_exp_f32 v55, v55
    v_exp_f32 v56, v56
    v_cvt_pk_bf16_f32 v69, v54, v55
    v_mfma_f32_32x32x16_bf16 v[36:51], a[0:3], v[20:23], v[36:51]
    ds_read_b128 v[28:31], v9 offset:1536
    ds_read_b64 v[32:33], v10 offset:2560
    v_exp_f32 v57, v57
    v_exp_f32 v58, v58
    v_cvt_pk_bf16_f32 v70, v56, v57
    v_exp_f32 v59, v59
    v_exp_f32 v60, v60
    v_mfma_f32_32x32x16_bf16 v[76:91], a[180:183], v[72:75], v[76:91]
    v_cvt_pk_bf16_f32 v71, v58, v59
    v_exp_f32 v61, v61
    v_add_u32 v9, 1536, v9
    v_add_u32 v10, 1536, v10
    v_exp_f32 v62, v62
    v_cvt_pk_bf16_f32 v72, v60, v61
    v_exp_f32 v63, v63
    v_exp_f32 v64, v64
    v_mfma_f32_32x32x16_bf16 v[76:91], a[184:187], v[68:71], v[76:91]
    v_cvt_pk_bf16_f32 v73, v62, v63
    v_exp_f32 v65, v65
    v_exp_f32 v66, v66
    v_cvt_pk_bf16_f32 v74, v64, v65
    v_exp_f32 v67, v67
    s_sub_u32 s33, s33, 1
    s_cmp_lg_u32 s33, 0
    s_cbranch_scc1 Lloop25
    s_waitcnt vmcnt(12)
    ds_read_b64_tr_b16 v[140:141], v8 offset:0
    ds_read_b64_tr_b16 v[142:143], v8 offset:512
    ds_read_b64_tr_b16 v[144:145], v8 offset:32
    ds_read_b64_tr_b16 v[146:147], v8 offset:544
    ds_read_b64_tr_b16 v[148:149], v8 offset:64
    ds_read_b64_tr_b16 v[150:151], v8 offset:576
    ds_read_b64_tr_b16 v[152:153], v8 offset:96
    ds_read_b64_tr_b16 v[154:155], v8 offset:608
    v_cvt_pk_bf16_f32 v75, v66, v67
    s_nop 1
    v_mfma_f32_32x32x16_bf16 v[76:91], a[188:191], v[72:75], v[76:91]
    s_mul_i32 s27, s3, 5120
    s_add_u32 s27, s27, 12288
    v_add_u32 v13, s27, v5
    v_and_b32 v14, 511, v5
    v_add_u32 v14, s27, v14
    v_bfe_u32 v15, v1, 4, 1
    v_mul_u32_u24 v15, 16384, v15
    v_and_b32 v16, 15, v1
    v_lshl_add_u32 v15, v16, 4, v15
    v_lshrrev_b32 v16, 5, v1
    v_lshl_add_u32 v16, v16, 8, v15
    s_lshr_b32 s27, s45, 4
    s_mul_i32 s27, s27, 16384
    s_add_u32 s27, s27, 0x740000
    s_lshl_b32 s46, s25, 9
    s_add_u32 s46, s46, s27
    s_lshl_b32 s47, s45, 7
    s_lshl_b32 s29, s25, 8
    s_add_u32 s47, s47, s29
    s_add_u32 s47, s47, 0x940000
    ds_write_b128 v11, v[76:79] offset:0
    ds_write_b128 v11, v[80:83] offset:1024
    s_mov_b32 exec_hi, 0
    ds_write_b128 v11, v[84:87] offset:2048
    s_mov_b32 exec_hi, -1
    s_mov_b32 s33, 2
    s_waitcnt lgkmcnt(3)
    buffer_store_dwordx4 v[140:143], v5, s[12:15], s6 offen sc1
    buffer_store_dwordx4 v[144:147], v5, s[12:15], s7 offen sc1
    buffer_store_dwordx4 v[148:151], v5, s[12:15], s8 offen sc1
    buffer_store_dwordx4 v[152:155], v5, s[12:15], s9 offen sc1
    s_waitcnt lgkmcnt(0)
    s_barrier
Lred26:
    ds_read_b128 v[156:159], v13 offset:0
    ds_read_b128 v[160:163], v13 offset:1024
    ds_read_b128 v[164:167], v14 offset:2048
    ds_read_b128 v[168:171], v13 offset:20480
    ds_read_b128 v[172:175], v13 offset:21504
    ds_read_b128 v[176:179], v14 offset:22528
    ds_read_b128 v[180:183], v13 offset:40960
    ds_read_b128 v[184:187], v13 offset:41984
    ds_read_b128 v[188:191], v14 offset:43008
    ds_read_b128 v[192:195], v13 offset:61440
    ds_read_b128 v[196:199], v13 offset:62464
    ds_read_b128 v[200:203], v14 offset:63488
    v_add_u32 v13, 2560, v13
    v_add_u32 v14, 2560, v14
    s_waitcnt lgkmcnt(6)
    v_pk_add_f32 v[156:157], v[156:157], v[168:169]
    v_pk_add_f32 v[158:159], v[158:159], v[170:171]
    v_pk_add_f32 v[160:161], v[160:161], v[172:173]
    v_pk_add_f32 v[162:163], v[162:163], v[174:175]
    v_pk_add_f32 v[164:165], v[164:165], v[176:177]
    v_pk_add_f32 v[166:167], v[166:167], v[178:179]
    s_waitcnt lgkmcnt(0)
    v_pk_add_f32 v[180:181], v[180:181], v[192:193]
    v_pk_add_f32 v[182:183], v[182:183], v[194:195]
    v_pk_add_f32 v[184:185], v[184:185], v[196:197]
    v_pk_add_f32 v[186:187], v[186:187], v[198:199]
    v_pk_add_f32 v[188:189], v[188:189], v[200:201]
    v_pk_add_f32 v[190:191], v[190:191], v[202:203]
    v_pk_add_f32 v[156:157], v[156:157], v[180:181]
    v_pk_add_f32 v[158:159], v[158:159], v[182:183]
    v_pk_add_f32 v[160:161], v[160:161], v[184:185]
    v_pk_add_f32 v[162:163], v[162:163], v[186:187]
    v_pk_add_f32 v[164:165], v[164:165], v[188:189]
    v_pk_add_f32 v[166:167], v[166:167], v[190:191]
    v_pk_add_f32 v[168:169], v[156:157], v[158:159]
    v_pk_add_f32 v[170:171], v[160:161], v[162:163]
    v_pk_add_f32 v[168:169], v[168:169], v[164:165]
    v_pk_add_f32 v[168:169], v[168:169], v[170:171]
    v_add_f32 v168, v168, v169
    v_mov_b32 v169, 0x1f8
    v_cmp_class_f32 s[68:69], v168, v169
    v_cmp_le_f32 vcc, 0x33800000, v166
    s_nop 0
    s_and_b64 s[68:69], s[68:69], vcc
    v_cmp_ge_f32 vcc, 0x6c800000, v166
    s_nop 0
    s_and_b64 s[68:69], s[68:69], vcc
    s_cmp_eq_u64 s[68:69], -1
    s_cbranch_scc0 Lslow27
Lfin28:
    v_rcp_f32 v166, v166
    s_nop 0
    v_pk_mul_f32 v[156:157], v[156:157], v[166:167] op_sel_hi:[1,0]
    v_pk_mul_f32 v[158:159], v[158:159], v[166:167] op_sel_hi:[1,0]
    v_pk_mul_f32 v[160:161], v[160:161], v[166:167] op_sel_hi:[1,0]
    v_pk_mul_f32 v[162:163], v[162:163], v[166:167] op_sel_hi:[1,0]
    v_pk_mul_f32 v[164:165], v[164:165], v[166:167] op_sel_hi:[1,0]
    v_cvt_pk_bf16_f32 v172, v156, v157
    v_cvt_pk_bf16_f32 v173, v158, v159
    v_cvt_pk_bf16_f32 v174, v160, v161
    v_cvt_pk_bf16_f32 v175, v162, v163
    buffer_store_dwordx4 v[172:175], v16, s[12:15], s46 offen sc1
    v_mov_b32 v20, v22
    v_mov_b32 v21, v23
    v_cvt_pk_bf16_f32 v22, v164, v165
    v_cvt_pk_bf16_f32 v23, v164, v165
    s_add_u32 s46, s46, 32768
    s_nop 0
    v_permlane16_swap_b32 v22, v23
    s_sub_u32 s33, s33, 1
    s_cmp_lg_u32 s33, 0
    s_cbranch_scc1 Lred26
    s_mov_b64 exec, 0xffff
    buffer_store_dwordx4 v[20:23], v5, s[12:15], s47 offen sc1
    s_mov_b64 exec, -1
p3_start:
    s_lshl_b32 s27, s2, 7
    s_add_u32 s27, s27, 0xcc8000
    s_load_dwordx2 s[46:47], s[0:1], 56
    v_and_b32 v1, 63, v0
    v_lshlrev_b32 v2, 4, v1
    s_and_b32 s24, s2, 7
    s_lshl_b32 s24, s24, 2
    s_bfe_u32 s25, s2, 0x20003
    s_add_u32 s24, s24, s25
    s_lshr_b32 s25, s2, 5
    s_mul_i32 s26, s25, 5
    s_lshl_b32 s28, s25, 2
    s_add_u32 s28, s28, 4
    s_min_u32 s26, s26, s28
    s_cmp_lt_u32 s25, 4
    s_cselect_b32 s34, 10, 8
    s_sub_u32 s29, s3, 1
    s_mul_i32 s30, s29, s34
    s_mul_i32 s30, s30, 3072
    s_mul_i32 s28, s26, 18432
    s_add_u32 s28, s28, s30
    s_add_u32 s28, s28, 0xc00000
    s_add_u32 s30, s30, 61440
    s_lshl_b32 s29, s29, 10
    s_add_u32 s31, s29, 153600
    s_add_u32 s29, s29, 0xbd4000
    s_mov_b32 s35, 1
    s_and_b32 s33, s2, 3
    s_lshl_b32 s33, s33, 3
    s_add_u32 s33, s33, s25
    s_mul_i32 s48, s33, 331776
    s_mul_i32 s49, s3, 9216
    s_add_u32 s48, s48, s49
    s_add_u32 s48, s48, 0xd00000
    s_mul_i32 s33, s33, 9
    v_and_b32 v12, 1, v1
    v_lshl_add_u32 v12, v12, 3, s33
    v_lshrrev_b32 v12, 4, v12
    v_bfe_u32 v13, v1, 1, 4
    v_min_u32 v13, 8, v13
    v_mul_u32_u24 v13, 18, v13
    v_add_u32 v12, v12, v13
    s_and_b32 s33, s2, 7
    s_lshl_b32 s33, s33, 5
    v_add_u32 v13, s33, v1
    v_cmp_gt_u32 vcc, 32, v1
    s_nop 1
    v_cndmask_b32 v9, v12, v13, vcc
    s_mov_b32 s33, 0xcc8000
    v_lshl_add_u32 v9, v9, 7, s33
    s_mov_b32 s40, 0x40000
Lslp30:
    s_waitcnt vmcnt(0)
    v_cmp_ne_u32 vcc, 1, v239
    s_nop 4
    s_cbranch_vccz Lsok29
    s_sub_u32 s40, s40, 1
    s_cbranch_scc1 Lsok29
    buffer_load_dword v239, v238, s[12:15], 0 offen sc1
    s_branch Lslp30
Lsok29:
    v_mov_b32 v12, 0
    v_mov_b32 v13, 1
    s_waitcnt vmcnt(0)
    s_barrier
    s_cmp_lg_u32 s3, 1
    s_cbranch_scc1 Lnosig31
    s_mov_b64 exec, 1
    buffer_store_dword v13, v12, s[12:15], s27 offen sc1
    s_mov_b64 exec, -1
Lnosig31:
    s_cmp_eq_u32 s3, 0
    s_cbranch_scc1 Lbskip32
Lbl33:
    s_mov_b32 m0, s30
    s_add_u32 s30, s30, 3072
    buffer_load_dwordx4 v2, s[12:15], s28 offen offset:0 sc1 lds
    buffer_load_dwordx4 v2, s[12:15], s28 offen offset:1024 sc1 lds
    buffer_load_dwordx4 v2, s[12:15], s28 offen offset:2048 sc1 lds
    s_add_u32 s28, s28, 3072
    s_sub_u32 s34, s34, 1
    s_cmp_lg_u32 s34, 0
    s_cbranch_scc1 Lbl33
Lbskip32:
    s_cmp_eq_u32 s3, 0
    s_cbranch_scc1 Lbskip34
Lbl35:
    s_mov_b32 m0, s31
    s_add_u32 s31, s31, 1024
    buffer_load_dwordx4 v2, s[12:15], s29 offen offset:0 sc1 lds
    s_add_u32 s29, s29, 1024
    s_sub_u32 s35, s35, 1
    s_cmp_lg_u32 s35, 0
    s_cbranch_scc1 Lbl35
Lbskip34:
    v_and_b32 v12, 15, v1
    v_lshrrev_b32 v13, 4, v1
    s_lshl_b32 s27, s24, 2
    s_add_u32 s27, s27, s3
    s_waitcnt lgkmcnt(0)
    s_lshl_b32 s30, s27, 14
    s_add_u32 s30, s30, 0x740000
    s_lshl_b32 s31, s24, 13
    s_lshl_b32 s41, s3, 11
    s_add_u32 s31, s31, s41
    s_add_u32 s31, s31, 0x940000
    s_add_u32 s41, s41, 49152
    s_lshl_b32 s28, s3, 2
    s_add_u32 s28, s28, 49152
    v_lshl_add_u32 v3, v13, 10, s28
    v_lshl_add_u32 v3, v12, 4, v3
    v_lshlrev_b32 v8, 2, v12
    s_lshl_b32 s29, s27, 6
    s_add_u32 s29, s29, 0xbc2000
    s_sub_u32 s40, s29, 8192
    v_mov_b32 v7, v8
    v_add_u32 v4, 61440, v2
    v_add_u32 v5, 116736, v2
    v_and_b32 v6, 1, v1
    v_lshlrev_b32 v6, 4, v6
    v_lshl_add_u32 v6, v13, 5, v6
    v_add_u32 v6, 153600, v6
    v_and_b32 v10, 1, v13
    v_lshlrev_b32 v10, 9, v10
    v_lshrrev_b32 v14, 1, v13
    v_lshl_add_u32 v10, v14, 8, v10
    v_lshl_add_u32 v10, v12, 4, v10
    s_mul_i32 s35, s27, 18432
    s_lshl_b32 s28, s26, 9
    s_add_u32 s35, s35, s28
    s_add_u32 s35, s35, 0x980000
    s_mov_b32 s32, 0xffff0000
    s_lshl_b32 s33, s2, 7
    s_add_u32 s33, s33, 0xcd0000
    s_mul_i32 s27, s3, 12288
    s_sub_u32 s28, s48, s49
    s_add_u32 s28, s28, s27
    s_sub_u32 s28, s28, 4096
    s_waitcnt vmcnt(0)
    s_barrier
    ds_read_b128 a[72:75], v4 offset:0
    ds_read_b128 a[76:79], v4 offset:18432
    ds_read_b128 a[80:83], v4 offset:36864
    ds_read_b128 a[84:87], v5 offset:0
    ds_read_b128 a[88:91], v5 offset:18432
    ds_read_b128 a[92:95], v6 offset:0
    ds_read_b128 a[96:99], v4 offset:1024
    ds_read_b128 a[100:103], v4 offset:19456
    ds_read_b128 a[104:107], v4 offset:37888
    ds_read_b128 a[108:111], v5 offset:1024
    ds_read_b128 a[112:115], v5 offset:19456
    ds_read_b128 a[116:119], v6 offset:128
    s_waitcnt lgkmcnt(6)
    ds_read_b128 a[120:123], v4 offset:2048
    ds_read_b128 a[124:127], v4 offset:20480
    ds_read_b128 a[128:131], v4 offset:38912
    ds_read_b128 a[132:135], v5 offset:2048
    ds_read_b128 a[136:139], v5 offset:20480
    ds_read_b128 a[140:143], v6 offset:256
    s_waitcnt lgkmcnt(6)
    ds_read_b128 a[144:147], v4 offset:3072
    ds_read_b128 a[148:151], v4 offset:21504
    ds_read_b128 a[152:155], v4 offset:39936
    ds_read_b128 a[156:159], v5 offset:3072
    ds_read_b128 a[160:163], v5 offset:21504
    ds_read_b128 a[164:167], v6 offset:384
    buffer_load_dword v12, v9, s[12:15], 0 offen sc1
    s_waitcnt lgkmcnt(6)
    ds_read_b128 a[168:171], v4 offset:4096
    ds_read_b128 a[172:175], v4 offset:22528
    ds_read_b128 a[176:179], v4 offset:40960
    ds_read_b128 a[180:183], v5 offset:4096
    ds_read_b128 a[184:187], v5 offset:22528
    ds_read_b128 a[188:191], v6 offset:512
    s_waitcnt lgkmcnt(6)
    ds_read_b128 a[192:195], v4 offset:5120
    ds_read_b128 a[196:199], v4 offset:23552
    ds_read_b128 a[200:203], v4 offset:41984
    ds_read_b128 a[204:207], v5 offset:5120
    ds_read_b128 a[208:211], v5 offset:23552
    ds_read_b128 a[212:215], v6 offset:640
    s_waitcnt lgkmcnt(6)
    ds_read_b128 a[216:219], v4 offset:6144
    ds_read_b128 a[220:223], v4 offset:24576
    ds_read_b128 a[224:227], v4 offset:43008
    ds_read_b128 a[228:231], v5 offset:6144
    ds_read_b128 a[232:235], v5 offset:24576
    ds_read_b128 a[236:239], v6 offset:768
    s_mov_b32 s34, 0x40000
Lflp37:
    s_waitcnt vmcnt(0)
    v_cmp_ne_u32 vcc, 1, v12
    s_nop 4
    s_cbranch_vccz Lfok36
    s_sub_u32 s34, s34, 1
    s_cbranch_scc1 Lfok36
    buffer_load_dword v12, v9, s[12:15], 0 offen sc1
    s_branch Lflp37
Lfok36:
    buffer_load_dwordx4 a[0:3], v2, s[12:15], s30 offen offset:0 sc1
    buffer_load_dwordx4 a[4:7], v2, s[12:15], s30 offen offset:1024 sc1
    buffer_load_dwordx4 a[8:11], v2, s[12:15], s30 offen offset:2048 sc1
    buffer_load_dwordx4 a[12:15], v2, s[12:15], s30 offen offset:3072 sc1
    s_add_u32 s30, s30, 4096
    buffer_load_dwordx4 a[16:19], v2, s[12:15], s30 offen offset:0 sc1
    buffer_load_dwordx4 a[20:23], v2, s[12:15], s30 offen offset:1024 sc1
    buffer_load_dwordx4 a[24:27], v2, s[12:15], s30 offen offset:2048 sc1
    buffer_load_dwordx4 a[28:31], v2, s[12:15], s30 offen offset:3072 sc1
    s_add_u32 s30, s30, 4096
    s_waitcnt lgkmcnt(0)
    s_waitcnt vmcnt(7)
    v_mfma_f32_16x16x32_bf16 v[76:79], a[72:75], a[0:3], 0
    ds_read_b128 v[28:31], v4 offset:7168
    v_mfma_f32_16x16x32_bf16 v[80:83], a[76:79], a[0:3], 0
    s_mov_b32 m0, s41
    s_nop 0
    buffer_load_dwordx4 v2, s[12:15], s31 offen sc1 lds
    v_mfma_f32_16x16x32_bf16 v[84:87], a[80:83], a[0:3], 0
    ds_read_b128 v[32:35], v4 offset:25600
    v_mfma_f32_16x16x32_bf16 v[88:91], a[84:87], a[0:3], 0
    ds_read_b128 v[36:39], v4 offset:44032
    v_mfma_f32_16x16x32_bf16 v[92:95], a[88:91], a[0:3], 0
    buffer_load_dwordx4 v2, s[12:15], s31 offen offset:1024 sc1 lds
    v_mfma_f32_16x16x32_bf16 v[96:99], a[92:95], a[0:3], 0
    ds_read_b128 v[40:43], v5 offset:7168
    s_waitcnt vmcnt(8)
    v_mfma_f32_16x16x32_bf16 v[76:79], a[96:99], a[4:7], v[76:79]
    ds_read_b128 v[44:47], v5 offset:25600
    v_mfma_f32_16x16x32_bf16 v[80:83], a[100:103], a[4:7], v[80:83]
    buffer_load_dwordx4 a[32:35], v2, s[12:15], s30 offen offset:0 sc1
    v_mfma_f32_16x16x32_bf16 v[84:87], a[104:107], a[4:7], v[84:87]
    ds_read_b128 v[48:51], v6 offset:896
    v_mfma_f32_16x16x32_bf16 v[88:91], a[108:111], a[4:7], v[88:91]
    ds_read_b128 v[52:55], v4 offset:8192
    v_mfma_f32_16x16x32_bf16 v[92:95], a[112:115], a[4:7], v[92:95]
    buffer_load_dwordx4 a[36:39], v2, s[12:15], s30 offen offset:1024 sc1
    v_mfma_f32_16x16x32_bf16 v[96:99], a[116:119], a[4:7], v[96:99]
    ds_read_b128 v[56:59], v4 offset:26624
    s_waitcnt vmcnt(9)
    v_mfma_f32_16x16x32_bf16 v[76:79], a[120:123], a[8:11], v[76:79]
    ds_read_b128 v[60:63], v4 offset:45056
    v_mfma_f32_16x16x32_bf16 v[80:83], a[124:127], a[8:11], v[80:83]
    buffer_load_dwordx4 a[40:43], v2, s[12:15], s30 offen offset:2048 sc1
    v_mfma_f32_16x16x32_bf16 v[84:87], a[128:131], a[8:11], v[84:87]
    ds_read_b128 v[64:67], v5 offset:8192
    v_mfma_f32_16x16x32_bf16 v[88:91], a[132:135], a[8:11], v[88:91]
    ds_read_b128 v[68:71], v5 offset:26624
    v_mfma_f32_16x16x32_bf16 v[92:95], a[136:139], a[8:11], v[92:95]
    buffer_load_dwordx4 a[44:47], v2, s[12:15], s30 offen offset:3072 sc1
    s_add_u32 s30, s30, 4096
    v_mfma_f32_16x16x32_bf16 v[96:99], a[140:143], a[8:11], v[96:99]
    ds_read_b128 v[72:75], v6 offset:1024
    s_waitcnt vmcnt(10)
    v_mfma_f32_16x16x32_bf16 v[76:79], a[144:147], a[12:15], v[76:79]
    ds_read_b128 v[148:151], v4 offset:9216
    v_mfma_f32_16x16x32_bf16 v[80:83], a[148:151], a[12:15], v[80:83]
    buffer_load_dwordx4 a[48:51], v2, s[12:15], s30 offen offset:0 sc1
    v_mfma_f32_16x16x32_bf16 v[84:87], a[152:155], a[12:15], v[84:87]
    ds_read_b128 v[152:155], v4 offset:27648
    v_mfma_f32_16x16x32_bf16 v[88:91], a[156:159], a[12:15], v[88:91]
    ds_read_b128 v[156:159], v4 offset:46080
    v_mfma_f32_16x16x32_bf16 v[92:95], a[160:163], a[12:15], v[92:95]
    buffer_load_dwordx4 a[52:55], v2, s[12:15], s30 offen offset:1024 sc1
    v_mfma_f32_16x16x32_bf16 v[96:99], a[164:167], a[12:15], v[96:99]
    ds_read_b128 v[160:163], v5 offset:9216
    s_waitcnt vmcnt(11)
    v_mfma_f32_16x16x32_bf16 v[76:79], a[168:171], a[16:19], v[76:79]
    ds_read_b128 v[164:167], v5 offset:27648
    v_mfma_f32_16x16x32_bf16 v[80:83], a[172:175], a[16:19], v[80:83]
    buffer_load_dwordx4 a[56:59], v2, s[12:15], s30 offen offset:2048 sc1
    v_mfma_f32_16x16x32_bf16 v[84:87], a[176:179], a[16:19], v[84:87]
    ds_read_b128 v[168:171], v6 offset:1152
    v_mfma_f32_16x16x32_bf16 v[88:91], a[180:183], a[16:19], v[88:91]
    ds_read_b128 v[172:175], v4 offset:10240
    v_mfma_f32_16x16x32_bf16 v[92:95], a[184:187], a[16:19], v[92:95]
    buffer_load_dwordx4 a[60:63], v2, s[12:15], s30 offen offset:3072 sc1
    s_add_u32 s30, s30, 4096
    v_mfma_f32_16x16x32_bf16 v[96:99], a[188:191], a[16:19], v[96:99]
    ds_read_b128 v[176:179], v4 offset:28672
    s_waitcnt vmcnt(12)
    v_mfma_f32_16x16x32_bf16 v[76:79], a[192:195], a[20:23], v[76:79]
    ds_read_b128 v[180:183], v4 offset:47104
    v_mfma_f32_16x16x32_bf16 v[80:83], a[196:199], a[20:23], v[80:83]
    buffer_load_dword v11, v7, s[12:15], s40 offen sc1
    v_mfma_f32_16x16x32_bf16 v[84:87], a[200:203], a[20:23], v[84:87]
    ds_read_b128 v[184:187], v5 offset:10240
    v_mfma_f32_16x16x32_bf16 v[88:91], a[204:207], a[20:23], v[88:91]
    ds_read_b128 v[188:191], v5 offset:28672
    v_mfma_f32_16x16x32_bf16 v[92:95], a[208:211], a[20:23], v[92:95]
    s_add_u32 m0, s27, 0
    s_add_u32 s28, s28, 4096
    buffer_load_dwordx4 v2, s[12:15], s28 offen offset:0 sc1 lds
    v_mfma_f32_16x16x32_bf16 v[96:99], a[212:215], a[20:23], v[96:99]
    ds_read_b128 v[192:195], v6 offset:1280
    s_waitcnt vmcnt(13)
    v_mfma_f32_16x16x32_bf16 v[76:79], a[216:219], a[24:27], v[76:79]
    ds_read_b128 v[196:199], v4 offset:11264
    v_mfma_f32_16x16x32_bf16 v[80:83], a[220:223], a[24:27], v[80:83]
    buffer_load_dwordx4 v2, s[12:15], s28 offen offset:1024 sc1 lds
    v_mfma_f32_16x16x32_bf16 v[84:87], a[224:227], a[24:27], v[84:87]
    ds_read_b128 v[200:203], v4 offset:29696
    v_mfma_f32_16x16x32_bf16 v[88:91], a[228:231], a[24:27], v[88:91]
    ds_read_b128 v[204:207], v4 offset:48128
    v_mfma_f32_16x16x32_bf16 v[92:95], a[232:235], a[24:27], v[92:95]
    buffer_load_dwordx4 v2, s[12:15], s28 offen offset:2048 sc1 lds
    v_mfma_f32_16x16x32_bf16 v[96:99], a[236:239], a[24:27], v[96:99]
    ds_read_b128 v[208:211], v5 offset:11264
    s_waitcnt vmcnt(14) lgkmcnt(15)
    v_mfma_f32_16x16x32_bf16 v[76:79], v[28:31], a[28:31], v[76:79]
    ds_read_b128 v[212:215], v5 offset:29696
    v_mfma_f32_16x16x32_bf16 v[80:83], v[32:35], a[28:31], v[80:83]
    buffer_load_dwordx4 v2, s[12:15], s28 offen offset:3072 sc1 lds
    v_mfma_f32_16x16x32_bf16 v[84:87], v[36:39], a[28:31], v[84:87]
    ds_read_b128 v[216:219], v6 offset:1408
    v_mfma_f32_16x16x32_bf16 v[88:91], v[40:43], a[28:31], v[88:91]
    ds_read_b128 v[220:223], v4 offset:12288
    v_mfma_f32_16x16x32_bf16 v[92:95], v[44:47], a[28:31], v[92:95]
    s_add_u32 m0, s27, 4096
    s_add_u32 s28, s28, 4096
    buffer_load_dwordx4 v2, s[12:15], s28 offen offset:0 sc1 lds
    v_mfma_f32_16x16x32_bf16 v[96:99], v[48:51], a[28:31], v[96:99]
    ds_read_b128 v[224:227], v4 offset:30720
    s_waitcnt vmcnt(13) lgkmcnt(15)
    v_mfma_f32_16x16x32_bf16 v[76:79], v[52:55], a[32:35], v[76:79]
    ds_read_b128 v[28:31], v4 offset:49152
    v_mfma_f32_16x16x32_bf16 v[80:83], v[56:59], a[32:35], v[80:83]
    buffer_load_dwordx4 v2, s[12:15], s28 offen offset:1024 sc1 lds
    v_mfma_f32_16x16x32_bf16 v[84:87], v[60:63], a[32:35], v[84:87]
    ds_read_b128 v[32:35], v5 offset:12288
    v_mfma_f32_16x16x32_bf16 v[88:91], v[64:67], a[32:35], v[88:91]
    ds_read_b128 v[36:39], v5 offset:30720
    v_mfma_f32_16x16x32_bf16 v[92:95], v[68:71], a[32:35], v[92:95]
    buffer_load_dwordx4 v2, s[12:15], s28 offen offset:2048 sc1 lds
    v_mfma_f32_16x16x32_bf16 v[96:99], v[72:75], a[32:35], v[96:99]
    ds_read_b128 v[40:43], v6 offset:1536
    s_waitcnt vmcnt(14) lgkmcnt(15)
    v_mfma_f32_16x16x32_bf16 v[76:79], v[148:151], a[36:39], v[76:79]
    ds_read_b128 v[44:47], v4 offset:13312
    v_mfma_f32_16x16x32_bf16 v[80:83], v[152:155], a[36:39], v[80:83]
    buffer_load_dwordx4 v2, s[12:15], s28 offen offset:3072 sc1 lds
    v_mfma_f32_16x16x32_bf16 v[84:87], v[156:159], a[36:39], v[84:87]
    ds_read_b128 v[48:51], v4 offset:31744
    v_mfma_f32_16x16x32_bf16 v[88:91], v[160:163], a[36:39], v[88:91]
    ds_read_b128 v[52:55], v4 offset:50176
    v_mfma_f32_16x16x32_bf16 v[92:95], v[164:167], a[36:39], v[92:95]
    s_add_u32 m0, s27, 8192
    s_add_u32 s28, s28, 4096
    buffer_load_dwordx4 v2, s[12:15], s28 offen offset:0 sc1 lds
    v_mfma_f32_16x16x32_bf16 v[96:99], v[168:171], a[36:39], v[96:99]
    ds_read_b128 v[56:59], v5 offset:13312
    s_waitcnt vmcnt(15) lgkmcnt(15)
    s_barrier
    ds_read_b32 a64, v3 offset:0
    ds_read_b32 a65, v3 offset:256
    ds_read_b32 a66, v3 offset:512
    ds_read_b32 a67, v3 offset:768
    ds_read_b32 a68, v3 offset:4096
    ds_read_b32 a69, v3 offset:4352
    ds_read_b32 a70, v3 offset:4608
    ds_read_b32 a71, v3 offset:4864
    v_mfma_f32_16x16x32_bf16 v[76:79], v[172:175], a[40:43], v[76:79]
    ds_read_b128 v[60:63], v5 offset:31744
    v_mfma_f32_16x16x32_bf16 v[80:83], v[176:179], a[40:43], v[80:83]
    buffer_load_dwordx4 v2, s[12:15], s28 offen offset:1024 sc1 lds
    v_mfma_f32_16x16x32_bf16 v[84:87], v[180:183], a[40:43], v[84:87]
    ds_read_b128 v[64:67], v6 offset:1664
    v_mfma_f32_16x16x32_bf16 v[88:91], v[184:187], a[40:43], v[88:91]
    ds_read_b128 v[68:71], v4 offset:14336
    v_mfma_f32_16x16x32_bf16 v[92:95], v[188:191], a[40:43], v[92:95]
    buffer_load_dwordx4 v2, s[12:15], s28 offen offset:2048 sc1 lds
    v_mfma_f32_16x16x32_bf16 v[96:99], v[192:195], a[40:43], v[96:99]
    ds_read_b128 v[72:75], v4 offset:32768
    s_waitcnt vmcnt(16) lgkmcnt(14)
    v_mfma_f32_16x16x32_bf16 v[76:79], v[196:199], a[44:47], v[76:79]
    ds_read_b128 v[148:151], v4 offset:51200
    v_mfma_f32_16x16x32_bf16 v[80:83], v[200:203], a[44:47], v[80:83]
    buffer_load_dwordx4 v2, s[12:15], s28 offen offset:3072 sc1 lds
    v_mfma_f32_16x16x32_bf16 v[84:87], v[204:207], a[44:47], v[84:87]
    ds_read_b128 v[152:155], v5 offset:14336
    v_mfma_f32_16x16x32_bf16 v[88:91], v[208:211], a[44:47], v[88:91]
    ds_read_b128 v[156:159], v5 offset:32768
    v_mfma_f32_16x16x32_bf16 v[92:95], v[212:215], a[44:47], v[92:95]
    ds_read_b128 v[160:163], v6 offset:1792
    v_mfma_f32_16x16x32_bf16 v[96:99], v[216:219], a[44:47], v[96:99]
    ds_read_b128 v[164:167], v4 offset:15360
    s_waitcnt vmcnt(16) lgkmcnt(13)
    v_mfma_f32_16x16x32_bf16 v[76:79], v[220:223], a[48:51], v[76:79]
    ds_read_b128 v[168:171], v4 offset:33792
    v_mfma_f32_16x16x32_bf16 v[80:83], v[224:227], a[48:51], v[80:83]
    ds_read_b128 v[172:175], v4 offset:52224
    v_mfma_f32_16x16x32_bf16 v[84:87], v[28:31], a[48:51], v[84:87]
    ds_read_b128 v[176:179], v5 offset:15360
    v_mfma_f32_16x16x32_bf16 v[88:91], v[32:35], a[48:51], v[88:91]
    ds_read_b128 v[180:183], v5 offset:33792
    v_mfma_f32_16x16x32_bf16 v[92:95], v[36:39], a[48:51], v[92:95]
    ds_read_b128 v[184:187], v6 offset:1920
    v_mfma_f32_16x16x32_bf16 v[96:99], v[40:43], a[48:51], v[96:99]
    ds_read_b128 v[188:191], v4 offset:16384
    s_waitcnt vmcnt(15) lgkmcnt(13)
    v_mfma_f32_16x16x32_bf16 v[76:79], v[44:47], a[52:55], v[76:79]
    ds_read_b128 v[192:195], v4 offset:34816
    v_mfma_f32_16x16x32_bf16 v[80:83], v[48:51], a[52:55], v[80:83]
    ds_read_b128 v[196:199], v4 offset:53248
    v_mfma_f32_16x16x32_bf16 v[84:87], v[52:55], a[52:55], v[84:87]
    ds_read_b128 v[200:203], v5 offset:16384
    v_mfma_f32_16x16x32_bf16 v[88:91], v[56:59], a[52:55], v[88:91]
    ds_read_b128 v[204:207], v5 offset:34816
    v_mfma_f32_16x16x32_bf16 v[92:95], v[60:63], a[52:55], v[92:95]
    ds_read_b128 v[208:211], v6 offset:2048
    v_mfma_f32_16x16x32_bf16 v[96:99], v[64:67], a[52:55], v[96:99]
    ds_read_b128 v[212:215], v4 offset:17408
    s_waitcnt vmcnt(14) lgkmcnt(13)
    v_mfma_f32_16x16x32_bf16 v[76:79], v[68:71], a[56:59], v[76:79]
    v_mfma_f32_16x16x32_bf16 v[80:83], v[72:75], a[56:59], v[80:83]
    ds_read_b128 v[216:219], v4 offset:35840
    v_mfma_f32_16x16x32_bf16 v[84:87], v[148:151], a[56:59], v[84:87]
    ds_read_b128 v[220:223], v4 offset:54272
    v_mfma_f32_16x16x32_bf16 v[88:91], v[152:155], a[56:59], v[88:91]
    ds_read_b128 v[224:227], v5 offset:17408
    v_mfma_f32_16x16x32_bf16 v[92:95], v[156:159], a[56:59], v[92:95]
    v_mfma_f32_16x16x32_bf16 v[96:99], v[160:163], a[56:59], v[96:99]
    ds_read_b128 v[28:31], v5 offset:35840
    s_waitcnt vmcnt(13) lgkmcnt(11)
    v_mfma_f32_16x16x32_bf16 v[76:79], v[164:167], a[60:63], v[76:79]
    ds_read_b128 v[32:35], v6 offset:2176
    v_mfma_f32_16x16x32_bf16 v[80:83], v[168:171], a[60:63], v[80:83]
    v_mfma_f32_16x16x32_bf16 v[84:87], v[172:175], a[60:63], v[84:87]
    v_mfma_f32_16x16x32_bf16 v[88:91], v[176:179], a[60:63], v[88:91]
    v_mfma_f32_16x16x32_bf16 v[92:95], v[180:183], a[60:63], v[92:95]
    v_mfma_f32_16x16x32_bf16 v[96:99], v[184:187], a[60:63], v[96:99]
    s_waitcnt lgkmcnt(6)
    v_mfma_f32_16x16x32_bf16 v[76:79], v[188:191], a[64:67], v[76:79]
    v_mfma_f32_16x16x32_bf16 v[80:83], v[192:195], a[64:67], v[80:83]
    v_mfma_f32_16x16x32_bf16 v[84:87], v[196:199], a[64:67], v[84:87]
    v_mfma_f32_16x16x32_bf16 v[88:91], v[200:203], a[64:67], v[88:91]
    v_mfma_f32_16x16x32_bf16 v[92:95], v[204:207], a[64:67], v[92:95]
    v_mfma_f32_16x16x32_bf16 v[96:99], v[208:211], a[64:67], v[96:99]
    s_waitcnt lgkmcnt(0)
    v_mfma_f32_16x16x32_bf16 v[76:79], v[212:215], a[68:71], v[76:79]
    v_mfma_f32_16x16x32_bf16 v[80:83], v[216:219], a[68:71], v[80:83]
    v_mfma_f32_16x16x32_bf16 v[84:87], v[220:223], a[68:71], v[84:87]
    v_mfma_f32_16x16x32_bf16 v[88:91], v[224:227], a[68:71], v[88:91]
    v_mfma_f32_16x16x32_bf16 v[92:95], v[28:31], a[68:71], v[92:95]
    v_mfma_f32_16x16x32_bf16 v[96:99], v[32:35], a[68:71], v[96:99]
    v_lshlrev_b32 v100, 16, v228
    v_and_b32 v101, s32, v228
    v_lshlrev_b32 v102, 16, v229
    v_and_b32 v103, s32, v229
    v_lshlrev_b32 v104, 16, v230
    v_and_b32 v105, s32, v230
    v_lshlrev_b32 v106, 16, v231
    v_and_b32 v107, s32, v231
    v_lshlrev_b32 v108, 16, v232
    v_and_b32 v109, s32, v232
    v_lshlrev_b32 v110, 16, v233
    v_and_b32 v111, s32, v233
    v_lshlrev_b32 v112, 16, v234
    v_and_b32 v113, s32, v234
    v_lshlrev_b32 v114, 16, v235
    v_and_b32 v115, s32, v235
    v_lshlrev_b32 v116, 16, v236
    v_and_b32 v117, s32, v236
    v_lshlrev_b32 v118, 16, v237
    v_and_b32 v119, s32, v237
    s_waitcnt vmcnt(12)
    v_add_f32 v124, v96, v97
    v_add_f32 v124, v124, v11
    v_mov_b32 v126, 0
    v_mov_b32 v127, 0
    v_pk_add_f32 v[76:77], v[76:77], v[100:101]
    v_pk_add_f32 v[78:79], v[78:79], v[102:103]
    v_pk_add_f32 v[76:77], v[76:77], v[124:125] op_sel_hi:[1,0] neg_lo:[0,1] neg_hi:[0,1]
    v_pk_add_f32 v[78:79], v[78:79], v[124:125] op_sel_hi:[1,0] neg_lo:[0,1] neg_hi:[0,1]
    v_cvt_pk_bf16_f32 v128, v76, v77
    v_cvt_pk_bf16_f32 v129, v78, v79
    v_pk_fma_f32 v[126:127], v[76:77], v[76:77], v[126:127]
    v_pk_fma_f32 v[126:127], v[78:79], v[78:79], v[126:127]
    v_pk_add_f32 v[80:81], v[80:81], v[104:105]
    v_pk_add_f32 v[82:83], v[82:83], v[106:107]
    v_pk_add_f32 v[80:81], v[80:81], v[124:125] op_sel_hi:[1,0] neg_lo:[0,1] neg_hi:[0,1]
    v_pk_add_f32 v[82:83], v[82:83], v[124:125] op_sel_hi:[1,0] neg_lo:[0,1] neg_hi:[0,1]
    v_cvt_pk_bf16_f32 v130, v80, v81
    v_cvt_pk_bf16_f32 v131, v82, v83
    v_pk_fma_f32 v[126:127], v[80:81], v[80:81], v[126:127]
    v_pk_fma_f32 v[126:127], v[82:83], v[82:83], v[126:127]
    v_permlane16_swap_b32 v128, v130
    v_permlane16_swap_b32 v129, v131
    buffer_store_dwordx4 v[128:131], v10, s[12:15], s35 offen offset:0 sc1
    v_pk_add_f32 v[84:85], v[84:85], v[108:109]
    v_pk_add_f32 v[86:87], v[86:87], v[110:111]
    v_pk_add_f32 v[84:85], v[84:85], v[124:125] op_sel_hi:[1,0] neg_lo:[0,1] neg_hi:[0,1]
    v_pk_add_f32 v[86:87], v[86:87], v[124:125] op_sel_hi:[1,0] neg_lo:[0,1] neg_hi:[0,1]
    v_cvt_pk_bf16_f32 v132, v84, v85
    v_cvt_pk_bf16_f32 v133, v86, v87
    v_pk_fma_f32 v[126:127], v[84:85], v[84:85], v[126:127]
    v_pk_fma_f32 v[126:127], v[86:87], v[86:87], v[126:127]
    v_pk_add_f32 v[88:89], v[88:89], v[112:113]
    v_pk_add_f32 v[90:91], v[90:91], v[114:115]
    v_pk_add_f32 v[88:89], v[88:89], v[124:125] op_sel_hi:[1,0] neg_lo:[0,1] neg_hi:[0,1]
    v_pk_add_f32 v[90:91], v[90:91], v[124:125] op_sel_hi:[1,0] neg_lo:[0,1] neg_hi:[0,1]
    v_cvt_pk_bf16_f32 v134, v88, v89
    v_cvt_pk_bf16_f32 v135, v90, v91
    v_pk_fma_f32 v[126:127], v[88:89], v[88:89], v[126:127]
    v_pk_fma_f32 v[126:127], v[90:91], v[90:91], v[126:127]
    v_permlane16_swap_b32 v132, v134
    v_permlane16_swap_b32 v133, v135
    buffer_store_dwordx4 v[132:135], v10, s[12:15], s35 offen offset:1024 sc1
    s_cmp_ge_u32 s25, 4
    s_cbranch_scc1 Lno5b38
    v_pk_add_f32 v[92:93], v[92:93], v[116:117]
    v_pk_add_f32 v[94:95], v[94:95], v[118:119]
    v_pk_add_f32 v[92:93], v[92:93], v[124:125] op_sel_hi:[1,0] neg_lo:[0,1] neg_hi:[0,1]
    v_pk_add_f32 v[94:95], v[94:95], v[124:125] op_sel_hi:[1,0] neg_lo:[0,1] neg_hi:[0,1]
    v_cvt_pk_bf16_f32 v136, v92, v93
    v_cvt_pk_bf16_f32 v137, v94, v95
    v_pk_fma_f32 v[126:127], v[92:93], v[92:93], v[126:127]
    v_pk_fma_f32 v[126:127], v[94:95], v[94:95], v[126:127]
    v_permlane16_swap_b32 v136, v138
    v_permlane16_swap_b32 v137, v139
    s_mov_b32 exec_lo, 0xffff
    s_mov_b32 exec_hi, 0xffff
    buffer_store_dwordx4 v[136:139], v10, s[12:15], s35 offen offset:2048 sc1
    s_mov_b64 exec, -1
Lno5b38:
    v_add_f32 v126, v126, v127
    v_mov_b32 v127, v126
    s_nop 1
    v_permlane16_swap_b32 v126, v127
    v_add_f32 v126, v126, v127
    v_mov_b32 v127, v126
    s_nop 1
    v_permlane32_swap_b32 v126, v127
    v_add_f32 v140, v126, v127
    v_mov_b32 v144, v124
    v_mov_b32_dpp v145, v124 quad_perm:[1,1,1,1] row_mask:0xf bank_mask:0xf
    v_mov_b32_dpp v141, v140 quad_perm:[1,1,1,1] row_mask:0xf bank_mask:0xf
    v_mov_b32_dpp v146, v124 quad_perm:[2,2,2,2] row_mask:0xf bank_mask:0xf
    v_mov_b32_dpp v142, v140 quad_perm:[2,2,2,2] row_mask:0xf bank_mask:0xf
    v_mov_b32_dpp v147, v124 quad_perm:[3,3,3,3] row_mask:0xf bank_mask:0xf
    v_mov_b32_dpp v143, v140 quad_perm:[3,3,3,3] row_mask:0xf bank_mask:0xf
    s_lshl_b32 s28, s24, 11
    s_lshl_b32 s27, s25, 8
    s_add_u32 s28, s28, s27
    s_lshl_b32 s27, s3, 6
    s_add_u32 s28, s28, s27
    s_add_u32 s28, s28, 0xbc4000
    s_cmp_lg_u32 s25, 0
    s_cselect_b32 s29, 0x7f000000, s29
    s_mov_b64 exec, 0x1111
    buffer_store_dwordx4 v[140:143], v8, s[12:15], s28 offen sc1
    buffer_store_dwordx4 v[144:147], v8, s[12:15], s29 offen sc1
    s_mov_b64 exec, -1
    v_mov_b32 v12, 0
    v_mov_b32 v13, 1
    s_waitcnt vmcnt(0)
    s_barrier
    s_cmp_lg_u32 s3, 1
    s_cbranch_scc1 Lnosig39
    s_mov_b64 exec, 1
    buffer_store_dword v13, v12, s[12:15], s33 offen sc1
    s_mov_b64 exec, -1
Lnosig39:
p4_start:
    s_sub_u32 s26, s3, 1
    s_mul_i32 s26, s26, 20480
    s_add_u32 s26, s26, 49152
    s_sub_u32 s27, s48, s49
    s_add_u32 s27, s27, s26
    s_mov_b32 s32, 5
    s_cmp_eq_u32 s3, 0
    s_cbranch_scc1 Lbskip40
Lbl41:
    s_mov_b32 m0, s26
    s_add_u32 s26, s26, 4096
    buffer_load_dwordx4 v2, s[12:15], s27 offen offset:0 sc1 lds
    buffer_load_dwordx4 v2, s[12:15], s27 offen offset:1024 sc1 lds
    buffer_load_dwordx4 v2, s[12:15], s27 offen offset:2048 sc1 lds
    buffer_load_dwordx4 v2, s[12:15], s27 offen offset:3072 sc1 lds
    s_add_u32 s27, s27, 4096
    s_sub_u32 s32, s32, 1
    s_cmp_lg_u32 s32, 0
    s_cbranch_scc1 Lbl41
Lbskip40:
    s_add_u32 s48, s48, 110592
    s_add_u32 s49, s49, 110592
    s_and_b32 s24, s2, 4
    s_bfe_u32 s26, s2, 0x20003
    s_add_u32 s24, s24, s26
    s_and_b32 s25, s2, 3
    s_lshl_b32 s25, s25, 3
    s_lshr_b32 s26, s2, 5
    s_add_u32 s25, s25, s26
    s_lshl_b32 s26, s24, 3
    s_lshl_b32 s27, s3, 1
    s_add_u32 s26, s26, s27
    s_mul_i32 s28, s26, 36864
    s_add_u32 s28, s28, 0x980000
    s_add_u32 s29, s28, 36864
    s_mul_i32 s30, s26, 294912
    s_and_b32 s27, s2, 3
    s_mul_i32 s27, s27, 36864
    s_add_u32 s30, s30, s27
    s_lshr_b32 s27, s2, 5
    s_lshl_b32 s27, s27, 9
    s_add_u32 s30, s30, s27
    s_add_u32 s30, s30, 0x1e00000
    s_add_u32 s31, s30, 294912
    s_lshl_b32 s26, s26, 10
    s_add_u32 s26, s26, 0xbc4000
    v_lshlrev_b32 v6, 2, v1
    v_lshrrev_b32 v7, 5, v1
    s_lshl_b32 s35, s2, 7
    s_add_u32 s35, s35, 0xcd8000
    s_lshr_b32 s34, s2, 6
    s_lshl_b32 s34, s34, 2
    s_and_b32 s27, s2, 3
    s_add_u32 s34, s34, s27
    s_mul_i32 s34, s34, 331776
    s_mul_i32 s27, s3, 9216
    s_add_u32 s34, s34, s27
    s_add_u32 s34, s34, 0x1800000
    v_bfe_u32 v5, v1, 4, 1
    v_mul_u32_u24 v5, 147456, v5
    v_lshl_add_u32 v5, v7, 8, v5
    v_and_b32 v7, 15, v1
    v_lshl_add_u32 v5, v7, 4, v5
    v_add_u32 v255, 18432, v2
    v_add_u32 v12, 36864, v2
    v_add_u32 v13, 73728, v2
    v_add_u32 v4, 110592, v2
    s_mov_b32 s33, 0
    v_lshl_add_u32 v14, v1, 3, s24
    v_lshlrev_b32 v14, 7, v14
    v_add_u32 v14, 0xcd0000, v14
    s_and_b32 s27, s2, 3
    s_mul_i32 s27, s27, 81
    s_add_u32 s27, s27, 648
    s_lshr_b32 s27, s27, 2
    v_and_b32 v7, 31, v1
    v_add_u32 v7, s27, v7
    s_and_b32 s27, s2, 0xfc
    v_and_b32 v15, 3, v1
    v_add_u32 v15, s27, v15
    v_cmp_lt_u32 vcc, 53, v1
    s_nop 1
    v_cndmask_b32 v7, v7, v15, vcc
    v_lshlrev_b32 v7, 7, v7
    v_add_u32 v7, 0xcc8000, v7
    v_cmp_gt_u32 vcc, 32, v1
    s_nop 1
    v_cndmask_b32 v14, v7, v14, vcc
    s_cmp_lg_u32 s3, 0
    s_cbranch_scc1 Lnopoll42
    s_mov_b32 s32, 0x40000
Lpoll43:
    s_sub_u32 s32, s32, 1
    s_cbranch_scc1 Lnopoll42
    buffer_load_dword v7, v14, s[12:15], 0 offen sc1
    s_waitcnt vmcnt(0)
    v_cmp_ne_u32 vcc, 1, v7
    s_nop 4
    s_cbranch_vccnz Lpoll43
Lnopoll42:
    s_waitcnt vmcnt(0)
    s_barrier
    buffer_load_dwordx4 a[0:3], v2, s[12:15], s28 offen offset:0 sc1
    buffer_load_dwordx4 a[4:7], v255, s[12:15], s28 offen offset:0 sc1
    buffer_load_dwordx4 a[8:11], v2, s[12:15], s29 offen offset:0 sc1
    buffer_load_dwordx4 a[12:15], v255, s[12:15], s29 offen offset:0 sc1
    ds_read_b128 v[16:19], v2 offset:0
    ds_read_b128 v[20:23], v12 offset:0
    ds_read_b128 v[24:27], v13 offset:0
    buffer_load_dwordx4 a[16:19], v2, s[12:15], s28 offen offset:1024 sc1
    buffer_load_dwordx4 a[20:23], v255, s[12:15], s28 offen offset:1024 sc1
    buffer_load_dwordx4 a[24:27], v2, s[12:15], s29 offen offset:1024 sc1
    buffer_load_dwordx4 a[28:31], v255, s[12:15], s29 offen offset:1024 sc1
    buffer_load_dwordx4 a[32:35], v2, s[12:15], s28 offen offset:2048 sc1
    buffer_load_dwordx4 a[36:39], v255, s[12:15], s28 offen offset:2048 sc1
    buffer_load_dwordx4 a[40:43], v2, s[12:15], s29 offen offset:2048 sc1
    buffer_load_dwordx4 a[44:47], v255, s[12:15], s29 offen offset:2048 sc1
    s_waitcnt vmcnt(8) lgkmcnt(0)
    v_mfma_f32_16x16x32_bf16 v[104:107], v[16:19], a[0:3], 0
    ds_read_b128 v[28:31], v2 offset:1024
    v_mfma_f32_16x16x32_bf16 v[112:115], v[16:19], a[4:7], 0
    v_mfma_f32_16x16x32_bf16 v[120:123], v[16:19], a[8:11], 0
    ds_read_b128 v[32:35], v12 offset:1024
    v_mfma_f32_16x16x32_bf16 v[128:131], v[16:19], a[12:15], 0
    v_mfma_f32_16x16x32_bf16 v[136:139], v[20:23], a[0:3], 0
    ds_read_b128 v[36:39], v13 offset:1024
    v_mfma_f32_16x16x32_bf16 v[144:147], v[20:23], a[4:7], 0
    v_mfma_f32_16x16x32_bf16 v[152:155], v[20:23], a[8:11], 0
    buffer_load_dwordx4 a[48:51], v2, s[12:15], s28 offen offset:3072 sc1
    v_mfma_f32_16x16x32_bf16 v[160:163], v[20:23], a[12:15], 0
    v_mfma_f32_16x16x32_bf16 v[168:171], v[24:27], a[0:3], 0
    v_mfma_f32_16x16x32_bf16 v[176:179], v[24:27], a[4:7], 0
    buffer_load_dwordx4 a[52:55], v255, s[12:15], s28 offen offset:3072 sc1
    s_add_u32 s28, s28, 4096
    v_mfma_f32_16x16x32_bf16 v[184:187], v[24:27], a[8:11], 0
    v_mfma_f32_16x16x32_bf16 v[192:195], v[24:27], a[12:15], 0
    s_waitcnt lgkmcnt(0)
    v_mfma_f32_16x16x32_bf16 v[108:111], v[28:31], a[0:3], 0
    ds_read_b128 v[16:19], v2 offset:2048
    v_mfma_f32_16x16x32_bf16 v[116:119], v[28:31], a[4:7], 0
    v_mfma_f32_16x16x32_bf16 v[124:127], v[28:31], a[8:11], 0
    ds_read_b128 v[20:23], v12 offset:2048
    v_mfma_f32_16x16x32_bf16 v[132:135], v[28:31], a[12:15], 0
    v_mfma_f32_16x16x32_bf16 v[140:143], v[32:35], a[0:3], 0
    ds_read_b128 v[24:27], v13 offset:2048
    v_mfma_f32_16x16x32_bf16 v[148:151], v[32:35], a[4:7], 0
    v_mfma_f32_16x16x32_bf16 v[156:159], v[32:35], a[8:11], 0
    buffer_load_dwordx4 a[56:59], v2, s[12:15], s29 offen offset:3072 sc1
    v_mfma_f32_16x16x32_bf16 v[164:167], v[32:35], a[12:15], 0
    v_mfma_f32_16x16x32_bf16 v[172:175], v[36:39], a[0:3], 0
    v_mfma_f32_16x16x32_bf16 v[180:183], v[36:39], a[4:7], 0
    buffer_load_dwordx4 a[60:63], v255, s[12:15], s29 offen offset:3072 sc1
    s_add_u32 s29, s29, 4096
    v_mfma_f32_16x16x32_bf16 v[188:191], v[36:39], a[8:11], 0
    v_mfma_f32_16x16x32_bf16 v[196:199], v[36:39], a[12:15], 0
    s_waitcnt vmcnt(8) lgkmcnt(0)
    v_mfma_f32_16x16x32_bf16 v[104:107], v[16:19], a[16:19], v[104:107]
    ds_read_b128 v[28:31], v2 offset:3072
    v_mfma_f32_16x16x32_bf16 v[112:115], v[16:19], a[20:23], v[112:115]
    s_and_b32 s50, s2, 3
    v_mfma_f32_16x16x32_bf16 v[120:123], v[16:19], a[24:27], v[120:123]
    ds_read_b128 v[32:35], v12 offset:3072
    v_mfma_f32_16x16x32_bf16 v[128:131], v[16:19], a[28:31], v[128:131]
    s_and_b32 s51, s2, 4
    v_mfma_f32_16x16x32_bf16 v[136:139], v[20:23], a[16:19], v[136:139]
    ds_read_b128 v[36:39], v13 offset:3072
    v_mfma_f32_16x16x32_bf16 v[144:147], v[20:23], a[20:23], v[144:147]
    s_lshl_b32 s51, s51, 1
    v_mfma_f32_16x16x32_bf16 v[152:155], v[20:23], a[24:27], v[152:155]
    buffer_load_dwordx4 a[64:67], v2, s[12:15], s28 offen offset:0 sc1
    v_mfma_f32_16x16x32_bf16 v[160:163], v[20:23], a[28:31], v[160:163]
    s_bfe_u32 s53, s2, 0x30003
    v_mfma_f32_16x16x32_bf16 v[168:171], v[24:27], a[16:19], v[168:171]
    v_mfma_f32_16x16x32_bf16 v[176:179], v[24:27], a[20:23], v[176:179]
    buffer_load_dwordx4 a[68:71], v255, s[12:15], s28 offen offset:0 sc1
    v_mfma_f32_16x16x32_bf16 v[184:187], v[24:27], a[24:27], v[184:187]
    v_mfma_f32_16x16x32_bf16 v[192:195], v[24:27], a[28:31], v[192:195]
    s_waitcnt lgkmcnt(0)
    v_mfma_f32_16x16x32_bf16 v[108:111], v[28:31], a[16:19], v[108:111]
    ds_read_b128 v[16:19], v2 offset:4096
    v_mfma_f32_16x16x32_bf16 v[116:119], v[28:31], a[20:23], v[116:119]
    s_add_u32 s51, s51, s53
    v_mfma_f32_16x16x32_bf16 v[124:127], v[28:31], a[24:27], v[124:127]
    ds_read_b128 v[20:23], v12 offset:4096
    v_mfma_f32_16x16x32_bf16 v[132:135], v[28:31], a[28:31], v[132:135]
    s_lshr_b32 s52, s2, 6
    v_mfma_f32_16x16x32_bf16 v[140:143], v[32:35], a[16:19], v[140:143]
    ds_read_b128 v[24:27], v13 offset:4096
    v_mfma_f32_16x16x32_bf16 v[148:151], v[32:35], a[20:23], v[148:151]
    s_lshr_b32 s53, s51, 1
    v_mfma_f32_16x16x32_bf16 v[156:159], v[32:35], a[24:27], v[156:159]
    buffer_load_dwordx4 a[72:75], v2, s[12:15], s29 offen offset:0 sc1
    v_mfma_f32_16x16x32_bf16 v[164:167], v[32:35], a[28:31], v[164:167]
    s_and_b32 s54, s53, 3
    v_mfma_f32_16x16x32_bf16 v[172:175], v[36:39], a[16:19], v[172:175]
    v_mfma_f32_16x16x32_bf16 v[180:183], v[36:39], a[20:23], v[180:183]
    buffer_load_dwordx4 a[76:79], v255, s[12:15], s29 offen offset:0 sc1
    v_mfma_f32_16x16x32_bf16 v[188:191], v[36:39], a[24:27], v[188:191]
    v_mfma_f32_16x16x32_bf16 v[196:199], v[36:39], a[28:31], v[196:199]
    s_waitcnt vmcnt(8) lgkmcnt(0)
    v_mfma_f32_16x16x32_bf16 v[104:107], v[16:19], a[32:35], v[104:107]
    ds_read_b128 v[28:31], v2 offset:5120
    v_mfma_f32_16x16x32_bf16 v[112:115], v[16:19], a[36:39], v[112:115]
    s_lshl_b32 s54, s54, 3
    v_mfma_f32_16x16x32_bf16 v[120:123], v[16:19], a[40:43], v[120:123]
    ds_read_b128 v[32:35], v12 offset:5120
    v_mfma_f32_16x16x32_bf16 v[128:131], v[16:19], a[44:47], v[128:131]
    s_and_b32 s53, s53, 4
    v_mfma_f32_16x16x32_bf16 v[136:139], v[20:23], a[32:35], v[136:139]
    ds_read_b128 v[36:39], v13 offset:5120
    v_mfma_f32_16x16x32_bf16 v[144:147], v[20:23], a[36:39], v[144:147]
    s_add_u32 s53, s53, s54
    v_mfma_f32_16x16x32_bf16 v[152:155], v[20:23], a[40:43], v[152:155]
    buffer_load_dwordx4 a[80:83], v2, s[12:15], s28 offen offset:1024 sc1
    v_mfma_f32_16x16x32_bf16 v[160:163], v[20:23], a[44:47], v[160:163]
    s_add_u32 s53, s53, s50
    v_mfma_f32_16x16x32_bf16 v[168:171], v[24:27], a[32:35], v[168:171]
    v_mfma_f32_16x16x32_bf16 v[176:179], v[24:27], a[36:39], v[176:179]
    buffer_load_dwordx4 a[84:87], v255, s[12:15], s28 offen offset:1024 sc1
    v_mfma_f32_16x16x32_bf16 v[184:187], v[24:27], a[40:43], v[184:187]
    v_mfma_f32_16x16x32_bf16 v[192:195], v[24:27], a[44:47], v[192:195]
    s_waitcnt lgkmcnt(0)
    v_mfma_f32_16x16x32_bf16 v[108:111], v[28:31], a[32:35], v[108:111]
    ds_read_b128 v[16:19], v2 offset:6144
    v_mfma_f32_16x16x32_bf16 v[116:119], v[28:31], a[36:39], v[116:119]
    s_lshl_b32 s53, s53, 7
    v_mfma_f32_16x16x32_bf16 v[124:127], v[28:31], a[40:43], v[124:127]
    ds_read_b128 v[20:23], v12 offset:6144
    v_mfma_f32_16x16x32_bf16 v[132:135], v[28:31], a[44:47], v[132:135]
    s_add_u32 s53, s53, 0xcd8000
    v_mfma_f32_16x16x32_bf16 v[140:143], v[32:35], a[32:35], v[140:143]
    ds_read_b128 v[24:27], v13 offset:6144
    v_mfma_f32_16x16x32_bf16 v[148:151], v[32:35], a[36:39], v[148:151]
    v_and_b32 v244, 7, v1
    v_mfma_f32_16x16x32_bf16 v[156:159], v[32:35], a[40:43], v[156:159]
    buffer_load_dwordx4 a[88:91], v2, s[12:15], s29 offen offset:1024 sc1
    v_mfma_f32_16x16x32_bf16 v[164:167], v[32:35], a[44:47], v[164:167]
    v_lshl_add_u32 v244, v244, 12, s53
    v_mfma_f32_16x16x32_bf16 v[172:175], v[36:39], a[32:35], v[172:175]
    v_mfma_f32_16x16x32_bf16 v[180:183], v[36:39], a[36:39], v[180:183]
    buffer_load_dwordx4 a[92:95], v255, s[12:15], s29 offen offset:1024 sc1
    v_mfma_f32_16x16x32_bf16 v[188:191], v[36:39], a[40:43], v[188:191]
    v_mfma_f32_16x16x32_bf16 v[196:199], v[36:39], a[44:47], v[196:199]
    s_waitcnt vmcnt(8) lgkmcnt(0)
    v_mfma_f32_16x16x32_bf16 v[104:107], v[16:19], a[48:51], v[104:107]
    ds_read_b128 v[28:31], v2 offset:7168
    v_mfma_f32_16x16x32_bf16 v[112:115], v[16:19], a[52:55], v[112:115]
    s_lshl_b32 s59, s51, 3
    v_mfma_f32_16x16x32_bf16 v[120:123], v[16:19], a[56:59], v[120:123]
    ds_read_b128 v[32:35], v12 offset:7168
    v_mfma_f32_16x16x32_bf16 v[128:131], v[16:19], a[60:63], v[128:131]
    s_lshl_b32 s54, s3, 1
    v_mfma_f32_16x16x32_bf16 v[136:139], v[20:23], a[48:51], v[136:139]
    ds_read_b128 v[36:39], v13 offset:7168
    v_mfma_f32_16x16x32_bf16 v[144:147], v[20:23], a[52:55], v[144:147]
    s_add_u32 s59, s59, s54
    v_mfma_f32_16x16x32_bf16 v[152:155], v[20:23], a[56:59], v[152:155]
    buffer_load_dwordx4 a[96:99], v2, s[12:15], s28 offen offset:2048 sc1
    v_mfma_f32_16x16x32_bf16 v[160:163], v[20:23], a[60:63], v[160:163]
    s_mul_i32 s56, s59, 147456
    v_mfma_f32_16x16x32_bf16 v[168:171], v[24:27], a[48:51], v[168:171]
    v_mfma_f32_16x16x32_bf16 v[176:179], v[24:27], a[52:55], v[176:179]
    buffer_load_dwordx4 a[100:103], v255, s[12:15], s28 offen offset:2048 sc1
    v_mfma_f32_16x16x32_bf16 v[184:187], v[24:27], a[56:59], v[184:187]
    v_mfma_f32_16x16x32_bf16 v[192:195], v[24:27], a[60:63], v[192:195]
    s_waitcnt lgkmcnt(0)
    v_mfma_f32_16x16x32_bf16 v[108:111], v[28:31], a[48:51], v[108:111]
    ds_read_b128 v[16:19], v2 offset:8192
    v_mfma_f32_16x16x32_bf16 v[116:119], v[28:31], a[52:55], v[116:119]
    s_mul_i32 s54, s50, 36864
    v_mfma_f32_16x16x32_bf16 v[124:127], v[28:31], a[56:59], v[124:127]
    ds_read_b128 v[20:23], v12 offset:8192
    v_mfma_f32_16x16x32_bf16 v[132:135], v[28:31], a[60:63], v[132:135]
    s_add_u32 s56, s56, s54
    v_mfma_f32_16x16x32_bf16 v[140:143], v[32:35], a[48:51], v[140:143]
    ds_read_b128 v[24:27], v13 offset:8192
    v_mfma_f32_16x16x32_bf16 v[148:151], v[32:35], a[52:55], v[148:151]
    s_add_u32 s56, s56, 0x1e00000
    v_mfma_f32_16x16x32_bf16 v[156:159], v[32:35], a[56:59], v[156:159]
    buffer_load_dwordx4 a[104:107], v2, s[12:15], s29 offen offset:2048 sc1
    v_mfma_f32_16x16x32_bf16 v[164:167], v[32:35], a[60:63], v[164:167]
    v_add_u32 v254, 147456, v2
    v_mfma_f32_16x16x32_bf16 v[172:175], v[36:39], a[48:51], v[172:175]
    v_mfma_f32_16x16x32_bf16 v[180:183], v[36:39], a[52:55], v[180:183]
    buffer_load_dwordx4 a[108:111], v255, s[12:15], s29 offen offset:2048 sc1
    v_mfma_f32_16x16x32_bf16 v[188:191], v[36:39], a[56:59], v[188:191]
    v_mfma_f32_16x16x32_bf16 v[196:199], v[36:39], a[60:63], v[196:199]
    s_waitcnt vmcnt(8) lgkmcnt(0)
    v_mfma_f32_16x16x32_bf16 v[104:107], v[16:19], a[64:67], v[104:107]
    ds_read_b128 v[28:31], v2 offset:9216
    v_mfma_f32_16x16x32_bf16 v[112:115], v[16:19], a[68:71], v[112:115]
    s_mul_i32 s55, s3, 9216
    v_mfma_f32_16x16x32_bf16 v[120:123], v[16:19], a[72:75], v[120:123]
    ds_read_b128 v[32:35], v12 offset:9216
    v_mfma_f32_16x16x32_bf16 v[128:131], v[16:19], a[76:79], v[128:131]
    v_add_u32 v241, 36864, v2
    v_mfma_f32_16x16x32_bf16 v[136:139], v[20:23], a[64:67], v[136:139]
    ds_read_b128 v[36:39], v13 offset:9216
    v_mfma_f32_16x16x32_bf16 v[144:147], v[20:23], a[68:71], v[144:147]
    v_add_u32 v242, 73728, v2
    v_mfma_f32_16x16x32_bf16 v[152:155], v[20:23], a[72:75], v[152:155]
    buffer_load_dwordx4 a[112:115], v2, s[12:15], s28 offen offset:3072 sc1
    v_mfma_f32_16x16x32_bf16 v[160:163], v[20:23], a[76:79], v[160:163]
    v_add_u32 v243, 110592, v2
    v_mfma_f32_16x16x32_bf16 v[168:171], v[24:27], a[64:67], v[168:171]
    v_mfma_f32_16x16x32_bf16 v[176:179], v[24:27], a[68:71], v[176:179]
    buffer_load_dwordx4 a[116:119], v255, s[12:15], s28 offen offset:3072 sc1
    s_add_u32 s28, s28, 4096
    v_mfma_f32_16x16x32_bf16 v[184:187], v[24:27], a[72:75], v[184:187]
    v_mfma_f32_16x16x32_bf16 v[192:195], v[24:27], a[76:79], v[192:195]
    s_add_u32 m0, s49, 0
    s_add_u32 s27, s48, 0
    buffer_load_dwordx4 v2, s[12:15], s27 offen offset:0 sc1 lds
    s_waitcnt lgkmcnt(0)
    v_mfma_f32_16x16x32_bf16 v[108:111], v[28:31], a[64:67], v[108:111]
    ds_read_b128 v[16:19], v2 offset:10240
    v_mfma_f32_16x16x32_bf16 v[116:119], v[28:31], a[68:71], v[116:119]
    s_mov_b32 s16, s46
    v_mfma_f32_16x16x32_bf16 v[124:127], v[28:31], a[72:75], v[124:127]
    ds_read_b128 v[20:23], v12 offset:10240
    v_mfma_f32_16x16x32_bf16 v[132:135], v[28:31], a[76:79], v[132:135]
    s_and_b32 s17, s47, 0xffff
    v_mfma_f32_16x16x32_bf16 v[140:143], v[32:35], a[64:67], v[140:143]
    ds_read_b128 v[24:27], v13 offset:10240
    v_mfma_f32_16x16x32_bf16 v[148:151], v[32:35], a[68:71], v[148:151]
    s_mov_b32 s18, 0x240000
    v_mfma_f32_16x16x32_bf16 v[156:159], v[32:35], a[72:75], v[156:159]
    buffer_load_dwordx4 a[120:123], v2, s[12:15], s29 offen offset:3072 sc1
    v_mfma_f32_16x16x32_bf16 v[164:167], v[32:35], a[76:79], v[164:167]
    s_mov_b32 s19, 0x00020000
    v_mfma_f32_16x16x32_bf16 v[172:175], v[36:39], a[64:67], v[172:175]
    v_mfma_f32_16x16x32_bf16 v[180:183], v[36:39], a[68:71], v[180:183]
    buffer_load_dwordx4 a[124:127], v255, s[12:15], s29 offen offset:3072 sc1
    s_add_u32 s29, s29, 4096
    v_mfma_f32_16x16x32_bf16 v[188:191], v[36:39], a[72:75], v[188:191]
    v_mfma_f32_16x16x32_bf16 v[196:199], v[36:39], a[76:79], v[196:199]
    buffer_load_dword v40, v6, s[12:15], s26 offen offset:0 sc1
    s_waitcnt vmcnt(10) lgkmcnt(0)
    v_mfma_f32_16x16x32_bf16 v[104:107], v[16:19], a[80:83], v[104:107]
    ds_read_b128 v[28:31], v2 offset:11264
    v_mfma_f32_16x16x32_bf16 v[112:115], v[16:19], a[84:87], v[112:115]
    s_mul_i32 s57, s59, 18432
    v_mfma_f32_16x16x32_bf16 v[120:123], v[16:19], a[88:91], v[120:123]
    ds_read_b128 v[32:35], v12 offset:11264
    v_mfma_f32_16x16x32_bf16 v[128:131], v[16:19], a[92:95], v[128:131]
    s_mul_i32 s53, s52, 4608
    v_mfma_f32_16x16x32_bf16 v[136:139], v[20:23], a[80:83], v[136:139]
    ds_read_b128 v[36:39], v13 offset:11264
    v_mfma_f32_16x16x32_bf16 v[144:147], v[20:23], a[84:87], v[144:147]
    s_add_u32 s57, s57, s53
    v_mfma_f32_16x16x32_bf16 v[152:155], v[20:23], a[88:91], v[152:155]
    buffer_load_dwordx4 a[128:131], v2, s[12:15], s28 offen offset:0 sc1
    v_mfma_f32_16x16x32_bf16 v[160:163], v[20:23], a[92:95], v[160:163]
    s_add_u32 s57, s57, 0x980000
    v_mfma_f32_16x16x32_bf16 v[168:171], v[24:27], a[80:83], v[168:171]
    v_mfma_f32_16x16x32_bf16 v[176:179], v[24:27], a[84:87], v[176:179]
    buffer_load_dwordx4 a[132:135], v255, s[12:15], s28 offen offset:0 sc1
    v_mfma_f32_16x16x32_bf16 v[184:187], v[24:27], a[88:91], v[184:187]
    v_mfma_f32_16x16x32_bf16 v[192:195], v[24:27], a[92:95], v[192:195]
    buffer_load_dwordx4 v2, s[12:15], s27 offen offset:1024 sc1 lds
    s_waitcnt lgkmcnt(0)
    v_mfma_f32_16x16x32_bf16 v[108:111], v[28:31], a[80:83], v[108:111]
    ds_read_b128 v[16:19], v2 offset:12288
    v_mfma_f32_16x16x32_bf16 v[116:119], v[28:31], a[84:87], v[116:119]
    s_lshl_b32 s53, s50, 10
    v_mfma_f32_16x16x32_bf16 v[124:127], v[28:31], a[88:91], v[124:127]
    ds_read_b128 v[20:23], v12 offset:12288
    v_mfma_f32_16x16x32_bf16 v[132:135], v[28:31], a[92:95], v[132:135]
    s_add_u32 s64, s57, s53
    v_mfma_f32_16x16x32_bf16 v[140:143], v[32:35], a[80:83], v[140:143]
    ds_read_b128 v[24:27], v13 offset:12288
    v_mfma_f32_16x16x32_bf16 v[148:151], v[32:35], a[84:87], v[148:151]
    s_add_u32 s57, s57, 4096
    v_mfma_f32_16x16x32_bf16 v[156:159], v[32:35], a[88:91], v[156:159]
    buffer_load_dwordx4 a[136:139], v2, s[12:15], s29 offen offset:0 sc1
    v_mfma_f32_16x16x32_bf16 v[164:167], v[32:35], a[92:95], v[164:167]
    s_mul_i32 s58, s59, 18432
    v_mfma_f32_16x16x32_bf16 v[172:175], v[36:39], a[80:83], v[172:175]
    v_mfma_f32_16x16x32_bf16 v[180:183], v[36:39], a[84:87], v[180:183]
    buffer_load_dwordx4 a[140:143], v255, s[12:15], s29 offen offset:0 sc1
    v_mfma_f32_16x16x32_bf16 v[188:191], v[36:39], a[88:91], v[188:191]
    v_mfma_f32_16x16x32_bf16 v[196:199], v[36:39], a[92:95], v[196:199]
    buffer_load_dword v41, v6, s[12:15], s26 offen offset:256 sc1
    s_waitcnt vmcnt(12) lgkmcnt(0)
    v_mfma_f32_16x16x32_bf16 v[104:107], v[16:19], a[96:99], v[104:107]
    ds_read_b128 v[28:31], v2 offset:13312
    v_mfma_f32_16x16x32_bf16 v[112:115], v[16:19], a[100:103], v[112:115]
    s_mul_i32 s53, s52, 288
    v_mfma_f32_16x16x32_bf16 v[120:123], v[16:19], a[104:107], v[120:123]
    ds_read_b128 v[32:35], v12 offset:13312
    v_mfma_f32_16x16x32_bf16 v[128:131], v[16:19], a[108:111], v[128:131]
    s_add_u32 s58, s58, s53
    v_mfma_f32_16x16x32_bf16 v[136:139], v[20:23], a[96:99], v[136:139]
    ds_read_b128 v[36:39], v13 offset:13312
    v_mfma_f32_16x16x32_bf16 v[144:147], v[20:23], a[100:103], v[144:147]
    s_lshl_b32 s53, s50, 6
    v_mfma_f32_16x16x32_bf16 v[152:155], v[20:23], a[104:107], v[152:155]
    buffer_load_dwordx4 a[144:147], v2, s[12:15], s28 offen offset:1024 sc1
    v_mfma_f32_16x16x32_bf16 v[160:163], v[20:23], a[108:111], v[160:163]
    s_add_u32 s65, s58, s53
    v_mfma_f32_16x16x32_bf16 v[168:171], v[24:27], a[96:99], v[168:171]
    v_mfma_f32_16x16x32_bf16 v[176:179], v[24:27], a[100:103], v[176:179]
    buffer_load_dwordx4 a[148:151], v255, s[12:15], s28 offen offset:1024 sc1
    v_mfma_f32_16x16x32_bf16 v[184:187], v[24:27], a[104:107], v[184:187]
    v_mfma_f32_16x16x32_bf16 v[192:195], v[24:27], a[108:111], v[192:195]
    buffer_load_dwordx4 v2, s[12:15], s27 offen offset:2048 sc1 lds
    s_waitcnt lgkmcnt(0)
    v_mfma_f32_16x16x32_bf16 v[108:111], v[28:31], a[96:99], v[108:111]
    ds_read_b128 v[16:19], v2 offset:14336
    v_mfma_f32_16x16x32_bf16 v[116:119], v[28:31], a[100:103], v[116:119]
    s_add_u32 s58, s58, 256
    v_mfma_f32_16x16x32_bf16 v[124:127], v[28:31], a[104:107], v[124:127]
    ds_read_b128 v[20:23], v12 offset:14336
    v_mfma_f32_16x16x32_bf16 v[132:135], v[28:31], a[108:111], v[132:135]
    s_lshl_b32 s61, s59, 6
    v_mfma_f32_16x16x32_bf16 v[140:143], v[32:35], a[96:99], v[140:143]
    ds_read_b128 v[24:27], v13 offset:14336
    v_mfma_f32_16x16x32_bf16 v[148:151], v[32:35], a[100:103], v[148:151]
    s_add_u32 s61, s61, 0xbc2000
    v_mfma_f32_16x16x32_bf16 v[156:159], v[32:35], a[104:107], v[156:159]
    buffer_load_dwordx4 a[152:155], v2, s[12:15], s29 offen offset:1024 sc1
    v_mfma_f32_16x16x32_bf16 v[164:167], v[32:35], a[108:111], v[164:167]
    v_and_b32 v246, 15, v1
    v_mfma_f32_16x16x32_bf16 v[172:175], v[36:39], a[96:99], v[172:175]
    v_mfma_f32_16x16x32_bf16 v[180:183], v[36:39], a[100:103], v[180:183]
    buffer_load_dwordx4 a[156:159], v255, s[12:15], s29 offen offset:1024 sc1
    v_mfma_f32_16x16x32_bf16 v[188:191], v[36:39], a[104:107], v[188:191]
    v_mfma_f32_16x16x32_bf16 v[196:199], v[36:39], a[108:111], v[196:199]
    buffer_load_dword v42, v6, s[12:15], s26 offen offset:512 sc1
    s_waitcnt vmcnt(13) lgkmcnt(0)
    v_mfma_f32_16x16x32_bf16 v[104:107], v[16:19], a[112:115], v[104:107]
    ds_read_b128 v[28:31], v2 offset:15360
    v_mfma_f32_16x16x32_bf16 v[112:115], v[16:19], a[116:119], v[112:115]
    v_lshlrev_b32 v253, 2, v246
    v_mfma_f32_16x16x32_bf16 v[120:123], v[16:19], a[120:123], v[120:123]
    ds_read_b128 v[32:35], v12 offset:15360
    v_mfma_f32_16x16x32_bf16 v[128:131], v[16:19], a[124:127], v[128:131]
    v_lshlrev_b32 v240, 4, v246
    v_mfma_f32_16x16x32_bf16 v[136:139], v[20:23], a[112:115], v[136:139]
    ds_read_b128 v[36:39], v13 offset:15360
    v_mfma_f32_16x16x32_bf16 v[144:147], v[20:23], a[116:119], v[144:147]
    v_mul_u32_u24 v252, 1152, v246
    v_mfma_f32_16x16x32_bf16 v[152:155], v[20:23], a[120:123], v[152:155]
    buffer_load_dwordx4 a[160:163], v2, s[12:15], s28 offen offset:2048 sc1
    v_mfma_f32_16x16x32_bf16 v[160:163], v[20:23], a[124:127], v[160:163]
    v_lshrrev_b32 v246, 5, v1
    v_mfma_f32_16x16x32_bf16 v[168:171], v[24:27], a[112:115], v[168:171]
    v_mfma_f32_16x16x32_bf16 v[176:179], v[24:27], a[116:119], v[176:179]
    buffer_load_dwordx4 a[164:167], v255, s[12:15], s28 offen offset:2048 sc1
    v_mfma_f32_16x16x32_bf16 v[184:187], v[24:27], a[120:123], v[184:187]
    v_mfma_f32_16x16x32_bf16 v[192:195], v[24:27], a[124:127], v[192:195]
    buffer_load_dwordx4 v2, s[12:15], s27 offen offset:3072 sc1 lds
    s_waitcnt lgkmcnt(0)
    v_mfma_f32_16x16x32_bf16 v[108:111], v[28:31], a[112:115], v[108:111]
    ds_read_b128 v[16:19], v2 offset:16384
    v_mfma_f32_16x16x32_bf16 v[116:119], v[28:31], a[116:119], v[116:119]
    v_lshl_add_u32 v240, v246, 8, v240
    v_mfma_f32_16x16x32_bf16 v[124:127], v[28:31], a[120:123], v[124:127]
    ds_read_b128 v[20:23], v12 offset:16384
    v_mfma_f32_16x16x32_bf16 v[132:135], v[28:31], a[124:127], v[132:135]
    v_lshl_add_u32 v252, v246, 4, v252
    v_mfma_f32_16x16x32_bf16 v[140:143], v[32:35], a[112:115], v[140:143]
    ds_read_b128 v[24:27], v13 offset:16384
    v_mfma_f32_16x16x32_bf16 v[148:151], v[32:35], a[116:119], v[148:151]
    v_bfe_u32 v247, v1, 4, 1
    v_mfma_f32_16x16x32_bf16 v[156:159], v[32:35], a[120:123], v[156:159]
    buffer_load_dwordx4 a[168:171], v2, s[12:15], s29 offen offset:2048 sc1
    v_mfma_f32_16x16x32_bf16 v[164:167], v[32:35], a[124:127], v[164:167]
    v_lshl_add_u32 v240, v247, 3, v240
    v_mfma_f32_16x16x32_bf16 v[172:175], v[36:39], a[112:115], v[172:175]
    v_mfma_f32_16x16x32_bf16 v[180:183], v[36:39], a[116:119], v[180:183]
    buffer_load_dwordx4 a[172:175], v255, s[12:15], s29 offen offset:2048 sc1
    v_mfma_f32_16x16x32_bf16 v[188:191], v[36:39], a[120:123], v[188:191]
    v_mfma_f32_16x16x32_bf16 v[196:199], v[36:39], a[124:127], v[196:199]
    buffer_load_dword v43, v6, s[12:15], s26 offen offset:768 sc1
    s_waitcnt vmcnt(13) lgkmcnt(0)
    v_mfma_f32_16x16x32_bf16 v[104:107], v[16:19], a[128:131], v[104:107]
    ds_read_b128 v[28:31], v2 offset:17408
    v_mfma_f32_16x16x32_bf16 v[112:115], v[16:19], a[132:135], v[112:115]
    s_and_b32 s54, s2, 0xfc
    v_mfma_f32_16x16x32_bf16 v[120:123], v[16:19], a[136:139], v[120:123]
    ds_read_b128 v[32:35], v12 offset:17408
    v_mfma_f32_16x16x32_bf16 v[128:131], v[16:19], a[140:143], v[128:131]
    s_mul_i32 s60, s3, 6144
    v_mfma_f32_16x16x32_bf16 v[136:139], v[20:23], a[128:131], v[136:139]
    ds_read_b128 v[36:39], v13 offset:17408
    v_mfma_f32_16x16x32_bf16 v[144:147], v[20:23], a[132:135], v[144:147]
    s_add_u32 s40, s50, 1
    v_mfma_f32_16x16x32_bf16 v[152:155], v[20:23], a[136:139], v[152:155]
    buffer_load_dwordx4 a[176:179], v2, s[12:15], s28 offen offset:3072 sc1
    v_mfma_f32_16x16x32_bf16 v[160:163], v[20:23], a[140:143], v[160:163]
    s_and_b32 s40, s40, 3
    v_mfma_f32_16x16x32_bf16 v[168:171], v[24:27], a[128:131], v[168:171]
    v_mfma_f32_16x16x32_bf16 v[176:179], v[24:27], a[132:135], v[176:179]
    buffer_load_dwordx4 a[180:183], v255, s[12:15], s28 offen offset:3072 sc1
    s_add_u32 s28, s28, 4096
    v_mfma_f32_16x16x32_bf16 v[184:187], v[24:27], a[136:139], v[184:187]
    v_mfma_f32_16x16x32_bf16 v[192:195], v[24:27], a[140:143], v[192:195]
    s_add_u32 m0, s49, 4096
    s_add_u32 s27, s48, 4096
    buffer_load_dwordx4 v2, s[12:15], s27 offen offset:0 sc1 lds
    s_waitcnt lgkmcnt(0)
    v_mfma_f32_16x16x32_bf16 v[108:111], v[28:31], a[128:131], v[108:111]
    ds_read_b128 v[16:19], v2 offset:18432
    v_mfma_f32_16x16x32_bf16 v[116:119], v[28:31], a[132:135], v[116:119]
    s_add_u32 s40, s40, s54
    v_mfma_f32_16x16x32_bf16 v[124:127], v[28:31], a[136:139], v[124:127]
    ds_read_b128 v[20:23], v12 offset:18432
    v_mfma_f32_16x16x32_bf16 v[132:135], v[28:31], a[140:143], v[132:135]
    s_mul_i32 s40, s40, 27648
    v_mfma_f32_16x16x32_bf16 v[140:143], v[32:35], a[128:131], v[140:143]
    ds_read_b128 v[24:27], v13 offset:18432
    v_mfma_f32_16x16x32_bf16 v[148:151], v[32:35], a[132:135], v[148:151]
    s_add_u32 s40, s40, s60
    v_mfma_f32_16x16x32_bf16 v[156:159], v[32:35], a[136:139], v[156:159]
    buffer_load_dwordx4 a[184:187], v2, s[12:15], s29 offen offset:3072 sc1
    v_mfma_f32_16x16x32_bf16 v[164:167], v[32:35], a[140:143], v[164:167]
    s_add_u32 s40, s40, 0x3200000
    v_mfma_f32_16x16x32_bf16 v[172:175], v[36:39], a[128:131], v[172:175]
    v_mfma_f32_16x16x32_bf16 v[180:183], v[36:39], a[132:135], v[180:183]
    buffer_load_dwordx4 a[188:191], v255, s[12:15], s29 offen offset:3072 sc1
    s_add_u32 s29, s29, 4096
    v_mfma_f32_16x16x32_bf16 v[188:191], v[36:39], a[136:139], v[188:191]
    v_mfma_f32_16x16x32_bf16 v[196:199], v[36:39], a[140:143], v[196:199]
    buffer_load_dword v44, v6, s[12:15], s26 offen offset:1024 sc1
    s_waitcnt vmcnt(13) lgkmcnt(0)
    v_mfma_f32_16x16x32_bf16 v[104:107], v[16:19], a[144:147], v[104:107]
    ds_read_b128 v[28:31], v2 offset:19456
    v_mfma_f32_16x16x32_bf16 v[112:115], v[16:19], a[148:151], v[112:115]
    s_add_u32 s41, s50, 2
    v_mfma_f32_16x16x32_bf16 v[120:123], v[16:19], a[152:155], v[120:123]
    ds_read_b128 v[32:35], v12 offset:19456
    v_mfma_f32_16x16x32_bf16 v[128:131], v[16:19], a[156:159], v[128:131]
    s_and_b32 s41, s41, 3
    v_mfma_f32_16x16x32_bf16 v[136:139], v[20:23], a[144:147], v[136:139]
    ds_read_b128 v[36:39], v13 offset:19456
    v_mfma_f32_16x16x32_bf16 v[144:147], v[20:23], a[148:151], v[144:147]
    s_add_u32 s41, s41, s54
    v_mfma_f32_16x16x32_bf16 v[152:155], v[20:23], a[152:155], v[152:155]
    buffer_load_dwordx4 a[192:195], v2, s[12:15], s28 offen offset:0 sc1
    v_mfma_f32_16x16x32_bf16 v[160:163], v[20:23], a[156:159], v[160:163]
    s_mul_i32 s41, s41, 27648
    v_mfma_f32_16x16x32_bf16 v[168:171], v[24:27], a[144:147], v[168:171]
    v_mfma_f32_16x16x32_bf16 v[176:179], v[24:27], a[148:151], v[176:179]
    buffer_load_dwordx4 a[196:199], v255, s[12:15], s28 offen offset:0 sc1
    v_mfma_f32_16x16x32_bf16 v[184:187], v[24:27], a[152:155], v[184:187]
    v_mfma_f32_16x16x32_bf16 v[192:195], v[24:27], a[156:159], v[192:195]
    buffer_load_dwordx4 v2, s[12:15], s27 offen offset:1024 sc1 lds
    s_waitcnt lgkmcnt(0)
    v_mfma_f32_16x16x32_bf16 v[108:111], v[28:31], a[144:147], v[108:111]
    ds_read_b128 v[16:19], v2 offset:20480
    v_mfma_f32_16x16x32_bf16 v[116:119], v[28:31], a[148:151], v[116:119]
    s_add_u32 s41, s41, s60
    v_mfma_f32_16x16x32_bf16 v[124:127], v[28:31], a[152:155], v[124:127]
    ds_read_b128 v[20:23], v12 offset:20480
    v_mfma_f32_16x16x32_bf16 v[132:135], v[28:31], a[156:159], v[132:135]
    s_add_u32 s41, s41, 0x3200800
    v_mfma_f32_16x16x32_bf16 v[140:143], v[32:35], a[144:147], v[140:143]
    ds_read_b128 v[24:27], v13 offset:20480
    v_mfma_f32_16x16x32_bf16 v[148:151], v[32:35], a[148:151], v[148:151]
    s_add_u32 s42, s50, 3
    v_mfma_f32_16x16x32_bf16 v[156:159], v[32:35], a[152:155], v[156:159]
    buffer_load_dwordx4 a[200:203], v2, s[12:15], s29 offen offset:0 sc1
    v_mfma_f32_16x16x32_bf16 v[164:167], v[32:35], a[156:159], v[164:167]
    s_and_b32 s42, s42, 3
    v_mfma_f32_16x16x32_bf16 v[172:175], v[36:39], a[144:147], v[172:175]
    v_mfma_f32_16x16x32_bf16 v[180:183], v[36:39], a[148:151], v[180:183]
    buffer_load_dwordx4 a[204:207], v255, s[12:15], s29 offen offset:0 sc1
    v_mfma_f32_16x16x32_bf16 v[188:191], v[36:39], a[152:155], v[188:191]
    v_mfma_f32_16x16x32_bf16 v[196:199], v[36:39], a[156:159], v[196:199]
    buffer_load_dword v45, v6, s[12:15], s26 offen offset:1280 sc1
    s_waitcnt vmcnt(13) lgkmcnt(0)
    v_mfma_f32_16x16x32_bf16 v[104:107], v[16:19], a[160:163], v[104:107]
    ds_read_b128 v[28:31], v2 offset:21504
    v_mfma_f32_16x16x32_bf16 v[112:115], v[16:19], a[164:167], v[112:115]
    s_add_u32 s42, s42, s54
    v_mfma_f32_16x16x32_bf16 v[120:123], v[16:19], a[168:171], v[120:123]
    ds_read_b128 v[32:35], v12 offset:21504
    v_mfma_f32_16x16x32_bf16 v[128:131], v[16:19], a[172:175], v[128:131]
    s_mul_i32 s42, s42, 27648
    v_mfma_f32_16x16x32_bf16 v[136:139], v[20:23], a[160:163], v[136:139]
    ds_read_b128 v[36:39], v13 offset:21504
    v_mfma_f32_16x16x32_bf16 v[144:147], v[20:23], a[164:167], v[144:147]
    s_add_u32 s42, s42, s60
    v_mfma_f32_16x16x32_bf16 v[152:155], v[20:23], a[168:171], v[152:155]
    buffer_load_dwordx4 a[208:211], v2, s[12:15], s28 offen offset:1024 sc1
    v_mfma_f32_16x16x32_bf16 v[160:163], v[20:23], a[172:175], v[160:163]
    s_add_u32 s42, s42, 0x3201000
    v_mfma_f32_16x16x32_bf16 v[168:171], v[24:27], a[160:163], v[168:171]
    v_mfma_f32_16x16x32_bf16 v[176:179], v[24:27], a[164:167], v[176:179]
    buffer_load_dwordx4 a[212:215], v255, s[12:15], s28 offen offset:1024 sc1
    v_mfma_f32_16x16x32_bf16 v[184:187], v[24:27], a[168:171], v[184:187]
    v_mfma_f32_16x16x32_bf16 v[192:195], v[24:27], a[172:175], v[192:195]
    buffer_load_dwordx4 v2, s[12:15], s27 offen offset:2048 sc1 lds
    s_waitcnt lgkmcnt(0)
    v_mfma_f32_16x16x32_bf16 v[108:111], v[28:31], a[160:163], v[108:111]
    ds_read_b128 v[16:19], v2 offset:22528
    v_mfma_f32_16x16x32_bf16 v[116:119], v[28:31], a[164:167], v[116:119]
    s_add_u32 s43, s54, s3
    v_mfma_f32_16x16x32_bf16 v[124:127], v[28:31], a[168:171], v[124:127]
    ds_read_b128 v[20:23], v12 offset:22528
    v_mfma_f32_16x16x32_bf16 v[132:135], v[28:31], a[172:175], v[132:135]
    s_mul_i32 s43, s43, 27648
    v_mfma_f32_16x16x32_bf16 v[140:143], v[32:35], a[160:163], v[140:143]
    ds_read_b128 v[24:27], v13 offset:22528
    v_mfma_f32_16x16x32_bf16 v[148:151], v[32:35], a[164:167], v[148:151]
    s_sub_u32 s53, s3, s50
    v_mfma_f32_16x16x32_bf16 v[156:159], v[32:35], a[168:171], v[156:159]
    buffer_load_dwordx4 a[216:219], v2, s[12:15], s29 offen offset:1024 sc1
    v_mfma_f32_16x16x32_bf16 v[164:167], v[32:35], a[172:175], v[164:167]
    s_and_b32 s53, s53, 3
    v_mfma_f32_16x16x32_bf16 v[172:175], v[36:39], a[160:163], v[172:175]
    v_mfma_f32_16x16x32_bf16 v[180:183], v[36:39], a[164:167], v[180:183]
    buffer_load_dwordx4 a[220:223], v255, s[12:15], s29 offen offset:1024 sc1
    v_mfma_f32_16x16x32_bf16 v[188:191], v[36:39], a[168:171], v[188:191]
    v_mfma_f32_16x16x32_bf16 v[196:199], v[36:39], a[172:175], v[196:199]
    buffer_load_dword v46, v6, s[12:15], s26 offen offset:1536 sc1
    s_waitcnt vmcnt(13) lgkmcnt(0)
    v_mfma_f32_16x16x32_bf16 v[104:107], v[16:19], a[176:179], v[104:107]
    ds_read_b128 v[28:31], v2 offset:23552
    v_mfma_f32_16x16x32_bf16 v[112:115], v[16:19], a[180:183], v[112:115]
    s_lshl_b32 s53, s53, 10
    v_mfma_f32_16x16x32_bf16 v[120:123], v[16:19], a[184:187], v[120:123]
    ds_read_b128 v[32:35], v12 offset:23552
    v_mfma_f32_16x16x32_bf16 v[128:131], v[16:19], a[188:191], v[128:131]
    s_add_u32 s43, s43, s53
    v_mfma_f32_16x16x32_bf16 v[136:139], v[20:23], a[176:179], v[136:139]
    ds_read_b128 v[36:39], v13 offset:23552
    v_mfma_f32_16x16x32_bf16 v[144:147], v[20:23], a[180:183], v[144:147]
    s_add_u32 s43, s43, 0x3205c00
    v_mfma_f32_16x16x32_bf16 v[152:155], v[20:23], a[184:187], v[152:155]
    buffer_load_dwordx4 a[224:227], v2, s[12:15], s28 offen offset:2048 sc1
    v_mfma_f32_16x16x32_bf16 v[160:163], v[20:23], a[188:191], v[160:163]
    s_cmp_eq_u32 s3, s50
    s_cselect_b32 s43, 0x7f000000, s43
    v_mfma_f32_16x16x32_bf16 v[168:171], v[24:27], a[176:179], v[168:171]
    v_mfma_f32_16x16x32_bf16 v[176:179], v[24:27], a[180:183], v[176:179]
    buffer_load_dwordx4 a[228:231], v255, s[12:15], s28 offen offset:2048 sc1
    v_mfma_f32_16x16x32_bf16 v[184:187], v[24:27], a[184:187], v[184:187]
    v_mfma_f32_16x16x32_bf16 v[192:195], v[24:27], a[188:191], v[192:195]
    buffer_load_dwordx4 v2, s[12:15], s27 offen offset:3072 sc1 lds
    s_waitcnt lgkmcnt(0)
    v_mfma_f32_16x16x32_bf16 v[108:111], v[28:31], a[176:179], v[108:111]
    ds_read_b128 v[16:19], v2 offset:24576
    v_mfma_f32_16x16x32_bf16 v[116:119], v[28:31], a[180:183], v[116:119]
    s_mul_i32 s66, s2, 27648
    v_mfma_f32_16x16x32_bf16 v[124:127], v[28:31], a[184:187], v[124:127]
    ds_read_b128 v[20:23], v12 offset:24576
    v_mfma_f32_16x16x32_bf16 v[132:135], v[28:31], a[188:191], v[132:135]
    s_add_u32 s36, s66, s60
    v_mfma_f32_16x16x32_bf16 v[140:143], v[32:35], a[176:179], v[140:143]
    ds_read_b128 v[24:27], v13 offset:24576
    v_mfma_f32_16x16x32_bf16 v[148:151], v[32:35], a[180:183], v[148:151]
    s_add_u32 s36, s36, 0x3200000
    v_mfma_f32_16x16x32_bf16 v[156:159], v[32:35], a[184:187], v[156:159]
    buffer_load_dwordx4 a[232:235], v2, s[12:15], s29 offen offset:2048 sc1
    v_mfma_f32_16x16x32_bf16 v[164:167], v[32:35], a[188:191], v[164:167]
    s_add_u32 s37, s36, 4096
    v_mfma_f32_16x16x32_bf16 v[172:175], v[36:39], a[176:179], v[172:175]
    v_mfma_f32_16x16x32_bf16 v[180:183], v[36:39], a[180:183], v[180:183]
    buffer_load_dwordx4 a[236:239], v255, s[12:15], s29 offen offset:2048 sc1
    v_mfma_f32_16x16x32_bf16 v[188:191], v[36:39], a[184:187], v[188:191]
    v_mfma_f32_16x16x32_bf16 v[196:199], v[36:39], a[188:191], v[196:199]
    buffer_load_dword v47, v6, s[12:15], s26 offen offset:1792 sc1
    s_waitcnt vmcnt(13) lgkmcnt(0)
    v_mfma_f32_16x16x32_bf16 v[104:107], v[16:19], a[192:195], v[104:107]
    ds_read_b128 v[28:31], v2 offset:25600
    v_mfma_f32_16x16x32_bf16 v[112:115], v[16:19], a[196:199], v[112:115]
    s_add_u32 s66, s66, 0x3206000
    v_mfma_f32_16x16x32_bf16 v[120:123], v[16:19], a[200:203], v[120:123]
    ds_read_b128 v[32:35], v12 offset:25600
    v_mfma_f32_16x16x32_bf16 v[128:131], v[16:19], a[204:207], v[128:131]
    s_mov_b32 s63, 0xffff0000
    v_mfma_f32_16x16x32_bf16 v[136:139], v[20:23], a[192:195], v[136:139]
    ds_read_b128 v[36:39], v13 offset:25600
    v_mfma_f32_16x16x32_bf16 v[144:147], v[20:23], a[196:199], v[144:147]
    v_mov_b32 v246, 0
    v_mfma_f32_16x16x32_bf16 v[152:155], v[20:23], a[200:203], v[152:155]
    buffer_load_dwordx4 a[240:243], v2, s[12:15], s28 offen offset:3072 sc1
    v_mfma_f32_16x16x32_bf16 v[160:163], v[20:23], a[204:207], v[160:163]
    v_mfma_f32_16x16x32_bf16 v[168:171], v[24:27], a[192:195], v[168:171]
    v_mfma_f32_16x16x32_bf16 v[176:179], v[24:27], a[196:199], v[176:179]
    buffer_load_dwordx4 a[244:247], v255, s[12:15], s28 offen offset:3072 sc1
    s_add_u32 s28, s28, 4096
    v_mfma_f32_16x16x32_bf16 v[184:187], v[24:27], a[200:203], v[184:187]
    v_mfma_f32_16x16x32_bf16 v[192:195], v[24:27], a[204:207], v[192:195]
    s_add_u32 m0, s49, 8192
    s_add_u32 s27, s48, 8192
    buffer_load_dwordx4 v2, s[12:15], s27 offen offset:0 sc1 lds
    s_add_u32 s48, s48, 36864
    s_add_u32 s49, s49, 36864
    s_cmp_ge_u32 s49, 147456
    s_cselect_b32 s27, 147456, 0
    s_sub_u32 s49, s49, s27
    s_waitcnt lgkmcnt(0)
    v_mfma_f32_16x16x32_bf16 v[108:111], v[28:31], a[192:195], v[108:111]
    ds_read_b128 v[16:19], v2 offset:26624
    v_mfma_f32_16x16x32_bf16 v[116:119], v[28:31], a[196:199], v[116:119]
    v_mfma_f32_16x16x32_bf16 v[124:127], v[28:31], a[200:203], v[124:127]
    ds_read_b128 v[20:23], v12 offset:26624
    v_mfma_f32_16x16x32_bf16 v[132:135], v[28:31], a[204:207], v[132:135]
    v_mfma_f32_16x16x32_bf16 v[140:143], v[32:35], a[192:195], v[140:143]
    ds_read_b128 v[24:27], v13 offset:26624
    v_mfma_f32_16x16x32_bf16 v[148:151], v[32:35], a[196:199], v[148:151]
    v_mfma_f32_16x16x32_bf16 v[156:159], v[32:35], a[200:203], v[156:159]
    buffer_load_dwordx4 a[248:251], v2, s[12:15], s29 offen offset:3072 sc1
    v_mfma_f32_16x16x32_bf16 v[164:167], v[32:35], a[204:207], v[164:167]
    v_mfma_f32_16x16x32_bf16 v[172:175], v[36:39], a[192:195], v[172:175]
    v_mfma_f32_16x16x32_bf16 v[180:183], v[36:39], a[196:199], v[180:183]
    buffer_load_dwordx4 a[252:255], v255, s[12:15], s29 offen offset:3072 sc1
    s_add_u32 s29, s29, 4096
    v_mfma_f32_16x16x32_bf16 v[188:191], v[36:39], a[200:203], v[188:191]
    v_mfma_f32_16x16x32_bf16 v[196:199], v[36:39], a[204:207], v[196:199]
    s_waitcnt vmcnt(12) lgkmcnt(0)
    v_mfma_f32_16x16x32_bf16 v[104:107], v[16:19], a[208:211], v[104:107]
    ds_read_b128 v[28:31], v2 offset:27648
    v_mfma_f32_16x16x32_bf16 v[112:115], v[16:19], a[212:215], v[112:115]
    v_mfma_f32_16x16x32_bf16 v[120:123], v[16:19], a[216:219], v[120:123]
    ds_read_b128 v[32:35], v12 offset:27648
    v_mfma_f32_16x16x32_bf16 v[128:131], v[16:19], a[220:223], v[128:131]
    v_mfma_f32_16x16x32_bf16 v[136:139], v[20:23], a[208:211], v[136:139]
    ds_read_b128 v[36:39], v13 offset:27648
    v_mfma_f32_16x16x32_bf16 v[144:147], v[20:23], a[212:215], v[144:147]
    v_mfma_f32_16x16x32_bf16 v[152:155], v[20:23], a[216:219], v[152:155]
    buffer_load_dwordx4 v[72:75], v2, s[12:15], s28 offen offset:0 sc1
    v_mfma_f32_16x16x32_bf16 v[160:163], v[20:23], a[220:223], v[160:163]
    v_mfma_f32_16x16x32_bf16 v[168:171], v[24:27], a[208:211], v[168:171]
    v_mfma_f32_16x16x32_bf16 v[176:179], v[24:27], a[212:215], v[176:179]
    buffer_load_dwordx4 v[76:79], v255, s[12:15], s28 offen offset:0 sc1
    v_mfma_f32_16x16x32_bf16 v[184:187], v[24:27], a[216:219], v[184:187]
    v_mfma_f32_16x16x32_bf16 v[192:195], v[24:27], a[220:223], v[192:195]
    s_waitcnt lgkmcnt(0)
    v_mfma_f32_16x16x32_bf16 v[108:111], v[28:31], a[208:211], v[108:111]
    ds_read_b128 v[16:19], v2 offset:28672
    v_mfma_f32_16x16x32_bf16 v[116:119], v[28:31], a[212:215], v[116:119]
    v_mfma_f32_16x16x32_bf16 v[124:127], v[28:31], a[216:219], v[124:127]
    ds_read_b128 v[20:23], v12 offset:28672
    v_mfma_f32_16x16x32_bf16 v[132:135], v[28:31], a[220:223], v[132:135]
    v_mfma_f32_16x16x32_bf16 v[140:143], v[32:35], a[208:211], v[140:143]
    ds_read_b128 v[24:27], v13 offset:28672
    v_mfma_f32_16x16x32_bf16 v[148:151], v[32:35], a[212:215], v[148:151]
    v_mfma_f32_16x16x32_bf16 v[156:159], v[32:35], a[216:219], v[156:159]
    buffer_load_dwordx4 v[80:83], v2, s[12:15], s29 offen offset:0 sc1
    v_mfma_f32_16x16x32_bf16 v[164:167], v[32:35], a[220:223], v[164:167]
    v_mfma_f32_16x16x32_bf16 v[172:175], v[36:39], a[208:211], v[172:175]
    v_mfma_f32_16x16x32_bf16 v[180:183], v[36:39], a[212:215], v[180:183]
    buffer_load_dwordx4 v[84:87], v255, s[12:15], s29 offen offset:0 sc1
    v_mfma_f32_16x16x32_bf16 v[188:191], v[36:39], a[216:219], v[188:191]
    v_mfma_f32_16x16x32_bf16 v[196:199], v[36:39], a[220:223], v[196:199]
    s_waitcnt vmcnt(10) lgkmcnt(0)
    v_mfma_f32_16x16x32_bf16 v[104:107], v[16:19], a[224:227], v[104:107]
    ds_read_b128 v[28:31], v2 offset:29696
    v_mfma_f32_16x16x32_bf16 v[112:115], v[16:19], a[228:231], v[112:115]
    v_mfma_f32_16x16x32_bf16 v[120:123], v[16:19], a[232:235], v[120:123]
    ds_read_b128 v[32:35], v12 offset:29696
    v_mfma_f32_16x16x32_bf16 v[128:131], v[16:19], a[236:239], v[128:131]
    v_mfma_f32_16x16x32_bf16 v[136:139], v[20:23], a[224:227], v[136:139]
    ds_read_b128 v[36:39], v13 offset:29696
    v_mfma_f32_16x16x32_bf16 v[144:147], v[20:23], a[228:231], v[144:147]
    v_mfma_f32_16x16x32_bf16 v[152:155], v[20:23], a[232:235], v[152:155]
    buffer_load_dwordx4 v[88:91], v2, s[12:15], s28 offen offset:1024 sc1
    v_mfma_f32_16x16x32_bf16 v[160:163], v[20:23], a[236:239], v[160:163]
    v_mfma_f32_16x16x32_bf16 v[168:171], v[24:27], a[224:227], v[168:171]
    v_mfma_f32_16x16x32_bf16 v[176:179], v[24:27], a[228:231], v[176:179]
    buffer_load_dwordx4 v[92:95], v255, s[12:15], s28 offen offset:1024 sc1
    v_mfma_f32_16x16x32_bf16 v[184:187], v[24:27], a[232:235], v[184:187]
    v_mfma_f32_16x16x32_bf16 v[192:195], v[24:27], a[236:239], v[192:195]
    s_waitcnt lgkmcnt(0)
    v_mfma_f32_16x16x32_bf16 v[108:111], v[28:31], a[224:227], v[108:111]
    ds_read_b128 v[16:19], v2 offset:30720
    v_mfma_f32_16x16x32_bf16 v[116:119], v[28:31], a[228:231], v[116:119]
    v_mfma_f32_16x16x32_bf16 v[124:127], v[28:31], a[232:235], v[124:127]
    ds_read_b128 v[20:23], v12 offset:30720
    v_mfma_f32_16x16x32_bf16 v[132:135], v[28:31], a[236:239], v[132:135]
    v_mfma_f32_16x16x32_bf16 v[140:143], v[32:35], a[224:227], v[140:143]
    ds_read_b128 v[24:27], v13 offset:30720
    v_mfma_f32_16x16x32_bf16 v[148:151], v[32:35], a[228:231], v[148:151]
    v_mfma_f32_16x16x32_bf16 v[156:159], v[32:35], a[232:235], v[156:159]
    buffer_load_dwordx4 v[96:99], v2, s[12:15], s29 offen offset:1024 sc1
    v_mfma_f32_16x16x32_bf16 v[164:167], v[32:35], a[236:239], v[164:167]
    v_mfma_f32_16x16x32_bf16 v[172:175], v[36:39], a[224:227], v[172:175]
    v_mfma_f32_16x16x32_bf16 v[180:183], v[36:39], a[228:231], v[180:183]
    buffer_load_dwordx4 v[100:103], v255, s[12:15], s29 offen offset:1024 sc1
    v_mfma_f32_16x16x32_bf16 v[188:191], v[36:39], a[232:235], v[188:191]
    v_mfma_f32_16x16x32_bf16 v[196:199], v[36:39], a[236:239], v[196:199]
    s_waitcnt vmcnt(8) lgkmcnt(0)
    v_mfma_f32_16x16x32_bf16 v[104:107], v[16:19], a[240:243], v[104:107]
    ds_read_b128 v[28:31], v2 offset:31744
    v_mfma_f32_16x16x32_bf16 v[112:115], v[16:19], a[244:247], v[112:115]
    v_mfma_f32_16x16x32_bf16 v[120:123], v[16:19], a[248:251], v[120:123]
    ds_read_b128 v[32:35], v12 offset:31744
    v_mfma_f32_16x16x32_bf16 v[128:131], v[16:19], a[252:255], v[128:131]
    v_mfma_f32_16x16x32_bf16 v[136:139], v[20:23], a[240:243], v[136:139]
    ds_read_b128 v[36:39], v13 offset:31744
    v_mfma_f32_16x16x32_bf16 v[144:147], v[20:23], a[244:247], v[144:147]
    v_mfma_f32_16x16x32_bf16 v[152:155], v[20:23], a[248:251], v[152:155]
    v_mfma_f32_16x16x32_bf16 v[160:163], v[20:23], a[252:255], v[160:163]
    v_mfma_f32_16x16x32_bf16 v[168:171], v[24:27], a[240:243], v[168:171]
    v_mfma_f32_16x16x32_bf16 v[176:179], v[24:27], a[244:247], v[176:179]
    v_mfma_f32_16x16x32_bf16 v[184:187], v[24:27], a[248:251], v[184:187]
    v_mfma_f32_16x16x32_bf16 v[192:195], v[24:27], a[252:255], v[192:195]
    s_waitcnt lgkmcnt(0)
    v_mfma_f32_16x16x32_bf16 v[108:111], v[28:31], a[240:243], v[108:111]
    ds_read_b128 v[16:19], v2 offset:32768
    v_mfma_f32_16x16x32_bf16 v[116:119], v[28:31], a[244:247], v[116:119]
    v_mfma_f32_16x16x32_bf16 v[124:127], v[28:31], a[248:251], v[124:127]
    ds_read_b128 v[20:23], v12 offset:32768
    v_mfma_f32_16x16x32_bf16 v[132:135], v[28:31], a[252:255], v[132:135]
    v_mfma_f32_16x16x32_bf16 v[140:143], v[32:35], a[240:243], v[140:143]
    ds_read_b128 v[24:27], v13 offset:32768
    v_mfma_f32_16x16x32_bf16 v[148:151], v[32:35], a[244:247], v[148:151]
    v_mfma_f32_16x16x32_bf16 v[156:159], v[32:35], a[248:251], v[156:159]
    v_mfma_f32_16x16x32_bf16 v[164:167], v[32:35], a[252:255], v[164:167]
    v_mfma_f32_16x16x32_bf16 v[172:175], v[36:39], a[240:243], v[172:175]
    v_mfma_f32_16x16x32_bf16 v[180:183], v[36:39], a[244:247], v[180:183]
    v_mfma_f32_16x16x32_bf16 v[188:191], v[36:39], a[248:251], v[188:191]
    v_mfma_f32_16x16x32_bf16 v[196:199], v[36:39], a[252:255], v[196:199]
    s_waitcnt vmcnt(4) lgkmcnt(0)
    v_mfma_f32_16x16x32_bf16 v[104:107], v[16:19], v[72:75], v[104:107]
    ds_read_b128 v[28:31], v2 offset:33792
    v_mfma_f32_16x16x32_bf16 v[112:115], v[16:19], v[76:79], v[112:115]
    v_mfma_f32_16x16x32_bf16 v[120:123], v[16:19], v[80:83], v[120:123]
    ds_read_b128 v[32:35], v12 offset:33792
    v_mfma_f32_16x16x32_bf16 v[128:131], v[16:19], v[84:87], v[128:131]
    v_mfma_f32_16x16x32_bf16 v[136:139], v[20:23], v[72:75], v[136:139]
    ds_read_b128 v[36:39], v13 offset:33792
    v_mfma_f32_16x16x32_bf16 v[144:147], v[20:23], v[76:79], v[144:147]
    v_mfma_f32_16x16x32_bf16 v[152:155], v[20:23], v[80:83], v[152:155]
    v_mfma_f32_16x16x32_bf16 v[160:163], v[20:23], v[84:87], v[160:163]
    v_mfma_f32_16x16x32_bf16 v[168:171], v[24:27], v[72:75], v[168:171]
    v_mfma_f32_16x16x32_bf16 v[176:179], v[24:27], v[76:79], v[176:179]
    v_mfma_f32_16x16x32_bf16 v[184:187], v[24:27], v[80:83], v[184:187]
    v_mfma_f32_16x16x32_bf16 v[192:195], v[24:27], v[84:87], v[192:195]
    s_waitcnt lgkmcnt(0)
    v_mfma_f32_16x16x32_bf16 v[108:111], v[28:31], v[72:75], v[108:111]
    ds_read_b128 v[16:19], v2 offset:34816
    v_mfma_f32_16x16x32_bf16 v[116:119], v[28:31], v[76:79], v[116:119]
    v_mfma_f32_16x16x32_bf16 v[124:127], v[28:31], v[80:83], v[124:127]
    ds_read_b128 v[20:23], v12 offset:34816
    v_mfma_f32_16x16x32_bf16 v[132:135], v[28:31], v[84:87], v[132:135]
    v_mfma_f32_16x16x32_bf16 v[140:143], v[32:35], v[72:75], v[140:143]
    ds_read_b128 v[24:27], v13 offset:34816
    v_mfma_f32_16x16x32_bf16 v[148:151], v[32:35], v[76:79], v[148:151]
    v_mfma_f32_16x16x32_bf16 v[156:159], v[32:35], v[80:83], v[156:159]
    v_mfma_f32_16x16x32_bf16 v[164:167], v[32:35], v[84:87], v[164:167]
    v_mfma_f32_16x16x32_bf16 v[172:175], v[36:39], v[72:75], v[172:175]
    v_mfma_f32_16x16x32_bf16 v[180:183], v[36:39], v[76:79], v[180:183]
    v_mfma_f32_16x16x32_bf16 v[188:191], v[36:39], v[80:83], v[188:191]
    v_mfma_f32_16x16x32_bf16 v[196:199], v[36:39], v[84:87], v[196:199]
    s_waitcnt vmcnt(0) lgkmcnt(0)
    v_mfma_f32_16x16x32_bf16 v[104:107], v[16:19], v[88:91], v[104:107]
    ds_read_b128 v[28:31], v2 offset:35840
    v_mfma_f32_16x16x32_bf16 v[112:115], v[16:19], v[92:95], v[112:115]
    v_mfma_f32_16x16x32_bf16 v[120:123], v[16:19], v[96:99], v[120:123]
    ds_read_b128 v[32:35], v12 offset:35840
    v_mfma_f32_16x16x32_bf16 v[128:131], v[16:19], v[100:103], v[128:131]
    v_mfma_f32_16x16x32_bf16 v[136:139], v[20:23], v[88:91], v[136:139]
    ds_read_b128 v[36:39], v13 offset:35840
    v_mfma_f32_16x16x32_bf16 v[144:147], v[20:23], v[92:95], v[144:147]
    v_mfma_f32_16x16x32_bf16 v[152:155], v[20:23], v[96:99], v[152:155]
    v_mfma_f32_16x16x32_bf16 v[160:163], v[20:23], v[100:103], v[160:163]
    v_mfma_f32_16x16x32_bf16 v[168:171], v[24:27], v[88:91], v[168:171]
    v_mfma_f32_16x16x32_bf16 v[176:179], v[24:27], v[92:95], v[176:179]
    v_mfma_f32_16x16x32_bf16 v[184:187], v[24:27], v[96:99], v[184:187]
    v_mfma_f32_16x16x32_bf16 v[192:195], v[24:27], v[100:103], v[192:195]
    s_waitcnt lgkmcnt(0)
    s_barrier
    v_mfma_f32_16x16x32_bf16 v[108:111], v[28:31], v[88:91], v[108:111]
    ds_read_b128 v[16:19], v4 offset:0
    v_mfma_f32_16x16x32_bf16 v[116:119], v[28:31], v[92:95], v[116:119]
    v_mfma_f32_16x16x32_bf16 v[124:127], v[28:31], v[96:99], v[124:127]
    ds_read_b128 v[20:23], v4 offset:1024
    v_mfma_f32_16x16x32_bf16 v[132:135], v[28:31], v[100:103], v[132:135]
    v_mfma_f32_16x16x32_bf16 v[140:143], v[32:35], v[88:91], v[140:143]
    ds_read_b128 v[24:27], v4 offset:2048
    v_mfma_f32_16x16x32_bf16 v[148:151], v[32:35], v[92:95], v[148:151]
    v_mfma_f32_16x16x32_bf16 v[156:159], v[32:35], v[96:99], v[156:159]
    v_mfma_f32_16x16x32_bf16 v[164:167], v[32:35], v[100:103], v[164:167]
    v_mfma_f32_16x16x32_bf16 v[172:175], v[36:39], v[88:91], v[172:175]
    v_mfma_f32_16x16x32_bf16 v[180:183], v[36:39], v[92:95], v[180:183]
    v_mfma_f32_16x16x32_bf16 v[188:191], v[36:39], v[96:99], v[188:191]
    v_mfma_f32_16x16x32_bf16 v[196:199], v[36:39], v[100:103], v[196:199]
    ds_read_b128 v[28:31], v4 offset:3072
    ds_read_b128 v[32:35], v4 offset:4096
    v_add_f32 v40, v40, v41
    v_add_f32 v42, v42, v43
    v_add_f32 v44, v44, v45
    v_add_f32 v46, v46, v47
    v_add_f32 v40, v40, v42
    v_add_f32 v44, v44, v46
    v_mov_b32 v12, 0x3727c5ac
    v_add_f32 v40, v40, v44
    v_fmac_f32 v12, 0x3ae38e39, v40
    v_mov_b32 v14, v12
    s_nop 1
    v_permlane32_swap_b32 v12, v14
    v_mov_b32 v13, v12
    v_mov_b32 v15, v14
    s_nop 0
    v_permlane16_swap_b32 v12, v13
    v_permlane16_swap_b32 v14, v15
    v_rsq_f32 v8, v12
    v_rsq_f32 v9, v13
    v_rsq_f32 v10, v14
    v_rsq_f32 v11, v15
    v_mul_f32 v8, 0xbfb8aa3b, v8
    v_mul_f32 v9, 0xbfb8aa3b, v9
    v_mul_f32 v10, 0xbfb8aa3b, v10
    v_mul_f32 v11, 0xbfb8aa3b, v11
    v_mov_b32 v3, v4
    v_add_u32 v4, s33, v2
    s_add_u32 s33, s33, 36864
    s_cmp_ge_u32 s33, 147456
    s_cselect_b32 s33, 0, s33
    s_waitcnt lgkmcnt(3)
    v_mfma_f32_16x16x32_bf16 v[200:203], v[16:19], a[0:3], 0
    ds_read_b128 v[36:39], v3 offset:5120
    v_mfma_f32_16x16x32_bf16 v[208:211], v[16:19], a[4:7], 0
    v_mfma_f32_16x16x32_bf16 v[216:219], v[16:19], a[8:11], 0
    v_mfma_f32_16x16x32_bf16 v[224:227], v[16:19], a[12:15], 0
    v_mfma_f32_16x16x32_bf16 v[204:207], v[20:23], a[0:3], 0
    ds_read_b128 v[16:19], v3 offset:6144
    v_mfma_f32_16x16x32_bf16 v[212:215], v[20:23], a[4:7], 0
    s_add_u32 m0, s49, 0
    s_add_u32 s27, s48, 0
    v_mfma_f32_16x16x32_bf16 v[220:223], v[20:23], a[8:11], 0
    buffer_load_dwordx4 v2, s[12:15], s27 offen offset:0 sc1 lds
    v_mfma_f32_16x16x32_bf16 v[228:231], v[20:23], a[12:15], 0
    v_mul_f32 v40, v8, v104
    s_waitcnt lgkmcnt(3)
    v_mfma_f32_16x16x32_bf16 v[200:203], v[24:27], a[16:19], v[200:203]
    ds_read_b128 v[20:23], v3 offset:7168
    v_mul_f32 v48, v104, v108
    v_mfma_f32_16x16x32_bf16 v[208:211], v[24:27], a[20:23], v[208:211]
    v_exp_f32 v40, v40
    v_mul_f32 v41, v8, v105
    v_mfma_f32_16x16x32_bf16 v[216:219], v[24:27], a[24:27], v[216:219]
    buffer_load_dwordx4 v2, s[12:15], s27 offen offset:1024 sc1 lds
    v_mfma_f32_16x16x32_bf16 v[224:227], v[24:27], a[28:31], v[224:227]
    v_exp_f32 v41, v41
    v_mul_f32 v49, v105, v109
    v_mfma_f32_16x16x32_bf16 v[204:207], v[28:31], a[16:19], v[204:207]
    ds_read_b128 v[24:27], v3 offset:8192
    v_mul_f32 v42, v8, v106
    v_mfma_f32_16x16x32_bf16 v[212:215], v[28:31], a[20:23], v[212:215]
    v_exp_f32 v42, v42
    v_mul_f32 v50, v106, v110
    v_mfma_f32_16x16x32_bf16 v[220:223], v[28:31], a[24:27], v[220:223]
    buffer_load_dwordx4 v2, s[12:15], s27 offen offset:2048 sc1 lds
    v_mfma_f32_16x16x32_bf16 v[228:231], v[28:31], a[28:31], v[228:231]
    v_mul_f32 v43, v8, v107
    s_waitcnt lgkmcnt(3)
    v_mfma_f32_16x16x32_bf16 v[200:203], v[32:35], a[32:35], v[200:203]
    ds_read_b128 v[28:31], v3 offset:9216
    v_mul_f32 v51, v107, v111
    v_mfma_f32_16x16x32_bf16 v[208:211], v[32:35], a[36:39], v[208:211]
    v_exp_f32 v43, v43
    v_fma_f32 v40, v40, v12, v12
    v_mfma_f32_16x16x32_bf16 v[216:219], v[32:35], a[40:43], v[216:219]
    buffer_load_dwordx4 v2, s[12:15], s27 offen offset:3072 sc1 lds
    v_mfma_f32_16x16x32_bf16 v[224:227], v[32:35], a[44:47], v[224:227]
    v_rcp_f32 v40, v40
    v_mul_f32 v44, v9, v112
    v_mfma_f32_16x16x32_bf16 v[204:207], v[36:39], a[32:35], v[204:207]
    ds_read_b128 v[32:35], v3 offset:10240
    v_mul_f32 v52, v112, v116
    v_mfma_f32_16x16x32_bf16 v[212:215], v[36:39], a[36:39], v[212:215]
    s_add_u32 m0, s49, 4096
    s_add_u32 s27, s48, 4096
    v_mfma_f32_16x16x32_bf16 v[220:223], v[36:39], a[40:43], v[220:223]
    buffer_load_dwordx4 v2, s[12:15], s27 offen offset:0 sc1 lds
    v_mfma_f32_16x16x32_bf16 v[228:231], v[36:39], a[44:47], v[228:231]
    v_fma_f32 v41, v41, v12, v12
    s_waitcnt lgkmcnt(3)
    v_mfma_f32_16x16x32_bf16 v[200:203], v[16:19], a[48:51], v[200:203]
    ds_read_b128 v[36:39], v3 offset:11264
    v_mul_f32 v45, v9, v113
    v_mfma_f32_16x16x32_bf16 v[208:211], v[16:19], a[52:55], v[208:211]
    v_exp_f32 v44, v44
    v_mul_f32 v53, v113, v117
    v_mfma_f32_16x16x32_bf16 v[216:219], v[16:19], a[56:59], v[216:219]
    buffer_load_dwordx4 v2, s[12:15], s27 offen offset:1024 sc1 lds
    v_mfma_f32_16x16x32_bf16 v[224:227], v[16:19], a[60:63], v[224:227]
    v_rcp_f32 v41, v41
    v_fma_f32 v42, v42, v12, v12
    v_mfma_f32_16x16x32_bf16 v[204:207], v[20:23], a[48:51], v[204:207]
    ds_read_b128 v[16:19], v3 offset:12288
    v_mul_f32 v46, v9, v114
    v_mfma_f32_16x16x32_bf16 v[212:215], v[20:23], a[52:55], v[212:215]
    v_exp_f32 v45, v45
    v_mul_f32 v54, v114, v118
    v_mfma_f32_16x16x32_bf16 v[220:223], v[20:23], a[56:59], v[220:223]
    buffer_load_dwordx4 v2, s[12:15], s27 offen offset:2048 sc1 lds
    v_mfma_f32_16x16x32_bf16 v[228:231], v[20:23], a[60:63], v[228:231]
    v_fma_f32 v43, v43, v12, v12
    s_waitcnt lgkmcnt(3)
    v_mfma_f32_16x16x32_bf16 v[200:203], v[24:27], a[64:67], v[200:203]
    ds_read_b128 v[20:23], v3 offset:13312
    v_mul_f32 v48, v48, v40
    v_mfma_f32_16x16x32_bf16 v[208:211], v[24:27], a[68:71], v[208:211]
    v_rcp_f32 v42, v42
    v_mul_f32 v47, v9, v115
    v_mfma_f32_16x16x32_bf16 v[216:219], v[24:27], a[72:75], v[216:219]
    buffer_load_dwordx4 v2, s[12:15], s27 offen offset:3072 sc1 lds
    v_mfma_f32_16x16x32_bf16 v[224:227], v[24:27], a[76:79], v[224:227]
    v_exp_f32 v46, v46
    v_mul_f32 v55, v115, v119
    v_mfma_f32_16x16x32_bf16 v[204:207], v[28:31], a[64:67], v[204:207]
    ds_read_b128 v[24:27], v3 offset:14336
    v_fma_f32 v44, v44, v13, v13
    v_mfma_f32_16x16x32_bf16 v[212:215], v[28:31], a[68:71], v[212:215]
    s_add_u32 m0, s49, 8192
    s_add_u32 s27, s48, 8192
    v_mfma_f32_16x16x32_bf16 v[220:223], v[28:31], a[72:75], v[220:223]
    buffer_load_dwordx4 v2, s[12:15], s27 offen offset:0 sc1 lds
    v_mfma_f32_16x16x32_bf16 v[228:231], v[28:31], a[76:79], v[228:231]
    s_add_u32 s48, s48, 36864
    s_add_u32 s49, s49, 36864
    s_cmp_ge_u32 s49, 147456
    s_cselect_b32 s27, 147456, 0
    s_sub_u32 s49, s49, s27
    s_waitcnt lgkmcnt(3)
    v_mfma_f32_16x16x32_bf16 v[200:203], v[32:35], a[80:83], v[200:203]
    ds_read_b128 v[28:31], v3 offset:15360
    v_mul_f32 v49, v49, v41
    v_mfma_f32_16x16x32_bf16 v[208:211], v[32:35], a[84:87], v[208:211]
    v_rcp_f32 v43, v43
    v_fma_f32 v45, v45, v13, v13
    v_mfma_f32_16x16x32_bf16 v[216:219], v[32:35], a[88:91], v[216:219]
    v_exp_f32 v47, v47
    v_mul_f32 v50, v50, v42
    v_mfma_f32_16x16x32_bf16 v[224:227], v[32:35], a[92:95], v[224:227]
    v_rcp_f32 v44, v44
    v_fma_f32 v46, v46, v13, v13
    v_mfma_f32_16x16x32_bf16 v[204:207], v[36:39], a[80:83], v[204:207]
    ds_read_b128 v[32:35], v3 offset:16384
    v_mul_f32 v51, v51, v43
    v_mfma_f32_16x16x32_bf16 v[212:215], v[36:39], a[84:87], v[212:215]
    v_rcp_f32 v45, v45
    v_fma_f32 v47, v47, v13, v13
    v_mfma_f32_16x16x32_bf16 v[220:223], v[36:39], a[88:91], v[220:223]
    v_rcp_f32 v46, v46
    v_mul_f32 v52, v52, v44
    v_mfma_f32_16x16x32_bf16 v[228:231], v[36:39], a[92:95], v[228:231]
    v_mul_f32 v53, v53, v45
    s_waitcnt lgkmcnt(3)
    v_mfma_f32_16x16x32_bf16 v[200:203], v[16:19], a[96:99], v[200:203]
    ds_read_b128 v[36:39], v3 offset:17408
    v_mul_f32 v54, v54, v46
    v_mfma_f32_16x16x32_bf16 v[208:211], v[16:19], a[100:103], v[208:211]
    s_add_u32 m0, s49, 0
    s_add_u32 s27, s48, 0
    v_mfma_f32_16x16x32_bf16 v[216:219], v[16:19], a[104:107], v[216:219]
    buffer_load_dwordx4 v2, s[12:15], s27 offen offset:0 sc1 lds
    v_mfma_f32_16x16x32_bf16 v[224:227], v[16:19], a[108:111], v[224:227]
    v_rcp_f32 v47, v47
    v_cvt_pk_bf16_f32 v40, v48, v49
    v_mfma_f32_16x16x32_bf16 v[204:207], v[20:23], a[96:99], v[204:207]
    ds_read_b128 v[16:19], v3 offset:18432
    v_mul_f32 v55, v55, v47
    v_mfma_f32_16x16x32_bf16 v[212:215], v[20:23], a[100:103], v[212:215]
    v_cvt_pk_bf16_f32 v42, v52, v53
    v_cvt_pk_bf16_f32 v41, v50, v51
    v_cvt_pk_bf16_f32 v43, v54, v55
    v_mfma_f32_16x16x32_bf16 v[220:223], v[20:23], a[104:107], v[220:223]
    v_permlane16_swap_b32 v40, v42
    v_permlane16_swap_b32 v41, v43
    v_mul_f32 v56, v10, v120
    v_mfma_f32_16x16x32_bf16 v[228:231], v[20:23], a[108:111], v[228:231]
    v_mul_f32 v64, v120, v124
    s_waitcnt lgkmcnt(3)
    v_mfma_f32_16x16x32_bf16 v[200:203], v[24:27], a[112:115], v[200:203]
    ds_read_b128 v[20:23], v3 offset:19456
    v_mul_f32 v57, v10, v121
    v_mfma_f32_16x16x32_bf16 v[208:211], v[24:27], a[116:119], v[208:211]
    buffer_store_dwordx4 v[40:43], v5, s[12:15], s30 offen sc1
    s_add_u32 s30, s30, 4096
    v_mfma_f32_16x16x32_bf16 v[216:219], v[24:27], a[120:123], v[216:219]
    buffer_load_dwordx4 v2, s[12:15], s27 offen offset:1024 sc1 lds
    v_mfma_f32_16x16x32_bf16 v[224:227], v[24:27], a[124:127], v[224:227]
    v_exp_f32 v56, v56
    v_mul_f32 v65, v121, v125
    v_mfma_f32_16x16x32_bf16 v[204:207], v[28:31], a[112:115], v[204:207]
    ds_read_b128 v[24:27], v3 offset:20480
    v_mul_f32 v58, v10, v122
    v_mfma_f32_16x16x32_bf16 v[212:215], v[28:31], a[116:119], v[212:215]
    v_exp_f32 v57, v57
    v_mul_f32 v66, v122, v126
    v_mfma_f32_16x16x32_bf16 v[220:223], v[28:31], a[120:123], v[220:223]
    v_exp_f32 v58, v58
    v_mul_f32 v59, v10, v123
    v_mfma_f32_16x16x32_bf16 v[228:231], v[28:31], a[124:127], v[228:231]
    v_mul_f32 v67, v123, v127
    s_waitcnt lgkmcnt(3)
    v_mfma_f32_16x16x32_bf16 v[200:203], v[32:35], a[128:131], v[200:203]
    ds_read_b128 v[28:31], v3 offset:21504
    v_fma_f32 v56, v56, v14, v14
    v_mfma_f32_16x16x32_bf16 v[208:211], v[32:35], a[132:135], v[208:211]
    v_exp_f32 v59, v59
    v_mul_f32 v60, v11, v128
    v_mfma_f32_16x16x32_bf16 v[216:219], v[32:35], a[136:139], v[216:219]
    buffer_load_dwordx4 v2, s[12:15], s27 offen offset:2048 sc1 lds
    v_mfma_f32_16x16x32_bf16 v[224:227], v[32:35], a[140:143], v[224:227]
    v_rcp_f32 v56, v56
    v_mul_f32 v68, v128, v132
    v_mfma_f32_16x16x32_bf16 v[204:207], v[36:39], a[128:131], v[204:207]
    ds_read_b128 v[32:35], v3 offset:22528
    v_fma_f32 v57, v57, v14, v14
    v_mfma_f32_16x16x32_bf16 v[212:215], v[36:39], a[132:135], v[212:215]
    v_exp_f32 v60, v60
    v_mul_f32 v61, v11, v129
    v_mfma_f32_16x16x32_bf16 v[220:223], v[36:39], a[136:139], v[220:223]
    v_rcp_f32 v57, v57
    v_mul_f32 v69, v129, v133
    v_mfma_f32_16x16x32_bf16 v[228:231], v[36:39], a[140:143], v[228:231]
    v_fma_f32 v58, v58, v14, v14
    s_waitcnt lgkmcnt(3)
    v_mfma_f32_16x16x32_bf16 v[200:203], v[16:19], a[144:147], v[200:203]
    ds_read_b128 v[36:39], v3 offset:23552
    v_mul_f32 v62, v11, v130
    v_mfma_f32_16x16x32_bf16 v[208:211], v[16:19], a[148:151], v[208:211]
    v_exp_f32 v61, v61
    v_mul_f32 v70, v130, v134
    v_mfma_f32_16x16x32_bf16 v[216:219], v[16:19], a[152:155], v[216:219]
    buffer_load_dwordx4 v2, s[12:15], s27 offen offset:3072 sc1 lds
    v_mfma_f32_16x16x32_bf16 v[224:227], v[16:19], a[156:159], v[224:227]
    v_rcp_f32 v58, v58
    v_fma_f32 v59, v59, v14, v14
    v_mfma_f32_16x16x32_bf16 v[204:207], v[20:23], a[144:147], v[204:207]
    ds_read_b128 v[16:19], v3 offset:24576
    v_mul_f32 v64, v64, v56
    v_mfma_f32_16x16x32_bf16 v[212:215], v[20:23], a[148:151], v[212:215]
    v_exp_f32 v62, v62
    v_mul_f32 v63, v11, v131
    v_mfma_f32_16x16x32_bf16 v[220:223], v[20:23], a[152:155], v[220:223]
    v_rcp_f32 v59, v59
    v_mul_f32 v71, v131, v135
    v_mfma_f32_16x16x32_bf16 v[228:231], v[20:23], a[156:159], v[228:231]
    v_fma_f32 v60, v60, v15, v15
    s_waitcnt lgkmcnt(3)
    v_mfma_f32_16x16x32_bf16 v[200:203], v[24:27], a[160:163], v[200:203]
    ds_read_b128 v[20:23], v3 offset:25600
    v_mul_f32 v65, v65, v57
    v_mfma_f32_16x16x32_bf16 v[208:211], v[24:27], a[164:167], v[208:211]
    s_add_u32 m0, s49, 4096
    s_add_u32 s27, s48, 4096
    v_mfma_f32_16x16x32_bf16 v[216:219], v[24:27], a[168:171], v[216:219]
    buffer_load_dwordx4 v2, s[12:15], s27 offen offset:0 sc1 lds
    v_mfma_f32_16x16x32_bf16 v[224:227], v[24:27], a[172:175], v[224:227]
    v_exp_f32 v63, v63
    v_fma_f32 v61, v61, v15, v15
    v_mfma_f32_16x16x32_bf16 v[204:207], v[28:31], a[160:163], v[204:207]
    ds_read_b128 v[24:27], v3 offset:26624
    v_mul_f32 v66, v66, v58
    v_mfma_f32_16x16x32_bf16 v[212:215], v[28:31], a[164:167], v[212:215]
    v_rcp_f32 v60, v60
    v_fma_f32 v62, v62, v15, v15
    v_mfma_f32_16x16x32_bf16 v[220:223], v[28:31], a[168:171], v[220:223]
    v_rcp_f32 v61, v61
    v_mul_f32 v67, v67, v59
    v_mfma_f32_16x16x32_bf16 v[228:231], v[28:31], a[172:175], v[228:231]
    v_fma_f32 v63, v63, v15, v15
    s_waitcnt lgkmcnt(3)
    v_mfma_f32_16x16x32_bf16 v[200:203], v[32:35], a[176:179], v[200:203]
    ds_read_b128 v[28:31], v3 offset:27648
    v_mul_f32 v68, v68, v60
    v_mfma_f32_16x16x32_bf16 v[208:211], v[32:35], a[180:183], v[208:211]
    v_rcp_f32 v62, v62
    v_mul_f32 v69, v69, v61
    v_mfma_f32_16x16x32_bf16 v[216:219], v[32:35], a[184:187], v[216:219]
    buffer_load_dwordx4 v2, s[12:15], s27 offen offset:1024 sc1 lds
    v_mfma_f32_16x16x32_bf16 v[224:227], v[32:35], a[188:191], v[224:227]
    v_rcp_f32 v63, v63
    v_mul_f32 v70, v70, v62
    v_mfma_f32_16x16x32_bf16 v[204:207], v[36:39], a[176:179], v[204:207]
    ds_read_b128 v[32:35], v3 offset:28672
    v_mul_f32 v71, v71, v63
    v_mfma_f32_16x16x32_bf16 v[212:215], v[36:39], a[180:183], v[212:215]
    v_cvt_pk_bf16_f32 v56, v64, v65
    v_cvt_pk_bf16_f32 v58, v68, v69
    v_cvt_pk_bf16_f32 v57, v66, v67
    v_mfma_f32_16x16x32_bf16 v[220:223], v[36:39], a[184:187], v[220:223]
    v_cvt_pk_bf16_f32 v59, v70, v71
    v_permlane16_swap_b32 v56, v58
    v_mul_f32 v40, v8, v136
    v_mfma_f32_16x16x32_bf16 v[228:231], v[36:39], a[188:191], v[228:231]
    v_permlane16_swap_b32 v57, v59
    s_waitcnt lgkmcnt(3)
    v_mfma_f32_16x16x32_bf16 v[200:203], v[16:19], a[192:195], v[200:203]
    ds_read_b128 v[36:39], v3 offset:29696
    v_mul_f32 v48, v136, v140
    v_mfma_f32_16x16x32_bf16 v[208:211], v[16:19], a[196:199], v[208:211]
    buffer_store_dwordx4 v[56:59], v5, s[12:15], s31 offen sc1
    s_add_u32 s31, s31, 4096
    v_mfma_f32_16x16x32_bf16 v[216:219], v[16:19], a[200:203], v[216:219]
    buffer_load_dwordx4 v2, s[12:15], s27 offen offset:2048 sc1 lds
    v_mfma_f32_16x16x32_bf16 v[224:227], v[16:19], a[204:207], v[224:227]
    v_exp_f32 v40, v40
    v_mul_f32 v41, v8, v137
    v_mfma_f32_16x16x32_bf16 v[204:207], v[20:23], a[192:195], v[204:207]
    ds_read_b128 v[16:19], v3 offset:30720
    v_mul_f32 v49, v137, v141
    v_mfma_f32_16x16x32_bf16 v[212:215], v[20:23], a[196:199], v[212:215]
    v_exp_f32 v41, v41
    v_mul_f32 v42, v8, v138
    v_mfma_f32_16x16x32_bf16 v[220:223], v[20:23], a[200:203], v[220:223]
    v_exp_f32 v42, v42
    v_mul_f32 v50, v138, v142
    v_mfma_f32_16x16x32_bf16 v[228:231], v[20:23], a[204:207], v[228:231]
    v_mul_f32 v43, v8, v139
    s_waitcnt lgkmcnt(3)
    v_mfma_f32_16x16x32_bf16 v[200:203], v[24:27], a[208:211], v[200:203]
    ds_read_b128 v[20:23], v3 offset:31744
    v_mul_f32 v51, v139, v143
    v_mfma_f32_16x16x32_bf16 v[208:211], v[24:27], a[212:215], v[208:211]
    v_exp_f32 v43, v43
    v_fma_f32 v40, v40, v12, v12
    v_mfma_f32_16x16x32_bf16 v[216:219], v[24:27], a[216:219], v[216:219]
    buffer_load_dwordx4 v2, s[12:15], s27 offen offset:3072 sc1 lds
    v_mfma_f32_16x16x32_bf16 v[224:227], v[24:27], a[220:223], v[224:227]
    v_rcp_f32 v40, v40
    v_mul_f32 v44, v9, v144
    v_mfma_f32_16x16x32_bf16 v[204:207], v[28:31], a[208:211], v[204:207]
    ds_read_b128 v[24:27], v3 offset:32768
    v_mul_f32 v52, v144, v148
    v_mfma_f32_16x16x32_bf16 v[212:215], v[28:31], a[212:215], v[212:215]
    v_exp_f32 v44, v44
    v_fma_f32 v41, v41, v12, v12
    v_mfma_f32_16x16x32_bf16 v[220:223], v[28:31], a[216:219], v[220:223]
    v_rcp_f32 v41, v41
    v_mul_f32 v45, v9, v145
    v_mfma_f32_16x16x32_bf16 v[228:231], v[28:31], a[220:223], v[228:231]
    v_mul_f32 v53, v145, v149
    s_waitcnt lgkmcnt(3)
    v_mfma_f32_16x16x32_bf16 v[200:203], v[32:35], a[224:227], v[200:203]
    ds_read_b128 v[28:31], v3 offset:33792
    v_fma_f32 v42, v42, v12, v12
    v_mfma_f32_16x16x32_bf16 v[208:211], v[32:35], a[228:231], v[208:211]
    s_add_u32 m0, s49, 8192
    s_add_u32 s27, s48, 8192
    v_mfma_f32_16x16x32_bf16 v[216:219], v[32:35], a[232:235], v[216:219]
    buffer_load_dwordx4 v2, s[12:15], s27 offen offset:0 sc1 lds
    v_mfma_f32_16x16x32_bf16 v[224:227], v[32:35], a[236:239], v[224:227]
    s_add_u32 s48, s48, 36864
    s_add_u32 s49, s49, 36864
    s_cmp_ge_u32 s49, 147456
    s_cselect_b32 s27, 147456, 0
    s_sub_u32 s49, s49, s27
    v_mfma_f32_16x16x32_bf16 v[204:207], v[36:39], a[224:227], v[204:207]
    ds_read_b128 v[32:35], v3 offset:34816
    v_mul_f32 v46, v9, v146
    v_mfma_f32_16x16x32_bf16 v[212:215], v[36:39], a[228:231], v[212:215]
    v_exp_f32 v45, v45
    v_mul_f32 v54, v146, v150
    v_mfma_f32_16x16x32_bf16 v[220:223], v[36:39], a[232:235], v[220:223]
    v_rcp_f32 v42, v42
    v_fma_f32 v43, v43, v12, v12
    v_mfma_f32_16x16x32_bf16 v[228:231], v[36:39], a[236:239], v[228:231]
    v_mul_f32 v48, v48, v40
    s_waitcnt lgkmcnt(3)
    v_mfma_f32_16x16x32_bf16 v[200:203], v[16:19], a[240:243], v[200:203]
    ds_read_b128 v[36:39], v3 offset:35840
    v_mul_f32 v47, v9, v147
    v_mfma_f32_16x16x32_bf16 v[208:211], v[16:19], a[244:247], v[208:211]
    v_exp_f32 v46, v46
    v_mul_f32 v55, v147, v151
    v_mfma_f32_16x16x32_bf16 v[216:219], v[16:19], a[248:251], v[216:219]
    v_rcp_f32 v43, v43
    v_fma_f32 v44, v44, v13, v13
    v_mfma_f32_16x16x32_bf16 v[224:227], v[16:19], a[252:255], v[224:227]
    s_waitcnt vmcnt(11)
    s_barrier
    v_mfma_f32_16x16x32_bf16 v[204:207], v[20:23], a[240:243], v[204:207]
    ds_read_b128 v[16:19], v4 offset:0
    v_mul_f32 v49, v49, v41
    v_mfma_f32_16x16x32_bf16 v[212:215], v[20:23], a[244:247], v[212:215]
    v_exp_f32 v47, v47
    v_fma_f32 v45, v45, v13, v13
    v_mfma_f32_16x16x32_bf16 v[220:223], v[20:23], a[248:251], v[220:223]
    v_rcp_f32 v44, v44
    v_mul_f32 v50, v50, v42
    v_mfma_f32_16x16x32_bf16 v[228:231], v[20:23], a[252:255], v[228:231]
    v_fma_f32 v46, v46, v13, v13
    s_waitcnt lgkmcnt(3)
    v_mfma_f32_16x16x32_bf16 v[200:203], v[24:27], v[72:75], v[200:203]
    ds_read_b128 v[20:23], v4 offset:1024
    v_mul_f32 v51, v51, v43
    v_mfma_f32_16x16x32_bf16 v[208:211], v[24:27], v[76:79], v[208:211]
    v_rcp_f32 v45, v45
    v_fma_f32 v47, v47, v13, v13
    v_mfma_f32_16x16x32_bf16 v[216:219], v[24:27], v[80:83], v[216:219]
    v_rcp_f32 v46, v46
    v_mul_f32 v52, v52, v44
    v_mfma_f32_16x16x32_bf16 v[224:227], v[24:27], v[84:87], v[224:227]
    v_rcp_f32 v47, v47
    v_mul_f32 v53, v53, v45
    v_mfma_f32_16x16x32_bf16 v[204:207], v[28:31], v[72:75], v[204:207]
    ds_read_b128 v[24:27], v4 offset:2048
    v_mul_f32 v54, v54, v46
    v_mfma_f32_16x16x32_bf16 v[212:215], v[28:31], v[76:79], v[212:215]
    v_mul_f32 v55, v55, v47
    v_cvt_pk_bf16_f32 v40, v48, v49
    v_cvt_pk_bf16_f32 v42, v52, v53
    v_mfma_f32_16x16x32_bf16 v[220:223], v[28:31], v[80:83], v[220:223]
    v_cvt_pk_bf16_f32 v41, v50, v51
    v_cvt_pk_bf16_f32 v43, v54, v55
    v_permlane16_swap_b32 v40, v42
    v_mfma_f32_16x16x32_bf16 v[228:231], v[28:31], v[84:87], v[228:231]
    v_permlane16_swap_b32 v41, v43
    s_waitcnt lgkmcnt(3)
    v_mfma_f32_16x16x32_bf16 v[200:203], v[32:35], v[88:91], v[200:203]
    ds_read_b128 v[28:31], v4 offset:3072
    v_mul_f32 v56, v10, v152
    v_mfma_f32_16x16x32_bf16 v[208:211], v[32:35], v[92:95], v[208:211]
    buffer_store_dwordx4 v[40:43], v5, s[12:15], s30 offen sc1
    s_add_u32 s30, s30, 4096
    v_mfma_f32_16x16x32_bf16 v[216:219], v[32:35], v[96:99], v[216:219]
    v_exp_f32 v56, v56
    v_mul_f32 v64, v152, v156
    v_mfma_f32_16x16x32_bf16 v[224:227], v[32:35], v[100:103], v[224:227]
    v_mul_f32 v57, v10, v153
    v_mul_f32 v65, v153, v157
    v_mul_f32 v58, v10, v154
    v_mfma_f32_16x16x32_bf16 v[204:207], v[36:39], v[88:91], v[204:207]
    ds_read_b128 v[32:35], v4 offset:4096
    v_mfma_f32_16x16x32_bf16 v[212:215], v[36:39], v[92:95], v[212:215]
    v_exp_f32 v57, v57
    v_mfma_f32_16x16x32_bf16 v[220:223], v[36:39], v[96:99], v[220:223]
    v_mfma_f32_16x16x32_bf16 v[228:231], v[36:39], v[100:103], v[228:231]
    v_mul_f32 v66, v154, v158
    v_exp_f32 v58, v58
    v_mul_f32 v59, v10, v155
    v_mul_f32 v67, v155, v159
    v_fma_f32 v56, v56, v14, v14
    v_exp_f32 v59, v59
    v_mul_f32 v60, v11, v160
    v_mul_f32 v68, v160, v164
    v_rcp_f32 v56, v56
    v_fma_f32 v57, v57, v14, v14
    v_exp_f32 v60, v60
    v_mul_f32 v61, v11, v161
    v_mul_f32 v69, v161, v165
    v_rcp_f32 v57, v57
    v_fma_f32 v58, v58, v14, v14
    v_exp_f32 v61, v61
    v_mul_f32 v62, v11, v162
    v_mul_f32 v70, v162, v166
    v_rcp_f32 v58, v58
    v_fma_f32 v59, v59, v14, v14
    v_mul_f32 v64, v64, v56
    v_exp_f32 v62, v62
    v_mul_f32 v63, v11, v163
    v_mul_f32 v71, v163, v167
    v_rcp_f32 v59, v59
    v_fma_f32 v60, v60, v15, v15
    v_mul_f32 v65, v65, v57
    v_exp_f32 v63, v63
    v_rcp_f32 v60, v60
    v_fma_f32 v61, v61, v15, v15
    v_mul_f32 v66, v66, v58
    v_rcp_f32 v61, v61
    v_fma_f32 v62, v62, v15, v15
    v_mul_f32 v67, v67, v59
    v_rcp_f32 v62, v62
    v_fma_f32 v63, v63, v15, v15
    v_mul_f32 v68, v68, v60
    v_rcp_f32 v63, v63
    v_mul_f32 v69, v69, v61
    v_mul_f32 v70, v70, v62
    v_mul_f32 v71, v71, v63
    v_cvt_pk_bf16_f32 v56, v64, v65
    v_cvt_pk_bf16_f32 v58, v68, v69
    v_cvt_pk_bf16_f32 v57, v66, v67
    v_cvt_pk_bf16_f32 v59, v70, v71
    v_permlane16_swap_b32 v56, v58
    s_nop 0
    v_permlane16_swap_b32 v57, v59
    buffer_store_dwordx4 v[56:59], v5, s[12:15], s31 offen sc1
    s_add_u32 s31, s31, 4096
    v_mov_b32 v3, v4
    v_add_u32 v4, s33, v2
    s_add_u32 s33, s33, 36864
    s_cmp_ge_u32 s33, 147456
    s_cselect_b32 s33, 0, s33
    s_waitcnt lgkmcnt(3)
    v_mfma_f32_16x16x32_bf16 v[104:107], v[16:19], a[0:3], 0
    ds_read_b128 v[36:39], v3 offset:5120
    v_mfma_f32_16x16x32_bf16 v[112:115], v[16:19], a[4:7], 0
    v_mfma_f32_16x16x32_bf16 v[120:123], v[16:19], a[8:11], 0
    v_mfma_f32_16x16x32_bf16 v[128:131], v[16:19], a[12:15], 0
    v_mfma_f32_16x16x32_bf16 v[108:111], v[20:23], a[0:3], 0
    ds_read_b128 v[16:19], v3 offset:6144
    v_mfma_f32_16x16x32_bf16 v[116:119], v[20:23], a[4:7], 0
    v_mfma_f32_16x16x32_bf16 v[124:127], v[20:23], a[8:11], 0
    v_mul_f32 v40, v8, v168
    v_mul_f32 v48, v168, v172
    v_mul_f32 v41, v8, v169
    v_mfma_f32_16x16x32_bf16 v[132:135], v[20:23], a[12:15], 0
    v_mul_f32 v49, v169, v173
    s_waitcnt lgkmcnt(3)
    v_mfma_f32_16x16x32_bf16 v[104:107], v[24:27], a[16:19], v[104:107]
    ds_read_b128 v[20:23], v3 offset:7168
    v_mul_f32 v42, v8, v170
    v_mfma_f32_16x16x32_bf16 v[112:115], v[24:27], a[20:23], v[112:115]
    s_add_u32 m0, s49, 0
    s_add_u32 s27, s48, 0
    v_mfma_f32_16x16x32_bf16 v[120:123], v[24:27], a[24:27], v[120:123]
    buffer_load_dwordx4 v2, s[12:15], s27 offen offset:0 sc1 lds
    v_mfma_f32_16x16x32_bf16 v[128:131], v[24:27], a[28:31], v[128:131]
    v_exp_f32 v40, v40
    v_mul_f32 v50, v170, v174
    v_mfma_f32_16x16x32_bf16 v[108:111], v[28:31], a[16:19], v[108:111]
    ds_read_b128 v[24:27], v3 offset:8192
    v_mul_f32 v43, v8, v171
    v_mfma_f32_16x16x32_bf16 v[116:119], v[28:31], a[20:23], v[116:119]
    v_exp_f32 v41, v41
    v_mul_f32 v51, v171, v175
    v_mfma_f32_16x16x32_bf16 v[124:127], v[28:31], a[24:27], v[124:127]
    v_exp_f32 v42, v42
    v_fma_f32 v40, v40, v12, v12
    v_mfma_f32_16x16x32_bf16 v[132:135], v[28:31], a[28:31], v[132:135]
    v_mul_f32 v44, v9, v176
    s_waitcnt lgkmcnt(3)
    v_mfma_f32_16x16x32_bf16 v[104:107], v[32:35], a[32:35], v[104:107]
    ds_read_b128 v[28:31], v3 offset:9216
    v_mul_f32 v52, v176, v180
    v_mfma_f32_16x16x32_bf16 v[112:115], v[32:35], a[36:39], v[112:115]
    v_exp_f32 v43, v43
    v_fma_f32 v41, v41, v12, v12
    v_mfma_f32_16x16x32_bf16 v[120:123], v[32:35], a[40:43], v[120:123]
    v_rcp_f32 v40, v40
    v_mul_f32 v45, v9, v177
    v_mfma_f32_16x16x32_bf16 v[128:131], v[32:35], a[44:47], v[128:131]
    v_exp_f32 v44, v44
    v_mul_f32 v53, v177, v181
    v_mfma_f32_16x16x32_bf16 v[108:111], v[36:39], a[32:35], v[108:111]
    ds_read_b128 v[32:35], v3 offset:10240
    v_fma_f32 v42, v42, v12, v12
    v_mfma_f32_16x16x32_bf16 v[116:119], v[36:39], a[36:39], v[116:119]
    v_rcp_f32 v41, v41
    v_mul_f32 v46, v9, v178
    v_mfma_f32_16x16x32_bf16 v[124:127], v[36:39], a[40:43], v[124:127]
    buffer_load_dwordx4 v2, s[12:15], s27 offen offset:1024 sc1 lds
    v_mfma_f32_16x16x32_bf16 v[132:135], v[36:39], a[44:47], v[132:135]
    v_mul_f32 v54, v178, v182
    s_waitcnt lgkmcnt(3)
    v_mfma_f32_16x16x32_bf16 v[104:107], v[16:19], a[48:51], v[104:107]
    ds_read_b128 v[36:39], v3 offset:11264
    v_fma_f32 v43, v43, v12, v12
    v_mfma_f32_16x16x32_bf16 v[112:115], v[16:19], a[52:55], v[112:115]
    v_exp_f32 v45, v45
    v_mul_f32 v48, v48, v40
    v_mfma_f32_16x16x32_bf16 v[120:123], v[16:19], a[56:59], v[120:123]
    v_rcp_f32 v42, v42
    v_mul_f32 v47, v9, v179
    v_mfma_f32_16x16x32_bf16 v[128:131], v[16:19], a[60:63], v[128:131]
    v_exp_f32 v46, v46
    v_mul_f32 v55, v179, v183
    v_mfma_f32_16x16x32_bf16 v[108:111], v[20:23], a[48:51], v[108:111]
    ds_read_b128 v[16:19], v3 offset:12288
    v_fma_f32 v44, v44, v13, v13
    v_mfma_f32_16x16x32_bf16 v[116:119], v[20:23], a[52:55], v[116:119]
    v_rcp_f32 v43, v43
    v_mul_f32 v49, v49, v41
    v_mfma_f32_16x16x32_bf16 v[124:127], v[20:23], a[56:59], v[124:127]
    v_exp_f32 v47, v47
    v_fma_f32 v45, v45, v13, v13
    v_mfma_f32_16x16x32_bf16 v[132:135], v[20:23], a[60:63], v[132:135]
    v_mul_f32 v50, v50, v42
    s_waitcnt lgkmcnt(3)
    v_mfma_f32_16x16x32_bf16 v[104:107], v[24:27], a[64:67], v[104:107]
    ds_read_b128 v[20:23], v3 offset:13312
    v_fma_f32 v46, v46, v13, v13
    v_mfma_f32_16x16x32_bf16 v[112:115], v[24:27], a[68:71], v[112:115]
    v_rcp_f32 v44, v44
    v_mul_f32 v51, v51, v43
    v_mfma_f32_16x16x32_bf16 v[120:123], v[24:27], a[72:75], v[120:123]
    buffer_load_dwordx4 v2, s[12:15], s27 offen offset:2048 sc1 lds
    v_mfma_f32_16x16x32_bf16 v[128:131], v[24:27], a[76:79], v[128:131]
    v_rcp_f32 v45, v45
    v_fma_f32 v47, v47, v13, v13
    v_mfma_f32_16x16x32_bf16 v[108:111], v[28:31], a[64:67], v[108:111]
    ds_read_b128 v[24:27], v3 offset:14336
    v_mul_f32 v52, v52, v44
    v_mfma_f32_16x16x32_bf16 v[116:119], v[28:31], a[68:71], v[116:119]
    v_rcp_f32 v46, v46
    v_mul_f32 v53, v53, v45
    v_mfma_f32_16x16x32_bf16 v[124:127], v[28:31], a[72:75], v[124:127]
    v_rcp_f32 v47, v47
    v_mul_f32 v54, v54, v46
    v_mfma_f32_16x16x32_bf16 v[132:135], v[28:31], a[76:79], v[132:135]
    v_mul_f32 v55, v55, v47
    s_waitcnt lgkmcnt(3)
    v_mfma_f32_16x16x32_bf16 v[104:107], v[32:35], a[80:83], v[104:107]
    ds_read_b128 v[28:31], v3 offset:15360
    v_cvt_pk_bf16_f32 v40, v48, v49
    v_mfma_f32_16x16x32_bf16 v[112:115], v[32:35], a[84:87], v[112:115]
    v_cvt_pk_bf16_f32 v42, v52, v53
    v_cvt_pk_bf16_f32 v41, v50, v51
    v_cvt_pk_bf16_f32 v43, v54, v55
    v_mfma_f32_16x16x32_bf16 v[120:123], v[32:35], a[88:91], v[120:123]
    v_permlane16_swap_b32 v40, v42
    v_permlane16_swap_b32 v41, v43
    v_mul_f32 v56, v10, v184
    v_mfma_f32_16x16x32_bf16 v[128:131], v[32:35], a[92:95], v[128:131]
    buffer_store_dwordx4 v[40:43], v5, s[12:15], s30 offen sc1
    s_add_u32 s30, s30, 4096
    v_mfma_f32_16x16x32_bf16 v[108:111], v[36:39], a[80:83], v[108:111]
    ds_read_b128 v[32:35], v3 offset:16384
    v_mul_f32 v64, v184, v188
    v_mfma_f32_16x16x32_bf16 v[116:119], v[36:39], a[84:87], v[116:119]
    v_exp_f32 v56, v56
    v_mul_f32 v57, v10, v185
    v_mfma_f32_16x16x32_bf16 v[124:127], v[36:39], a[88:91], v[124:127]
    buffer_load_dwordx4 v2, s[12:15], s27 offen offset:3072 sc1 lds
    v_mfma_f32_16x16x32_bf16 v[132:135], v[36:39], a[92:95], v[132:135]
    v_mul_f32 v65, v185, v189
    s_waitcnt lgkmcnt(3)
    v_mfma_f32_16x16x32_bf16 v[104:107], v[16:19], a[96:99], v[104:107]
    ds_read_b128 v[36:39], v3 offset:17408
    v_mul_f32 v58, v10, v186
    v_mfma_f32_16x16x32_bf16 v[112:115], v[16:19], a[100:103], v[112:115]
    v_exp_f32 v57, v57
    v_mul_f32 v66, v186, v190
    v_mfma_f32_16x16x32_bf16 v[120:123], v[16:19], a[104:107], v[120:123]
    v_exp_f32 v58, v58
    v_mul_f32 v59, v10, v187
    v_mfma_f32_16x16x32_bf16 v[128:131], v[16:19], a[108:111], v[128:131]
    v_exp_f32 v59, v59
    v_mul_f32 v67, v187, v191
    v_mfma_f32_16x16x32_bf16 v[108:111], v[20:23], a[96:99], v[108:111]
    ds_read_b128 v[16:19], v3 offset:18432
    v_fma_f32 v56, v56, v14, v14
    v_mfma_f32_16x16x32_bf16 v[116:119], v[20:23], a[100:103], v[116:119]
    v_rcp_f32 v56, v56
    v_mul_f32 v60, v11, v192
    v_mfma_f32_16x16x32_bf16 v[124:127], v[20:23], a[104:107], v[124:127]
    v_exp_f32 v60, v60
    v_mul_f32 v68, v192, v196
    v_mfma_f32_16x16x32_bf16 v[132:135], v[20:23], a[108:111], v[132:135]
    v_fma_f32 v57, v57, v14, v14
    s_waitcnt lgkmcnt(3)
    v_mfma_f32_16x16x32_bf16 v[104:107], v[24:27], a[112:115], v[104:107]
    ds_read_b128 v[20:23], v3 offset:19456
    v_mul_f32 v61, v11, v193
    v_mfma_f32_16x16x32_bf16 v[112:115], v[24:27], a[116:119], v[112:115]
    s_add_u32 m0, s49, 4096
    s_add_u32 s27, s48, 4096
    v_mfma_f32_16x16x32_bf16 v[120:123], v[24:27], a[120:123], v[120:123]
    buffer_load_dwordx4 v2, s[12:15], s27 offen offset:0 sc1 lds
    v_mfma_f32_16x16x32_bf16 v[128:131], v[24:27], a[124:127], v[128:131]
    v_rcp_f32 v57, v57
    v_mul_f32 v69, v193, v197
    v_mfma_f32_16x16x32_bf16 v[108:111], v[28:31], a[112:115], v[108:111]
    ds_read_b128 v[24:27], v3 offset:20480
    v_fma_f32 v58, v58, v14, v14
    v_mfma_f32_16x16x32_bf16 v[116:119], v[28:31], a[116:119], v[116:119]
    v_exp_f32 v61, v61
    v_mul_f32 v62, v11, v194
    v_mfma_f32_16x16x32_bf16 v[124:127], v[28:31], a[120:123], v[124:127]
    v_rcp_f32 v58, v58
    v_mul_f32 v70, v194, v198
    v_mfma_f32_16x16x32_bf16 v[132:135], v[28:31], a[124:127], v[132:135]
    v_fma_f32 v59, v59, v14, v14
    s_waitcnt lgkmcnt(3)
    v_mfma_f32_16x16x32_bf16 v[104:107], v[32:35], a[128:131], v[104:107]
    ds_read_b128 v[28:31], v3 offset:21504
    v_mul_f32 v64, v64, v56
    v_mfma_f32_16x16x32_bf16 v[112:115], v[32:35], a[132:135], v[112:115]
    v_exp_f32 v62, v62
    v_mul_f32 v63, v11, v195
    v_mfma_f32_16x16x32_bf16 v[120:123], v[32:35], a[136:139], v[120:123]
    v_rcp_f32 v59, v59
    v_mul_f32 v71, v195, v199
    v_mfma_f32_16x16x32_bf16 v[128:131], v[32:35], a[140:143], v[128:131]
    v_exp_f32 v63, v63
    v_fma_f32 v60, v60, v15, v15
    v_mfma_f32_16x16x32_bf16 v[108:111], v[36:39], a[128:131], v[108:111]
    ds_read_b128 v[32:35], v3 offset:22528
    v_mul_f32 v65, v65, v57
    v_mfma_f32_16x16x32_bf16 v[116:119], v[36:39], a[132:135], v[116:119]
    v_rcp_f32 v60, v60
    v_fma_f32 v61, v61, v15, v15
    v_mfma_f32_16x16x32_bf16 v[124:127], v[36:39], a[136:139], v[124:127]
    buffer_load_dwordx4 v2, s[12:15], s27 offen offset:1024 sc1 lds
    v_mfma_f32_16x16x32_bf16 v[132:135], v[36:39], a[140:143], v[132:135]
    v_mul_f32 v66, v66, v58
    s_waitcnt lgkmcnt(3)
    v_mfma_f32_16x16x32_bf16 v[104:107], v[16:19], a[144:147], v[104:107]
    ds_read_b128 v[36:39], v3 offset:23552
    v_fma_f32 v62, v62, v15, v15
    v_mfma_f32_16x16x32_bf16 v[112:115], v[16:19], a[148:151], v[112:115]
    v_rcp_f32 v61, v61
    v_mul_f32 v67, v67, v59
    v_mfma_f32_16x16x32_bf16 v[120:123], v[16:19], a[152:155], v[120:123]
    v_rcp_f32 v62, v62
    v_fma_f32 v63, v63, v15, v15
    v_mfma_f32_16x16x32_bf16 v[128:131], v[16:19], a[156:159], v[128:131]
    v_rcp_f32 v63, v63
    v_mul_f32 v68, v68, v60
    v_mfma_f32_16x16x32_bf16 v[108:111], v[20:23], a[144:147], v[108:111]
    ds_read_b128 v[16:19], v3 offset:24576
    v_mul_f32 v69, v69, v61
    v_mfma_f32_16x16x32_bf16 v[116:119], v[20:23], a[148:151], v[116:119]
    v_mul_f32 v70, v70, v62
    v_mul_f32 v71, v71, v63
    v_cvt_pk_bf16_f32 v56, v64, v65
    v_mfma_f32_16x16x32_bf16 v[124:127], v[20:23], a[152:155], v[124:127]
    v_cvt_pk_bf16_f32 v58, v68, v69
    v_cvt_pk_bf16_f32 v57, v66, v67
    v_cvt_pk_bf16_f32 v59, v70, v71
    v_mfma_f32_16x16x32_bf16 v[132:135], v[20:23], a[156:159], v[132:135]
    v_permlane16_swap_b32 v56, v58
    s_waitcnt lgkmcnt(3)
    v_mfma_f32_16x16x32_bf16 v[104:107], v[24:27], a[160:163], v[104:107]
    ds_read_b128 v[20:23], v3 offset:25600
    v_permlane16_swap_b32 v57, v59
    v_mfma_f32_16x16x32_bf16 v[112:115], v[24:27], a[164:167], v[112:115]
    buffer_store_dwordx4 v[56:59], v5, s[12:15], s31 offen sc1
    s_add_u32 s31, s31, 4096
    v_mfma_f32_16x16x32_bf16 v[120:123], v[24:27], a[168:171], v[120:123]
    buffer_load_dwordx4 v2, s[12:15], s27 offen offset:2048 sc1 lds
    v_mfma_f32_16x16x32_bf16 v[128:131], v[24:27], a[172:175], v[128:131]
    v_mul_f32 v40, v8, v200
    v_mul_f32 v48, v200, v204
    v_mul_f32 v41, v8, v201
    v_mfma_f32_16x16x32_bf16 v[108:111], v[28:31], a[160:163], v[108:111]
    ds_read_b128 v[24:27], v3 offset:26624
    v_mul_f32 v49, v201, v205
    v_mfma_f32_16x16x32_bf16 v[116:119], v[28:31], a[164:167], v[116:119]
    v_exp_f32 v40, v40
    v_mul_f32 v42, v8, v202
    v_mfma_f32_16x16x32_bf16 v[124:127], v[28:31], a[168:171], v[124:127]
    v_exp_f32 v41, v41
    v_mul_f32 v50, v202, v206
    v_mfma_f32_16x16x32_bf16 v[132:135], v[28:31], a[172:175], v[132:135]
    v_mul_f32 v43, v8, v203
    s_waitcnt lgkmcnt(3)
    v_mfma_f32_16x16x32_bf16 v[104:107], v[32:35], a[176:179], v[104:107]
    ds_read_b128 v[28:31], v3 offset:27648
    v_mul_f32 v51, v203, v207
    v_mfma_f32_16x16x32_bf16 v[112:115], v[32:35], a[180:183], v[112:115]
    v_exp_f32 v42, v42
    v_fma_f32 v40, v40, v12, v12
    v_mfma_f32_16x16x32_bf16 v[120:123], v[32:35], a[184:187], v[120:123]
    v_exp_f32 v43, v43
    v_mul_f32 v44, v9, v208
    v_mfma_f32_16x16x32_bf16 v[128:131], v[32:35], a[188:191], v[128:131]
    v_rcp_f32 v40, v40
    v_mul_f32 v52, v208, v212
    v_mfma_f32_16x16x32_bf16 v[108:111], v[36:39], a[176:179], v[108:111]
    ds_read_b128 v[32:35], v3 offset:28672
    v_fma_f32 v41, v41, v12, v12
    v_mfma_f32_16x16x32_bf16 v[116:119], v[36:39], a[180:183], v[116:119]
    v_exp_f32 v44, v44
    v_mul_f32 v45, v9, v209
    v_mfma_f32_16x16x32_bf16 v[124:127], v[36:39], a[184:187], v[124:127]
    buffer_load_dwordx4 v2, s[12:15], s27 offen offset:3072 sc1 lds
    v_mfma_f32_16x16x32_bf16 v[132:135], v[36:39], a[188:191], v[132:135]
    v_mul_f32 v53, v209, v213
    s_waitcnt lgkmcnt(3)
    v_mfma_f32_16x16x32_bf16 v[104:107], v[16:19], a[192:195], v[104:107]
    ds_read_b128 v[36:39], v3 offset:29696
    v_fma_f32 v42, v42, v12, v12
    v_mfma_f32_16x16x32_bf16 v[112:115], v[16:19], a[196:199], v[112:115]
    v_rcp_f32 v41, v41
    v_mul_f32 v46, v9, v210
    v_mfma_f32_16x16x32_bf16 v[120:123], v[16:19], a[200:203], v[120:123]
    v_exp_f32 v45, v45
    v_mul_f32 v54, v210, v214
    v_mfma_f32_16x16x32_bf16 v[128:131], v[16:19], a[204:207], v[128:131]
    v_rcp_f32 v42, v42
    v_fma_f32 v43, v43, v12, v12
    v_mfma_f32_16x16x32_bf16 v[108:111], v[20:23], a[192:195], v[108:111]
    ds_read_b128 v[16:19], v3 offset:30720
    v_mul_f32 v48, v48, v40
    v_mfma_f32_16x16x32_bf16 v[116:119], v[20:23], a[196:199], v[116:119]
    v_exp_f32 v46, v46
    v_mul_f32 v47, v9, v211
    v_mfma_f32_16x16x32_bf16 v[124:127], v[20:23], a[200:203], v[124:127]
    v_rcp_f32 v43, v43
    v_mul_f32 v55, v211, v215
    v_mfma_f32_16x16x32_bf16 v[132:135], v[20:23], a[204:207], v[132:135]
    v_fma_f32 v44, v44, v13, v13
    s_waitcnt lgkmcnt(3)
    v_mfma_f32_16x16x32_bf16 v[104:107], v[24:27], a[208:211], v[104:107]
    ds_read_b128 v[20:23], v3 offset:31744
    v_mul_f32 v49, v49, v41
    v_mfma_f32_16x16x32_bf16 v[112:115], v[24:27], a[212:215], v[112:115]
    s_add_u32 m0, s49, 8192
    s_add_u32 s27, s48, 8192
    v_mfma_f32_16x16x32_bf16 v[120:123], v[24:27], a[216:219], v[120:123]
    buffer_load_dwordx4 v2, s[12:15], s27 offen offset:0 sc1 lds
    v_mfma_f32_16x16x32_bf16 v[128:131], v[24:27], a[220:223], v[128:131]
    s_add_u32 s48, s48, 36864
    s_add_u32 s49, s49, 36864
    s_cmp_ge_u32 s49, 147456
    s_cselect_b32 s27, 147456, 0
    s_sub_u32 s49, s49, s27
    v_mfma_f32_16x16x32_bf16 v[108:111], v[28:31], a[208:211], v[108:111]
    ds_read_b128 v[24:27], v3 offset:32768
    v_fma_f32 v45, v45, v13, v13
    v_mfma_f32_16x16x32_bf16 v[116:119], v[28:31], a[212:215], v[116:119]
    v_exp_f32 v47, v47
    v_mul_f32 v50, v50, v42
    v_mfma_f32_16x16x32_bf16 v[124:127], v[28:31], a[216:219], v[124:127]
    v_rcp_f32 v44, v44
    v_fma_f32 v46, v46, v13, v13
    v_mfma_f32_16x16x32_bf16 v[132:135], v[28:31], a[220:223], v[132:135]
    v_mul_f32 v51, v51, v43
    s_waitcnt lgkmcnt(3)
    v_mfma_f32_16x16x32_bf16 v[104:107], v[32:35], a[224:227], v[104:107]
    ds_read_b128 v[28:31], v3 offset:33792
    v_fma_f32 v47, v47, v13, v13
    v_mfma_f32_16x16x32_bf16 v[112:115], v[32:35], a[228:231], v[112:115]
    v_rcp_f32 v45, v45
    v_mul_f32 v52, v52, v44
    v_mfma_f32_16x16x32_bf16 v[120:123], v[32:35], a[232:235], v[120:123]
    v_rcp_f32 v46, v46
    v_mul_f32 v53, v53, v45
    v_mfma_f32_16x16x32_bf16 v[128:131], v[32:35], a[236:239], v[128:131]
    v_rcp_f32 v47, v47
    v_mul_f32 v54, v54, v46
    v_mfma_f32_16x16x32_bf16 v[108:111], v[36:39], a[224:227], v[108:111]
    ds_read_b128 v[32:35], v3 offset:34816
    v_mul_f32 v55, v55, v47
    v_mfma_f32_16x16x32_bf16 v[116:119], v[36:39], a[228:231], v[116:119]
    v_cvt_pk_bf16_f32 v40, v48, v49
    v_cvt_pk_bf16_f32 v42, v52, v53
    v_cvt_pk_bf16_f32 v41, v50, v51
    v_mfma_f32_16x16x32_bf16 v[124:127], v[36:39], a[232:235], v[124:127]
    v_cvt_pk_bf16_f32 v43, v54, v55
    v_permlane16_swap_b32 v40, v42
    v_mul_f32 v56, v10, v216
    v_mfma_f32_16x16x32_bf16 v[132:135], v[36:39], a[236:239], v[132:135]
    v_permlane16_swap_b32 v41, v43
    s_waitcnt lgkmcnt(3)
    v_mfma_f32_16x16x32_bf16 v[104:107], v[16:19], a[240:243], v[104:107]
    ds_read_b128 v[36:39], v3 offset:35840
    v_mul_f32 v64, v216, v220
    v_mfma_f32_16x16x32_bf16 v[112:115], v[16:19], a[244:247], v[112:115]
    buffer_store_dwordx4 v[40:43], v5, s[12:15], s30 offen sc1
    s_add_u32 s30, s30, 4096
    v_mfma_f32_16x16x32_bf16 v[120:123], v[16:19], a[248:251], v[120:123]
    v_exp_f32 v56, v56
    v_mul_f32 v57, v10, v217
    v_mfma_f32_16x16x32_bf16 v[128:131], v[16:19], a[252:255], v[128:131]
    s_waitcnt vmcnt(12)
    s_barrier
    v_mfma_f32_16x16x32_bf16 v[108:111], v[20:23], a[240:243], v[108:111]
    ds_read_b128 v[16:19], v4 offset:0
    v_mul_f32 v65, v217, v221
    v_mfma_f32_16x16x32_bf16 v[116:119], v[20:23], a[244:247], v[116:119]
    v_exp_f32 v57, v57
    v_mul_f32 v58, v10, v218
    v_mfma_f32_16x16x32_bf16 v[124:127], v[20:23], a[248:251], v[124:127]
    v_exp_f32 v58, v58
    v_mul_f32 v66, v218, v222
    v_mfma_f32_16x16x32_bf16 v[132:135], v[20:23], a[252:255], v[132:135]
    v_mul_f32 v59, v10, v219
    s_waitcnt lgkmcnt(3)
    v_mfma_f32_16x16x32_bf16 v[104:107], v[24:27], v[72:75], v[104:107]
    ds_read_b128 v[20:23], v4 offset:1024
    v_mul_f32 v67, v219, v223
    v_mfma_f32_16x16x32_bf16 v[112:115], v[24:27], v[76:79], v[112:115]
    v_exp_f32 v59, v59
    v_fma_f32 v56, v56, v14, v14
    v_mfma_f32_16x16x32_bf16 v[120:123], v[24:27], v[80:83], v[120:123]
    v_rcp_f32 v56, v56
    v_mul_f32 v60, v11, v224
    v_mfma_f32_16x16x32_bf16 v[128:131], v[24:27], v[84:87], v[128:131]
    v_exp_f32 v60, v60
    v_mul_f32 v68, v224, v228
    v_mfma_f32_16x16x32_bf16 v[108:111], v[28:31], v[72:75], v[108:111]
    ds_read_b128 v[24:27], v4 offset:2048
    v_fma_f32 v57, v57, v14, v14
    v_mfma_f32_16x16x32_bf16 v[116:119], v[28:31], v[76:79], v[116:119]
    v_rcp_f32 v57, v57
    v_mul_f32 v61, v11, v225
    v_mfma_f32_16x16x32_bf16 v[124:127], v[28:31], v[80:83], v[124:127]
    v_exp_f32 v61, v61
    v_mul_f32 v69, v225, v229
    v_mfma_f32_16x16x32_bf16 v[132:135], v[28:31], v[84:87], v[132:135]
    v_fma_f32 v58, v58, v14, v14
    s_waitcnt lgkmcnt(3)
    v_mfma_f32_16x16x32_bf16 v[104:107], v[32:35], v[88:91], v[104:107]
    ds_read_b128 v[28:31], v4 offset:3072
    v_mul_f32 v62, v11, v226
    v_mfma_f32_16x16x32_bf16 v[112:115], v[32:35], v[92:95], v[112:115]
    v_rcp_f32 v58, v58
    v_mul_f32 v70, v226, v230
    v_mfma_f32_16x16x32_bf16 v[120:123], v[32:35], v[96:99], v[120:123]
    v_exp_f32 v62, v62
    v_fma_f32 v59, v59, v14, v14
    v_mfma_f32_16x16x32_bf16 v[128:131], v[32:35], v[100:103], v[128:131]
    v_rcp_f32 v59, v59
    v_mul_f32 v64, v64, v56
    v_mfma_f32_16x16x32_bf16 v[108:111], v[36:39], v[88:91], v[108:111]
    ds_read_b128 v[32:35], v4 offset:4096
    v_mfma_f32_16x16x32_bf16 v[116:119], v[36:39], v[92:95], v[116:119]
    v_mul_f32 v63, v11, v227
    v_mul_f32 v71, v227, v231
    v_mfma_f32_16x16x32_bf16 v[124:127], v[36:39], v[96:99], v[124:127]
    v_mfma_f32_16x16x32_bf16 v[132:135], v[36:39], v[100:103], v[132:135]
    v_fma_f32 v60, v60, v15, v15
    v_mul_f32 v65, v65, v57
    v_exp_f32 v63, v63
    v_rcp_f32 v60, v60
    v_fma_f32 v61, v61, v15, v15
    v_mul_f32 v66, v66, v58
    v_rcp_f32 v61, v61
    v_fma_f32 v62, v62, v15, v15
    v_mul_f32 v67, v67, v59
    v_rcp_f32 v62, v62
    v_fma_f32 v63, v63, v15, v15
    v_mul_f32 v68, v68, v60
    v_rcp_f32 v63, v63
    v_mul_f32 v69, v69, v61
    v_mul_f32 v70, v70, v62
    v_mul_f32 v71, v71, v63
    v_cvt_pk_bf16_f32 v56, v64, v65
    v_cvt_pk_bf16_f32 v58, v68, v69
    v_cvt_pk_bf16_f32 v57, v66, v67
    v_cvt_pk_bf16_f32 v59, v70, v71
    v_permlane16_swap_b32 v56, v58
    s_nop 0
    v_permlane16_swap_b32 v57, v59
    buffer_store_dwordx4 v[56:59], v5, s[12:15], s31 offen sc1
    s_add_u32 s31, s31, 4096
    v_mov_b32 v3, v4
    v_add_u32 v4, s33, v2
    s_add_u32 s33, s33, 36864
    s_cmp_ge_u32 s33, 147456
    s_cselect_b32 s33, 0, s33
    s_getpc_b64 s[44:45]
Lpc44:
    s_lshr_b32 s27, s2, 3
    s_lshl_b32 s27, s27, 2
    s_add_u32 s27, s27, s3
    s_mul_i32 s27, s27, 128
    s_add_u32 s27, s27, p5_start-Lpc44
    v_and_b32 v6, 0, v0
    v_lshl_add_u32 v6, v6, 7, s27
    v_min_u32 v6, code_end-Lpc44-4, v6
    global_load_dword v7, v6, s[44:45]
    s_mov_b32 s32, 2
Lloop45:
    s_waitcnt lgkmcnt(3)
    v_mfma_f32_16x16x32_bf16 v[136:139], v[16:19], a[0:3], 0
    ds_read_b128 v[36:39], v3 offset:5120
    v_mfma_f32_16x16x32_bf16 v[144:147], v[16:19], a[4:7], 0
    v_mfma_f32_16x16x32_bf16 v[152:155], v[16:19], a[8:11], 0
    v_mfma_f32_16x16x32_bf16 v[160:163], v[16:19], a[12:15], 0
    v_mfma_f32_16x16x32_bf16 v[140:143], v[20:23], a[0:3], 0
    ds_read_b128 v[16:19], v3 offset:6144
    v_mfma_f32_16x16x32_bf16 v[148:151], v[20:23], a[4:7], 0
    v_mfma_f32_16x16x32_bf16 v[156:159], v[20:23], a[8:11], 0
    v_mul_f32 v40, v8, v104
    v_mul_f32 v48, v104, v108
    v_mfma_f32_16x16x32_bf16 v[164:167], v[20:23], a[12:15], 0
    v_mul_f32 v41, v8, v105
    s_waitcnt lgkmcnt(3)
    v_mfma_f32_16x16x32_bf16 v[136:139], v[24:27], a[16:19], v[136:139]
    ds_read_b128 v[20:23], v3 offset:7168
    v_mfma_f32_16x16x32_bf16 v[144:147], v[24:27], a[20:23], v[144:147]
    s_add_u32 m0, s49, 0
    s_add_u32 s27, s48, 0
    v_mfma_f32_16x16x32_bf16 v[152:155], v[24:27], a[24:27], v[152:155]
    buffer_load_dwordx4 v2, s[12:15], s27 offen offset:0 sc1 lds
    v_mfma_f32_16x16x32_bf16 v[160:163], v[24:27], a[28:31], v[160:163]
    v_exp_f32 v40, v40
    v_mfma_f32_16x16x32_bf16 v[140:143], v[28:31], a[16:19], v[140:143]
    ds_read_b128 v[24:27], v3 offset:8192
    v_mfma_f32_16x16x32_bf16 v[148:151], v[28:31], a[20:23], v[148:151]
    v_exp_f32 v41, v41
    v_mfma_f32_16x16x32_bf16 v[156:159], v[28:31], a[24:27], v[156:159]
    v_mul_f32 v49, v105, v109
    v_mul_f32 v42, v8, v106
    v_mfma_f32_16x16x32_bf16 v[164:167], v[28:31], a[28:31], v[164:167]
    v_mul_f32 v50, v106, v110
    s_waitcnt lgkmcnt(3)
    v_mfma_f32_16x16x32_bf16 v[136:139], v[32:35], a[32:35], v[136:139]
    ds_read_b128 v[28:31], v3 offset:9216
    v_mfma_f32_16x16x32_bf16 v[144:147], v[32:35], a[36:39], v[144:147]
    v_exp_f32 v42, v42
    v_mfma_f32_16x16x32_bf16 v[152:155], v[32:35], a[40:43], v[152:155]
    v_mul_f32 v43, v8, v107
    v_mul_f32 v51, v107, v111
    v_mfma_f32_16x16x32_bf16 v[160:163], v[32:35], a[44:47], v[160:163]
    v_exp_f32 v43, v43
    v_mfma_f32_16x16x32_bf16 v[140:143], v[36:39], a[32:35], v[140:143]
    ds_read_b128 v[32:35], v3 offset:10240
    v_mfma_f32_16x16x32_bf16 v[148:151], v[36:39], a[36:39], v[148:151]
    v_fma_f32 v40, v40, v12, v12
    v_mul_f32 v44, v9, v112
    v_mfma_f32_16x16x32_bf16 v[156:159], v[36:39], a[40:43], v[156:159]
    buffer_load_dwordx4 v2, s[12:15], s27 offen offset:1024 sc1 lds
    v_mfma_f32_16x16x32_bf16 v[164:167], v[36:39], a[44:47], v[164:167]
    v_mul_f32 v52, v112, v116
    s_waitcnt lgkmcnt(3)
    v_mfma_f32_16x16x32_bf16 v[136:139], v[16:19], a[48:51], v[136:139]
    ds_read_b128 v[36:39], v3 offset:11264
    v_mfma_f32_16x16x32_bf16 v[144:147], v[16:19], a[52:55], v[144:147]
    v_rcp_f32 v40, v40
    v_mfma_f32_16x16x32_bf16 v[152:155], v[16:19], a[56:59], v[152:155]
    v_fma_f32 v41, v41, v12, v12
    v_mul_f32 v45, v9, v113
    v_mfma_f32_16x16x32_bf16 v[160:163], v[16:19], a[60:63], v[160:163]
    v_exp_f32 v44, v44
    v_mfma_f32_16x16x32_bf16 v[140:143], v[20:23], a[48:51], v[140:143]
    ds_read_b128 v[16:19], v3 offset:12288
    v_mfma_f32_16x16x32_bf16 v[148:151], v[20:23], a[52:55], v[148:151]
    v_rcp_f32 v41, v41
    v_mfma_f32_16x16x32_bf16 v[156:159], v[20:23], a[56:59], v[156:159]
    v_mul_f32 v53, v113, v117
    v_fma_f32 v42, v42, v12, v12
    v_mfma_f32_16x16x32_bf16 v[164:167], v[20:23], a[60:63], v[164:167]
    v_mul_f32 v46, v9, v114
    s_waitcnt lgkmcnt(3)
    v_mfma_f32_16x16x32_bf16 v[136:139], v[24:27], a[64:67], v[136:139]
    ds_read_b128 v[20:23], v3 offset:13312
    v_mfma_f32_16x16x32_bf16 v[144:147], v[24:27], a[68:71], v[144:147]
    v_exp_f32 v45, v45
    v_mfma_f32_16x16x32_bf16 v[152:155], v[24:27], a[72:75], v[152:155]
    buffer_load_dwordx4 v2, s[12:15], s27 offen offset:2048 sc1 lds
    v_mfma_f32_16x16x32_bf16 v[160:163], v[24:27], a[76:79], v[160:163]
    v_rcp_f32 v42, v42
    v_mfma_f32_16x16x32_bf16 v[140:143], v[28:31], a[64:67], v[140:143]
    ds_read_b128 v[24:27], v3 offset:14336
    v_mfma_f32_16x16x32_bf16 v[148:151], v[28:31], a[68:71], v[148:151]
    v_exp_f32 v46, v46
    v_mfma_f32_16x16x32_bf16 v[156:159], v[28:31], a[72:75], v[156:159]
    v_mul_f32 v54, v114, v118
    v_fma_f32 v43, v43, v12, v12
    v_mfma_f32_16x16x32_bf16 v[164:167], v[28:31], a[76:79], v[164:167]
    v_mul_f32 v48, v48, v40
    s_waitcnt lgkmcnt(3)
    v_mfma_f32_16x16x32_bf16 v[136:139], v[32:35], a[80:83], v[136:139]
    ds_read_b128 v[28:31], v3 offset:15360
    v_mfma_f32_16x16x32_bf16 v[144:147], v[32:35], a[84:87], v[144:147]
    v_rcp_f32 v43, v43
    v_mfma_f32_16x16x32_bf16 v[152:155], v[32:35], a[88:91], v[152:155]
    v_mul_f32 v47, v9, v115
    v_mul_f32 v55, v115, v119
    v_mfma_f32_16x16x32_bf16 v[160:163], v[32:35], a[92:95], v[160:163]
    v_exp_f32 v47, v47
    v_mfma_f32_16x16x32_bf16 v[140:143], v[36:39], a[80:83], v[140:143]
    ds_read_b128 v[32:35], v3 offset:16384
    v_mfma_f32_16x16x32_bf16 v[148:151], v[36:39], a[84:87], v[148:151]
    v_fma_f32 v44, v44, v13, v13
    v_mul_f32 v49, v49, v41
    v_mfma_f32_16x16x32_bf16 v[156:159], v[36:39], a[88:91], v[156:159]
    buffer_load_dwordx4 v2, s[12:15], s27 offen offset:3072 sc1 lds
    v_mfma_f32_16x16x32_bf16 v[164:167], v[36:39], a[92:95], v[164:167]
    v_fma_f32 v45, v45, v13, v13
    s_waitcnt lgkmcnt(3)
    v_mfma_f32_16x16x32_bf16 v[136:139], v[16:19], a[96:99], v[136:139]
    ds_read_b128 v[36:39], v3 offset:17408
    v_mfma_f32_16x16x32_bf16 v[144:147], v[16:19], a[100:103], v[144:147]
    v_rcp_f32 v44, v44
    v_mfma_f32_16x16x32_bf16 v[152:155], v[16:19], a[104:107], v[152:155]
    v_mul_f32 v50, v50, v42
    v_fma_f32 v46, v46, v13, v13
    v_mfma_f32_16x16x32_bf16 v[160:163], v[16:19], a[108:111], v[160:163]
    v_rcp_f32 v45, v45
    v_mfma_f32_16x16x32_bf16 v[140:143], v[20:23], a[96:99], v[140:143]
    ds_read_b128 v[16:19], v3 offset:18432
    v_mfma_f32_16x16x32_bf16 v[148:151], v[20:23], a[100:103], v[148:151]
    v_rcp_f32 v46, v46
    v_mfma_f32_16x16x32_bf16 v[156:159], v[20:23], a[104:107], v[156:159]
    v_mul_f32 v51, v51, v43
    v_fma_f32 v47, v47, v13, v13
    v_mfma_f32_16x16x32_bf16 v[164:167], v[20:23], a[108:111], v[164:167]
    v_mul_f32 v52, v52, v44
    s_waitcnt lgkmcnt(3)
    v_mfma_f32_16x16x32_bf16 v[136:139], v[24:27], a[112:115], v[136:139]
    ds_read_b128 v[20:23], v3 offset:19456
    v_mfma_f32_16x16x32_bf16 v[144:147], v[24:27], a[116:119], v[144:147]
    s_add_u32 m0, s49, 4096
    s_add_u32 s27, s48, 4096
    v_mfma_f32_16x16x32_bf16 v[152:155], v[24:27], a[120:123], v[152:155]
    buffer_load_dwordx4 v2, s[12:15], s27 offen offset:0 sc1 lds
    v_mfma_f32_16x16x32_bf16 v[160:163], v[24:27], a[124:127], v[160:163]
    v_rcp_f32 v47, v47
    v_mfma_f32_16x16x32_bf16 v[140:143], v[28:31], a[112:115], v[140:143]
    ds_read_b128 v[24:27], v3 offset:20480
    v_mfma_f32_16x16x32_bf16 v[148:151], v[28:31], a[116:119], v[148:151]
    v_mul_f32 v53, v53, v45
    v_mul_f32 v54, v54, v46
    v_mfma_f32_16x16x32_bf16 v[156:159], v[28:31], a[120:123], v[156:159]
    v_mul_f32 v55, v55, v47
    v_cvt_pk_bf16_f32 v40, v48, v49
    v_mfma_f32_16x16x32_bf16 v[164:167], v[28:31], a[124:127], v[164:167]
    v_cvt_pk_bf16_f32 v42, v52, v53
    s_waitcnt lgkmcnt(3)
    v_mfma_f32_16x16x32_bf16 v[136:139], v[32:35], a[128:131], v[136:139]
    ds_read_b128 v[28:31], v3 offset:21504
    v_mfma_f32_16x16x32_bf16 v[144:147], v[32:35], a[132:135], v[144:147]
    v_cvt_pk_bf16_f32 v41, v50, v51
    v_cvt_pk_bf16_f32 v43, v54, v55
    v_mfma_f32_16x16x32_bf16 v[152:155], v[32:35], a[136:139], v[152:155]
    v_permlane16_swap_b32 v40, v42
    v_permlane16_swap_b32 v41, v43
    v_mfma_f32_16x16x32_bf16 v[160:163], v[32:35], a[140:143], v[160:163]
    buffer_store_dwordx4 v[40:43], v5, s[12:15], s30 offen sc1
    v_mfma_f32_16x16x32_bf16 v[140:143], v[36:39], a[128:131], v[140:143]
    ds_read_b128 v[32:35], v3 offset:22528
    v_mfma_f32_16x16x32_bf16 v[148:151], v[36:39], a[132:135], v[148:151]
    s_add_u32 s30, s30, 4096
    v_mul_f32 v56, v10, v120
    v_mfma_f32_16x16x32_bf16 v[156:159], v[36:39], a[136:139], v[156:159]
    buffer_load_dwordx4 v2, s[12:15], s27 offen offset:1024 sc1 lds
    v_mfma_f32_16x16x32_bf16 v[164:167], v[36:39], a[140:143], v[164:167]
    v_mul_f32 v64, v120, v124
    s_waitcnt lgkmcnt(3)
    v_mfma_f32_16x16x32_bf16 v[136:139], v[16:19], a[144:147], v[136:139]
    ds_read_b128 v[36:39], v3 offset:23552
    v_mfma_f32_16x16x32_bf16 v[144:147], v[16:19], a[148:151], v[144:147]
    v_exp_f32 v56, v56
    v_mfma_f32_16x16x32_bf16 v[152:155], v[16:19], a[152:155], v[152:155]
    v_mul_f32 v57, v10, v121
    v_mul_f32 v65, v121, v125
    v_mfma_f32_16x16x32_bf16 v[160:163], v[16:19], a[156:159], v[160:163]
    v_exp_f32 v57, v57
    v_mfma_f32_16x16x32_bf16 v[140:143], v[20:23], a[144:147], v[140:143]
    ds_read_b128 v[16:19], v3 offset:24576
    v_mfma_f32_16x16x32_bf16 v[148:151], v[20:23], a[148:151], v[148:151]
    v_mul_f32 v58, v10, v122
    v_mul_f32 v66, v122, v126
    v_mfma_f32_16x16x32_bf16 v[156:159], v[20:23], a[152:155], v[156:159]
    v_exp_f32 v58, v58
    v_mfma_f32_16x16x32_bf16 v[164:167], v[20:23], a[156:159], v[164:167]
    v_mul_f32 v59, v10, v123
    s_waitcnt lgkmcnt(3)
    v_mfma_f32_16x16x32_bf16 v[136:139], v[24:27], a[160:163], v[136:139]
    ds_read_b128 v[20:23], v3 offset:25600
    v_mfma_f32_16x16x32_bf16 v[144:147], v[24:27], a[164:167], v[144:147]
    v_exp_f32 v59, v59
    v_mfma_f32_16x16x32_bf16 v[152:155], v[24:27], a[168:171], v[152:155]
    buffer_load_dwordx4 v2, s[12:15], s27 offen offset:2048 sc1 lds
    v_mfma_f32_16x16x32_bf16 v[160:163], v[24:27], a[172:175], v[160:163]
    v_mul_f32 v67, v123, v127
    v_fma_f32 v56, v56, v14, v14
    v_mfma_f32_16x16x32_bf16 v[140:143], v[28:31], a[160:163], v[140:143]
    ds_read_b128 v[24:27], v3 offset:26624
    v_mfma_f32_16x16x32_bf16 v[148:151], v[28:31], a[164:167], v[148:151]
    v_rcp_f32 v56, v56
    v_mfma_f32_16x16x32_bf16 v[156:159], v[28:31], a[168:171], v[156:159]
    v_mul_f32 v60, v11, v128
    v_mul_f32 v68, v128, v132
    v_mfma_f32_16x16x32_bf16 v[164:167], v[28:31], a[172:175], v[164:167]
    v_fma_f32 v57, v57, v14, v14
    s_waitcnt lgkmcnt(3)
    v_mfma_f32_16x16x32_bf16 v[136:139], v[32:35], a[176:179], v[136:139]
    ds_read_b128 v[28:31], v3 offset:27648
    v_mfma_f32_16x16x32_bf16 v[144:147], v[32:35], a[180:183], v[144:147]
    v_exp_f32 v60, v60
    v_mfma_f32_16x16x32_bf16 v[152:155], v[32:35], a[184:187], v[152:155]
    v_mul_f32 v61, v11, v129
    v_mul_f32 v69, v129, v133
    v_mfma_f32_16x16x32_bf16 v[160:163], v[32:35], a[188:191], v[160:163]
    v_rcp_f32 v57, v57
    v_mfma_f32_16x16x32_bf16 v[140:143], v[36:39], a[176:179], v[140:143]
    ds_read_b128 v[32:35], v3 offset:28672
    v_mfma_f32_16x16x32_bf16 v[148:151], v[36:39], a[180:183], v[148:151]
    v_exp_f32 v61, v61
    v_mfma_f32_16x16x32_bf16 v[156:159], v[36:39], a[184:187], v[156:159]
    buffer_load_dwordx4 v2, s[12:15], s27 offen offset:3072 sc1 lds
    v_mfma_f32_16x16x32_bf16 v[164:167], v[36:39], a[188:191], v[164:167]
    v_fma_f32 v58, v58, v14, v14
    s_waitcnt lgkmcnt(3)
    v_mfma_f32_16x16x32_bf16 v[136:139], v[16:19], a[192:195], v[136:139]
    ds_read_b128 v[36:39], v3 offset:29696
    v_mfma_f32_16x16x32_bf16 v[144:147], v[16:19], a[196:199], v[144:147]
    v_rcp_f32 v58, v58
    v_mfma_f32_16x16x32_bf16 v[152:155], v[16:19], a[200:203], v[152:155]
    v_mul_f32 v62, v11, v130
    v_mul_f32 v70, v130, v134
    v_mfma_f32_16x16x32_bf16 v[160:163], v[16:19], a[204:207], v[160:163]
    v_exp_f32 v62, v62
    v_mfma_f32_16x16x32_bf16 v[140:143], v[20:23], a[192:195], v[140:143]
    ds_read_b128 v[16:19], v3 offset:30720
    v_mfma_f32_16x16x32_bf16 v[148:151], v[20:23], a[196:199], v[148:151]
    v_fma_f32 v59, v59, v14, v14
    v_mul_f32 v64, v64, v56
    v_mfma_f32_16x16x32_bf16 v[156:159], v[20:23], a[200:203], v[156:159]
    v_rcp_f32 v59, v59
    v_mfma_f32_16x16x32_bf16 v[164:167], v[20:23], a[204:207], v[164:167]
    v_mul_f32 v63, v11, v131
    s_waitcnt lgkmcnt(3)
    v_mfma_f32_16x16x32_bf16 v[136:139], v[24:27], a[208:211], v[136:139]
    ds_read_b128 v[20:23], v3 offset:31744
    v_mfma_f32_16x16x32_bf16 v[144:147], v[24:27], a[212:215], v[144:147]
    s_add_u32 m0, s49, 8192
    s_add_u32 s27, s48, 8192
    v_mfma_f32_16x16x32_bf16 v[152:155], v[24:27], a[216:219], v[152:155]
    buffer_load_dwordx4 v2, s[12:15], s27 offen offset:0 sc1 lds
    v_mfma_f32_16x16x32_bf16 v[160:163], v[24:27], a[220:223], v[160:163]
    s_add_u32 s48, s48, 36864
    s_add_u32 s49, s49, 36864
    s_cmp_ge_u32 s49, 147456
    s_cselect_b32 s27, 147456, 0
    s_sub_u32 s49, s49, s27
    v_mfma_f32_16x16x32_bf16 v[140:143], v[28:31], a[208:211], v[140:143]
    ds_read_b128 v[24:27], v3 offset:32768
    v_mfma_f32_16x16x32_bf16 v[148:151], v[28:31], a[212:215], v[148:151]
    v_exp_f32 v63, v63
    v_mfma_f32_16x16x32_bf16 v[156:159], v[28:31], a[216:219], v[156:159]
    v_mul_f32 v71, v131, v135
    v_fma_f32 v60, v60, v15, v15
    v_mfma_f32_16x16x32_bf16 v[164:167], v[28:31], a[220:223], v[164:167]
    v_mul_f32 v65, v65, v57
    s_waitcnt lgkmcnt(3)
    v_mfma_f32_16x16x32_bf16 v[136:139], v[32:35], a[224:227], v[136:139]
    ds_read_b128 v[28:31], v3 offset:33792
    v_mfma_f32_16x16x32_bf16 v[144:147], v[32:35], a[228:231], v[144:147]
    v_rcp_f32 v60, v60
    v_mfma_f32_16x16x32_bf16 v[152:155], v[32:35], a[232:235], v[152:155]
    v_fma_f32 v61, v61, v15, v15
    v_mul_f32 v66, v66, v58
    v_mfma_f32_16x16x32_bf16 v[160:163], v[32:35], a[236:239], v[160:163]
    v_rcp_f32 v61, v61
    v_mfma_f32_16x16x32_bf16 v[140:143], v[36:39], a[224:227], v[140:143]
    ds_read_b128 v[32:35], v3 offset:34816
    v_mfma_f32_16x16x32_bf16 v[148:151], v[36:39], a[228:231], v[148:151]
    v_fma_f32 v62, v62, v15, v15
    v_mul_f32 v67, v67, v59
    v_mfma_f32_16x16x32_bf16 v[156:159], v[36:39], a[232:235], v[156:159]
    v_rcp_f32 v62, v62
    v_mfma_f32_16x16x32_bf16 v[164:167], v[36:39], a[236:239], v[164:167]
    v_fma_f32 v63, v63, v15, v15
    s_waitcnt lgkmcnt(3)
    v_mfma_f32_16x16x32_bf16 v[136:139], v[16:19], a[240:243], v[136:139]
    ds_read_b128 v[36:39], v3 offset:35840
    v_mfma_f32_16x16x32_bf16 v[144:147], v[16:19], a[244:247], v[144:147]
    v_rcp_f32 v63, v63
    v_mfma_f32_16x16x32_bf16 v[152:155], v[16:19], a[248:251], v[152:155]
    v_mul_f32 v68, v68, v60
    v_mul_f32 v69, v69, v61
    v_mfma_f32_16x16x32_bf16 v[160:163], v[16:19], a[252:255], v[160:163]
    s_waitcnt vmcnt(10)
    s_barrier
    v_mfma_f32_16x16x32_bf16 v[140:143], v[20:23], a[240:243], v[140:143]
    ds_read_b128 v[16:19], v4 offset:0
    v_mfma_f32_16x16x32_bf16 v[148:151], v[20:23], a[244:247], v[148:151]
    v_mul_f32 v70, v70, v62
    v_mul_f32 v71, v71, v63
    v_mfma_f32_16x16x32_bf16 v[156:159], v[20:23], a[248:251], v[156:159]
    v_cvt_pk_bf16_f32 v56, v64, v65
    v_cvt_pk_bf16_f32 v58, v68, v69
    v_mfma_f32_16x16x32_bf16 v[164:167], v[20:23], a[252:255], v[164:167]
    v_cvt_pk_bf16_f32 v57, v66, v67
    s_waitcnt lgkmcnt(3)
    v_mfma_f32_16x16x32_bf16 v[136:139], v[24:27], v[72:75], v[136:139]
    ds_read_b128 v[20:23], v4 offset:1024
    v_mfma_f32_16x16x32_bf16 v[144:147], v[24:27], v[76:79], v[144:147]
    v_cvt_pk_bf16_f32 v59, v70, v71
    v_permlane16_swap_b32 v56, v58
    v_mfma_f32_16x16x32_bf16 v[152:155], v[24:27], v[80:83], v[152:155]
    v_permlane16_swap_b32 v57, v59
    v_mfma_f32_16x16x32_bf16 v[160:163], v[24:27], v[84:87], v[160:163]
    buffer_store_dwordx4 v[56:59], v5, s[12:15], s31 offen sc1
    v_mfma_f32_16x16x32_bf16 v[140:143], v[28:31], v[72:75], v[140:143]
    ds_read_b128 v[24:27], v4 offset:2048
    v_mfma_f32_16x16x32_bf16 v[148:151], v[28:31], v[76:79], v[148:151]
    s_add_u32 s31, s31, 4096
    v_mfma_f32_16x16x32_bf16 v[156:159], v[28:31], v[80:83], v[156:159]
    v_mfma_f32_16x16x32_bf16 v[164:167], v[28:31], v[84:87], v[164:167]
    s_waitcnt lgkmcnt(3)
    v_mfma_f32_16x16x32_bf16 v[136:139], v[32:35], v[88:91], v[136:139]
    ds_read_b128 v[28:31], v4 offset:3072
    v_mfma_f32_16x16x32_bf16 v[144:147], v[32:35], v[92:95], v[144:147]
    v_mfma_f32_16x16x32_bf16 v[152:155], v[32:35], v[96:99], v[152:155]
    v_mfma_f32_16x16x32_bf16 v[160:163], v[32:35], v[100:103], v[160:163]
    v_mfma_f32_16x16x32_bf16 v[140:143], v[36:39], v[88:91], v[140:143]
    ds_read_b128 v[32:35], v4 offset:4096
    v_mfma_f32_16x16x32_bf16 v[148:151], v[36:39], v[92:95], v[148:151]
    v_mfma_f32_16x16x32_bf16 v[156:159], v[36:39], v[96:99], v[156:159]
    v_mfma_f32_16x16x32_bf16 v[164:167], v[36:39], v[100:103], v[164:167]
    v_mov_b32 v3, v4
    v_add_u32 v4, s33, v2
    s_add_u32 s33, s33, 36864
    s_cmp_ge_u32 s33, 147456
    s_cselect_b32 s33, 0, s33
    s_cmp_eq_u32 s32, 1
    s_cbranch_scc1 Llast46
    s_waitcnt lgkmcnt(3)
    v_mfma_f32_16x16x32_bf16 v[104:107], v[16:19], a[0:3], 0
    ds_read_b128 v[36:39], v3 offset:5120
    v_mfma_f32_16x16x32_bf16 v[112:115], v[16:19], a[4:7], 0
    v_mfma_f32_16x16x32_bf16 v[120:123], v[16:19], a[8:11], 0
    v_mfma_f32_16x16x32_bf16 v[128:131], v[16:19], a[12:15], 0
    v_mfma_f32_16x16x32_bf16 v[108:111], v[20:23], a[0:3], 0
    ds_read_b128 v[16:19], v3 offset:6144
    v_mfma_f32_16x16x32_bf16 v[116:119], v[20:23], a[4:7], 0
    v_mfma_f32_16x16x32_bf16 v[124:127], v[20:23], a[8:11], 0
    v_mul_f32 v40, v8, v136
    v_mul_f32 v48, v136, v140
    v_mfma_f32_16x16x32_bf16 v[132:135], v[20:23], a[12:15], 0
    v_mul_f32 v41, v8, v137
    s_waitcnt lgkmcnt(3)
    v_mfma_f32_16x16x32_bf16 v[104:107], v[24:27], a[16:19], v[104:107]
    ds_read_b128 v[20:23], v3 offset:7168
    v_mfma_f32_16x16x32_bf16 v[112:115], v[24:27], a[20:23], v[112:115]
    s_add_u32 m0, s49, 0
    s_add_u32 s27, s48, 0
    v_mfma_f32_16x16x32_bf16 v[120:123], v[24:27], a[24:27], v[120:123]
    buffer_load_dwordx4 v2, s[12:15], s27 offen offset:0 sc1 lds
    v_mfma_f32_16x16x32_bf16 v[128:131], v[24:27], a[28:31], v[128:131]
    v_exp_f32 v40, v40
    v_mfma_f32_16x16x32_bf16 v[108:111], v[28:31], a[16:19], v[108:111]
    ds_read_b128 v[24:27], v3 offset:8192
    v_mfma_f32_16x16x32_bf16 v[116:119], v[28:31], a[20:23], v[116:119]
    v_exp_f32 v41, v41
    v_mfma_f32_16x16x32_bf16 v[124:127], v[28:31], a[24:27], v[124:127]
    v_mul_f32 v49, v137, v141
    v_mul_f32 v42, v8, v138
    v_mfma_f32_16x16x32_bf16 v[132:135], v[28:31], a[28:31], v[132:135]
    v_mul_f32 v50, v138, v142
    s_waitcnt lgkmcnt(3)
    v_mfma_f32_16x16x32_bf16 v[104:107], v[32:35], a[32:35], v[104:107]
    ds_read_b128 v[28:31], v3 offset:9216
    v_mfma_f32_16x16x32_bf16 v[112:115], v[32:35], a[36:39], v[112:115]
    v_exp_f32 v42, v42
    v_mfma_f32_16x16x32_bf16 v[120:123], v[32:35], a[40:43], v[120:123]
    v_mul_f32 v43, v8, v139
    v_mul_f32 v51, v139, v143
    v_mfma_f32_16x16x32_bf16 v[128:131], v[32:35], a[44:47], v[128:131]
    v_exp_f32 v43, v43
    v_mfma_f32_16x16x32_bf16 v[108:111], v[36:39], a[32:35], v[108:111]
    ds_read_b128 v[32:35], v3 offset:10240
    v_mfma_f32_16x16x32_bf16 v[116:119], v[36:39], a[36:39], v[116:119]
    v_fma_f32 v40, v40, v12, v12
    v_mul_f32 v44, v9, v144
    v_mfma_f32_16x16x32_bf16 v[124:127], v[36:39], a[40:43], v[124:127]
    buffer_load_dwordx4 v2, s[12:15], s27 offen offset:1024 sc1 lds
    v_mfma_f32_16x16x32_bf16 v[132:135], v[36:39], a[44:47], v[132:135]
    v_mul_f32 v52, v144, v148
    s_waitcnt lgkmcnt(3)
    v_mfma_f32_16x16x32_bf16 v[104:107], v[16:19], a[48:51], v[104:107]
    ds_read_b128 v[36:39], v3 offset:11264
    v_mfma_f32_16x16x32_bf16 v[112:115], v[16:19], a[52:55], v[112:115]
    v_rcp_f32 v40, v40
    v_mfma_f32_16x16x32_bf16 v[120:123], v[16:19], a[56:59], v[120:123]
    v_fma_f32 v41, v41, v12, v12
    v_mul_f32 v45, v9, v145
    v_mfma_f32_16x16x32_bf16 v[128:131], v[16:19], a[60:63], v[128:131]
    v_exp_f32 v44, v44
    v_mfma_f32_16x16x32_bf16 v[108:111], v[20:23], a[48:51], v[108:111]
    ds_read_b128 v[16:19], v3 offset:12288
    v_mfma_f32_16x16x32_bf16 v[116:119], v[20:23], a[52:55], v[116:119]
    v_rcp_f32 v41, v41
    v_mfma_f32_16x16x32_bf16 v[124:127], v[20:23], a[56:59], v[124:127]
    v_mul_f32 v53, v145, v149
    v_fma_f32 v42, v42, v12, v12
    v_mfma_f32_16x16x32_bf16 v[132:135], v[20:23], a[60:63], v[132:135]
    v_mul_f32 v46, v9, v146
    s_waitcnt lgkmcnt(3)
    v_mfma_f32_16x16x32_bf16 v[104:107], v[24:27], a[64:67], v[104:107]
    ds_read_b128 v[20:23], v3 offset:13312
    v_mfma_f32_16x16x32_bf16 v[112:115], v[24:27], a[68:71], v[112:115]
    v_exp_f32 v45, v45
    v_mfma_f32_16x16x32_bf16 v[120:123], v[24:27], a[72:75], v[120:123]
    buffer_load_dwordx4 v2, s[12:15], s27 offen offset:2048 sc1 lds
    v_mfma_f32_16x16x32_bf16 v[128:131], v[24:27], a[76:79], v[128:131]
    v_rcp_f32 v42, v42
    v_mfma_f32_16x16x32_bf16 v[108:111], v[28:31], a[64:67], v[108:111]
    ds_read_b128 v[24:27], v3 offset:14336
    v_mfma_f32_16x16x32_bf16 v[116:119], v[28:31], a[68:71], v[116:119]
    v_exp_f32 v46, v46
    v_mfma_f32_16x16x32_bf16 v[124:127], v[28:31], a[72:75], v[124:127]
    v_mul_f32 v54, v146, v150
    v_fma_f32 v43, v43, v12, v12
    v_mfma_f32_16x16x32_bf16 v[132:135], v[28:31], a[76:79], v[132:135]
    v_mul_f32 v48, v48, v40
    s_waitcnt lgkmcnt(3)
    v_mfma_f32_16x16x32_bf16 v[104:107], v[32:35], a[80:83], v[104:107]
    ds_read_b128 v[28:31], v3 offset:15360
    v_mfma_f32_16x16x32_bf16 v[112:115], v[32:35], a[84:87], v[112:115]
    v_rcp_f32 v43, v43
    v_mfma_f32_16x16x32_bf16 v[120:123], v[32:35], a[88:91], v[120:123]
    v_mul_f32 v47, v9, v147
    v_mul_f32 v55, v147, v151
    v_mfma_f32_16x16x32_bf16 v[128:131], v[32:35], a[92:95], v[128:131]
    v_exp_f32 v47, v47
    v_mfma_f32_16x16x32_bf16 v[108:111], v[36:39], a[80:83], v[108:111]
    ds_read_b128 v[32:35], v3 offset:16384
    v_mfma_f32_16x16x32_bf16 v[116:119], v[36:39], a[84:87], v[116:119]
    v_fma_f32 v44, v44, v13, v13
    v_mul_f32 v49, v49, v41
    v_mfma_f32_16x16x32_bf16 v[124:127], v[36:39], a[88:91], v[124:127]
    buffer_load_dwordx4 v2, s[12:15], s27 offen offset:3072 sc1 lds
    v_mfma_f32_16x16x32_bf16 v[132:135], v[36:39], a[92:95], v[132:135]
    v_fma_f32 v45, v45, v13, v13
    s_waitcnt lgkmcnt(3)
    v_mfma_f32_16x16x32_bf16 v[104:107], v[16:19], a[96:99], v[104:107]
    ds_read_b128 v[36:39], v3 offset:17408
    v_mfma_f32_16x16x32_bf16 v[112:115], v[16:19], a[100:103], v[112:115]
    v_rcp_f32 v44, v44
    v_mfma_f32_16x16x32_bf16 v[120:123], v[16:19], a[104:107], v[120:123]
    v_mul_f32 v50, v50, v42
    v_fma_f32 v46, v46, v13, v13
    v_mfma_f32_16x16x32_bf16 v[128:131], v[16:19], a[108:111], v[128:131]
    v_rcp_f32 v45, v45
    v_mfma_f32_16x16x32_bf16 v[108:111], v[20:23], a[96:99], v[108:111]
    ds_read_b128 v[16:19], v3 offset:18432
    v_mfma_f32_16x16x32_bf16 v[116:119], v[20:23], a[100:103], v[116:119]
    v_rcp_f32 v46, v46
    v_mfma_f32_16x16x32_bf16 v[124:127], v[20:23], a[104:107], v[124:127]
    v_mul_f32 v51, v51, v43
    v_fma_f32 v47, v47, v13, v13
    v_mfma_f32_16x16x32_bf16 v[132:135], v[20:23], a[108:111], v[132:135]
    v_mul_f32 v52, v52, v44
    s_waitcnt lgkmcnt(3)
    v_mfma_f32_16x16x32_bf16 v[104:107], v[24:27], a[112:115], v[104:107]
    ds_read_b128 v[20:23], v3 offset:19456
    v_mfma_f32_16x16x32_bf16 v[112:115], v[24:27], a[116:119], v[112:115]
    s_add_u32 m0, s49, 4096
    s_add_u32 s27, s48, 4096
    v_mfma_f32_16x16x32_bf16 v[120:123], v[24:27], a[120:123], v[120:123]
    buffer_load_dwordx4 v2, s[12:15], s27 offen offset:0 sc1 lds
    v_mfma_f32_16x16x32_bf16 v[128:131], v[24:27], a[124:127], v[128:131]
    v_rcp_f32 v47, v47
    v_mfma_f32_16x16x32_bf16 v[108:111], v[28:31], a[112:115], v[108:111]
    ds_read_b128 v[24:27], v3 offset:20480
    v_mfma_f32_16x16x32_bf16 v[116:119], v[28:31], a[116:119], v[116:119]
    v_mul_f32 v53, v53, v45
    v_mul_f32 v54, v54, v46
    v_mfma_f32_16x16x32_bf16 v[124:127], v[28:31], a[120:123], v[124:127]
    v_mul_f32 v55, v55, v47
    v_cvt_pk_bf16_f32 v40, v48, v49
    v_mfma_f32_16x16x32_bf16 v[132:135], v[28:31], a[124:127], v[132:135]
    v_cvt_pk_bf16_f32 v42, v52, v53
    s_waitcnt lgkmcnt(3)
    v_mfma_f32_16x16x32_bf16 v[104:107], v[32:35], a[128:131], v[104:107]
    ds_read_b128 v[28:31], v3 offset:21504
    v_mfma_f32_16x16x32_bf16 v[112:115], v[32:35], a[132:135], v[112:115]
    v_cvt_pk_bf16_f32 v41, v50, v51
    v_cvt_pk_bf16_f32 v43, v54, v55
    v_mfma_f32_16x16x32_bf16 v[120:123], v[32:35], a[136:139], v[120:123]
    v_permlane16_swap_b32 v40, v42
    v_permlane16_swap_b32 v41, v43
    v_mfma_f32_16x16x32_bf16 v[128:131], v[32:35], a[140:143], v[128:131]
    buffer_store_dwordx4 v[40:43], v5, s[12:15], s30 offen sc1
    v_mfma_f32_16x16x32_bf16 v[108:111], v[36:39], a[128:131], v[108:111]
    ds_read_b128 v[32:35], v3 offset:22528
    v_mfma_f32_16x16x32_bf16 v[116:119], v[36:39], a[132:135], v[116:119]
    s_add_u32 s30, s30, 4096
    v_mul_f32 v56, v10, v152
    v_mfma_f32_16x16x32_bf16 v[124:127], v[36:39], a[136:139], v[124:127]
    buffer_load_dwordx4 v2, s[12:15], s27 offen offset:1024 sc1 lds
    v_mfma_f32_16x16x32_bf16 v[132:135], v[36:39], a[140:143], v[132:135]
    v_mul_f32 v64, v152, v156
    s_waitcnt lgkmcnt(3)
    v_mfma_f32_16x16x32_bf16 v[104:107], v[16:19], a[144:147], v[104:107]
    ds_read_b128 v[36:39], v3 offset:23552
    v_mfma_f32_16x16x32_bf16 v[112:115], v[16:19], a[148:151], v[112:115]
    v_exp_f32 v56, v56
    v_mfma_f32_16x16x32_bf16 v[120:123], v[16:19], a[152:155], v[120:123]
    v_mul_f32 v57, v10, v153
    v_mul_f32 v65, v153, v157
    v_mfma_f32_16x16x32_bf16 v[128:131], v[16:19], a[156:159], v[128:131]
    v_exp_f32 v57, v57
    v_mfma_f32_16x16x32_bf16 v[108:111], v[20:23], a[144:147], v[108:111]
    ds_read_b128 v[16:19], v3 offset:24576
    v_mfma_f32_16x16x32_bf16 v[116:119], v[20:23], a[148:151], v[116:119]
    v_mul_f32 v58, v10, v154
    v_mul_f32 v66, v154, v158
    v_mfma_f32_16x16x32_bf16 v[124:127], v[20:23], a[152:155], v[124:127]
    v_exp_f32 v58, v58
    v_mfma_f32_16x16x32_bf16 v[132:135], v[20:23], a[156:159], v[132:135]
    v_mul_f32 v59, v10, v155
    s_waitcnt lgkmcnt(3)
    v_mfma_f32_16x16x32_bf16 v[104:107], v[24:27], a[160:163], v[104:107]
    ds_read_b128 v[20:23], v3 offset:25600
    v_mfma_f32_16x16x32_bf16 v[112:115], v[24:27], a[164:167], v[112:115]
    v_exp_f32 v59, v59
    v_mfma_f32_16x16x32_bf16 v[120:123], v[24:27], a[168:171], v[120:123]
    buffer_load_dwordx4 v2, s[12:15], s27 offen offset:2048 sc1 lds
    v_mfma_f32_16x16x32_bf16 v[128:131], v[24:27], a[172:175], v[128:131]
    v_mul_f32 v67, v155, v159
    v_fma_f32 v56, v56, v14, v14
    v_mfma_f32_16x16x32_bf16 v[108:111], v[28:31], a[160:163], v[108:111]
    ds_read_b128 v[24:27], v3 offset:26624
    v_mfma_f32_16x16x32_bf16 v[116:119], v[28:31], a[164:167], v[116:119]
    v_rcp_f32 v56, v56
    v_mfma_f32_16x16x32_bf16 v[124:127], v[28:31], a[168:171], v[124:127]
    v_mul_f32 v60, v11, v160
    v_mul_f32 v68, v160, v164
    v_mfma_f32_16x16x32_bf16 v[132:135], v[28:31], a[172:175], v[132:135]
    v_fma_f32 v57, v57, v14, v14
    s_waitcnt lgkmcnt(3)
    v_mfma_f32_16x16x32_bf16 v[104:107], v[32:35], a[176:179], v[104:107]
    ds_read_b128 v[28:31], v3 offset:27648
    v_mfma_f32_16x16x32_bf16 v[112:115], v[32:35], a[180:183], v[112:115]
    v_exp_f32 v60, v60
    v_mfma_f32_16x16x32_bf16 v[120:123], v[32:35], a[184:187], v[120:123]
    v_mul_f32 v61, v11, v161
    v_mul_f32 v69, v161, v165
    v_mfma_f32_16x16x32_bf16 v[128:131], v[32:35], a[188:191], v[128:131]
    v_rcp_f32 v57, v57
    v_mfma_f32_16x16x32_bf16 v[108:111], v[36:39], a[176:179], v[108:111]
    ds_read_b128 v[32:35], v3 offset:28672
    v_mfma_f32_16x16x32_bf16 v[116:119], v[36:39], a[180:183], v[116:119]
    v_exp_f32 v61, v61
    v_mfma_f32_16x16x32_bf16 v[124:127], v[36:39], a[184:187], v[124:127]
    buffer_load_dwordx4 v2, s[12:15], s27 offen offset:3072 sc1 lds
    v_mfma_f32_16x16x32_bf16 v[132:135], v[36:39], a[188:191], v[132:135]
    v_fma_f32 v58, v58, v14, v14
    s_waitcnt lgkmcnt(3)
    v_mfma_f32_16x16x32_bf16 v[104:107], v[16:19], a[192:195], v[104:107]
    ds_read_b128 v[36:39], v3 offset:29696
    v_mfma_f32_16x16x32_bf16 v[112:115], v[16:19], a[196:199], v[112:115]
    v_rcp_f32 v58, v58
    v_mfma_f32_16x16x32_bf16 v[120:123], v[16:19], a[200:203], v[120:123]
    v_mul_f32 v62, v11, v162
    v_mul_f32 v70, v162, v166
    v_mfma_f32_16x16x32_bf16 v[128:131], v[16:19], a[204:207], v[128:131]
    v_exp_f32 v62, v62
    v_mfma_f32_16x16x32_bf16 v[108:111], v[20:23], a[192:195], v[108:111]
    ds_read_b128 v[16:19], v3 offset:30720
    v_mfma_f32_16x16x32_bf16 v[116:119], v[20:23], a[196:199], v[116:119]
    v_fma_f32 v59, v59, v14, v14
    v_mul_f32 v64, v64, v56
    v_mfma_f32_16x16x32_bf16 v[124:127], v[20:23], a[200:203], v[124:127]
    v_rcp_f32 v59, v59
    v_mfma_f32_16x16x32_bf16 v[132:135], v[20:23], a[204:207], v[132:135]
    v_mul_f32 v63, v11, v163
    s_waitcnt lgkmcnt(3)
    v_mfma_f32_16x16x32_bf16 v[104:107], v[24:27], a[208:211], v[104:107]
    ds_read_b128 v[20:23], v3 offset:31744
    v_mfma_f32_16x16x32_bf16 v[112:115], v[24:27], a[212:215], v[112:115]
    s_add_u32 m0, s49, 8192
    s_add_u32 s27, s48, 8192
    v_mfma_f32_16x16x32_bf16 v[120:123], v[24:27], a[216:219], v[120:123]
    buffer_load_dwordx4 v2, s[12:15], s27 offen offset:0 sc1 lds
    v_mfma_f32_16x16x32_bf16 v[128:131], v[24:27], a[220:223], v[128:131]
    s_add_u32 s48, s48, 36864
    s_add_u32 s49, s49, 36864
    s_cmp_ge_u32 s49, 147456
    s_cselect_b32 s27, 147456, 0
    s_sub_u32 s49, s49, s27
    v_mfma_f32_16x16x32_bf16 v[108:111], v[28:31], a[208:211], v[108:111]
    ds_read_b128 v[24:27], v3 offset:32768
    v_mfma_f32_16x16x32_bf16 v[116:119], v[28:31], a[212:215], v[116:119]
    v_exp_f32 v63, v63
    v_mfma_f32_16x16x32_bf16 v[124:127], v[28:31], a[216:219], v[124:127]
    v_mul_f32 v71, v163, v167
    v_fma_f32 v60, v60, v15, v15
    v_mfma_f32_16x16x32_bf16 v[132:135], v[28:31], a[220:223], v[132:135]
    v_mul_f32 v65, v65, v57
    s_waitcnt lgkmcnt(3)
    v_mfma_f32_16x16x32_bf16 v[104:107], v[32:35], a[224:227], v[104:107]
    ds_read_b128 v[28:31], v3 offset:33792
    v_mfma_f32_16x16x32_bf16 v[112:115], v[32:35], a[228:231], v[112:115]
    v_rcp_f32 v60, v60
    v_mfma_f32_16x16x32_bf16 v[120:123], v[32:35], a[232:235], v[120:123]
    v_fma_f32 v61, v61, v15, v15
    v_mul_f32 v66, v66, v58
    v_mfma_f32_16x16x32_bf16 v[128:131], v[32:35], a[236:239], v[128:131]
    v_rcp_f32 v61, v61
    v_mfma_f32_16x16x32_bf16 v[108:111], v[36:39], a[224:227], v[108:111]
    ds_read_b128 v[32:35], v3 offset:34816
    v_mfma_f32_16x16x32_bf16 v[116:119], v[36:39], a[228:231], v[116:119]
    v_fma_f32 v62, v62, v15, v15
    v_mul_f32 v67, v67, v59
    v_mfma_f32_16x16x32_bf16 v[124:127], v[36:39], a[232:235], v[124:127]
    v_rcp_f32 v62, v62
    v_mfma_f32_16x16x32_bf16 v[132:135], v[36:39], a[236:239], v[132:135]
    v_fma_f32 v63, v63, v15, v15
    s_waitcnt lgkmcnt(3)
    v_mfma_f32_16x16x32_bf16 v[104:107], v[16:19], a[240:243], v[104:107]
    ds_read_b128 v[36:39], v3 offset:35840
    v_mfma_f32_16x16x32_bf16 v[112:115], v[16:19], a[244:247], v[112:115]
    v_rcp_f32 v63, v63
    v_mfma_f32_16x16x32_bf16 v[120:123], v[16:19], a[248:251], v[120:123]
    v_mul_f32 v68, v68, v60
    v_mul_f32 v69, v69, v61
    v_mfma_f32_16x16x32_bf16 v[128:131], v[16:19], a[252:255], v[128:131]
    s_waitcnt vmcnt(10)
    s_barrier
    s_cmp_lg_u32 s3, 0
    s_cbranch_scc1 Lnp47
    v_mov_b32 v255, 5
    s_mov_b64 exec, 1
    buffer_store_dword v255, v246, s[12:15], s35 offen sc1
    s_mov_b64 exec, -1
Lnp47:
    v_mfma_f32_16x16x32_bf16 v[108:111], v[20:23], a[240:243], v[108:111]
    ds_read_b128 v[16:19], v4 offset:0
    v_mfma_f32_16x16x32_bf16 v[116:119], v[20:23], a[244:247], v[116:119]
    v_mul_f32 v70, v70, v62
    v_mul_f32 v71, v71, v63
    v_mfma_f32_16x16x32_bf16 v[124:127], v[20:23], a[248:251], v[124:127]
    v_cvt_pk_bf16_f32 v56, v64, v65
    v_cvt_pk_bf16_f32 v58, v68, v69
    v_mfma_f32_16x16x32_bf16 v[132:135], v[20:23], a[252:255], v[132:135]
    v_cvt_pk_bf16_f32 v57, v66, v67
    s_waitcnt lgkmcnt(3)
    v_mfma_f32_16x16x32_bf16 v[104:107], v[24:27], v[72:75], v[104:107]
    ds_read_b128 v[20:23], v4 offset:1024
    v_mfma_f32_16x16x32_bf16 v[112:115], v[24:27], v[76:79], v[112:115]
    v_cvt_pk_bf16_f32 v59, v70, v71
    v_permlane16_swap_b32 v56, v58
    v_mfma_f32_16x16x32_bf16 v[120:123], v[24:27], v[80:83], v[120:123]
    v_permlane16_swap_b32 v57, v59
    v_mfma_f32_16x16x32_bf16 v[128:131], v[24:27], v[84:87], v[128:131]
    buffer_store_dwordx4 v[56:59], v5, s[12:15], s31 offen sc1
    v_mfma_f32_16x16x32_bf16 v[108:111], v[28:31], v[72:75], v[108:111]
    ds_read_b128 v[24:27], v4 offset:2048
    v_mfma_f32_16x16x32_bf16 v[116:119], v[28:31], v[76:79], v[116:119]
    s_add_u32 s31, s31, 4096
    v_mfma_f32_16x16x32_bf16 v[124:127], v[28:31], v[80:83], v[124:127]
    v_mfma_f32_16x16x32_bf16 v[132:135], v[28:31], v[84:87], v[132:135]
    s_waitcnt lgkmcnt(3)
    v_mfma_f32_16x16x32_bf16 v[104:107], v[32:35], v[88:91], v[104:107]
    ds_read_b128 v[28:31], v4 offset:3072
    v_mfma_f32_16x16x32_bf16 v[112:115], v[32:35], v[92:95], v[112:115]
    v_mfma_f32_16x16x32_bf16 v[120:123], v[32:35], v[96:99], v[120:123]
    v_mfma_f32_16x16x32_bf16 v[128:131], v[32:35], v[100:103], v[128:131]
    v_mfma_f32_16x16x32_bf16 v[108:111], v[36:39], v[88:91], v[108:111]
    ds_read_b128 v[32:35], v4 offset:4096
    v_mfma_f32_16x16x32_bf16 v[116:119], v[36:39], v[92:95], v[116:119]
    v_mfma_f32_16x16x32_bf16 v[124:127], v[36:39], v[96:99], v[124:127]
    v_mfma_f32_16x16x32_bf16 v[132:135], v[36:39], v[100:103], v[132:135]
    v_mov_b32 v3, v4
    v_add_u32 v4, s33, v2
    s_add_u32 s33, s33, 36864
    s_cmp_ge_u32 s33, 147456
    s_cselect_b32 s33, 0, s33
    s_mov_b32 s48, s34
    s_mov_b32 s32, 1
    s_branch Lloop45
Llast46:
    s_waitcnt lgkmcnt(3)
    v_mfma_f32_16x16x32_bf16 v[104:107], v[16:19], a[0:3], 0
    ds_read_b128 v[36:39], v3 offset:5120
    v_mfma_f32_16x16x32_bf16 v[112:115], v[16:19], a[4:7], 0
    v_mfma_f32_16x16x32_bf16 v[120:123], v[16:19], a[8:11], 0
    buffer_load_dword v245, v244, s[12:15], 0 offen sc1
    v_mfma_f32_16x16x32_bf16 v[128:131], v[16:19], a[12:15], 0
    v_mfma_f32_16x16x32_bf16 v[108:111], v[20:23], a[0:3], 0
    ds_read_b128 v[16:19], v3 offset:6144
    v_mfma_f32_16x16x32_bf16 v[116:119], v[20:23], a[4:7], 0
    s_add_u32 m0, s49, 0
    s_add_u32 s27, s48, 0
    v_mfma_f32_16x16x32_bf16 v[124:127], v[20:23], a[8:11], 0
    buffer_load_dwordx4 v2, s[12:15], s27 offen offset:0 sc1 lds
    v_mfma_f32_16x16x32_bf16 v[132:135], v[20:23], a[12:15], 0
    v_mul_f32 v40, v8, v136
    s_waitcnt lgkmcnt(3)
    v_mfma_f32_16x16x32_bf16 v[104:107], v[24:27], a[16:19], v[104:107]
    ds_read_b128 v[20:23], v3 offset:7168
    v_mul_f32 v48, v136, v140
    v_mfma_f32_16x16x32_bf16 v[112:115], v[24:27], a[20:23], v[112:115]
    v_exp_f32 v40, v40
    v_mul_f32 v41, v8, v137
    v_mfma_f32_16x16x32_bf16 v[120:123], v[24:27], a[24:27], v[120:123]
    buffer_load_dwordx4 v2, s[12:15], s27 offen offset:1024 sc1 lds
    v_mfma_f32_16x16x32_bf16 v[128:131], v[24:27], a[28:31], v[128:131]
    v_exp_f32 v41, v41
    v_mfma_f32_16x16x32_bf16 v[108:111], v[28:31], a[16:19], v[108:111]
    ds_read_b128 v[24:27], v3 offset:8192
    v_mul_f32 v49, v137, v141
    v_mfma_f32_16x16x32_bf16 v[116:119], v[28:31], a[20:23], v[116:119]
    v_mul_f32 v42, v8, v138
    v_mul_f32 v50, v138, v142
    v_mfma_f32_16x16x32_bf16 v[124:127], v[28:31], a[24:27], v[124:127]
    buffer_load_dwordx4 v2, s[12:15], s27 offen offset:2048 sc1 lds
    v_mfma_f32_16x16x32_bf16 v[132:135], v[28:31], a[28:31], v[132:135]
    v_mul_f32 v43, v8, v139
    s_waitcnt lgkmcnt(3)
    v_mfma_f32_16x16x32_bf16 v[104:107], v[32:35], a[32:35], v[104:107]
    ds_read_b128 v[28:31], v3 offset:9216
    v_mul_f32 v51, v139, v143
    v_mfma_f32_16x16x32_bf16 v[112:115], v[32:35], a[36:39], v[112:115]
    v_exp_f32 v42, v42
    v_mfma_f32_16x16x32_bf16 v[120:123], v[32:35], a[40:43], v[120:123]
    buffer_load_dwordx4 v2, s[12:15], s27 offen offset:3072 sc1 lds
    v_mfma_f32_16x16x32_bf16 v[128:131], v[32:35], a[44:47], v[128:131]
    v_exp_f32 v43, v43
    v_mfma_f32_16x16x32_bf16 v[108:111], v[36:39], a[32:35], v[108:111]
    ds_read_b128 v[32:35], v3 offset:10240
    v_fma_f32 v40, v40, v12, v12
    v_mfma_f32_16x16x32_bf16 v[116:119], v[36:39], a[36:39], v[116:119]
    s_add_u32 m0, s49, 4096
    s_add_u32 s27, s48, 4096
    v_mfma_f32_16x16x32_bf16 v[124:127], v[36:39], a[40:43], v[124:127]
    buffer_load_dwordx4 v2, s[12:15], s27 offen offset:0 sc1 lds
    v_mfma_f32_16x16x32_bf16 v[132:135], v[36:39], a[44:47], v[132:135]
    v_mul_f32 v44, v9, v144
    s_waitcnt lgkmcnt(3)
    v_mfma_f32_16x16x32_bf16 v[104:107], v[16:19], a[48:51], v[104:107]
    ds_read_b128 v[36:39], v3 offset:11264
    v_mul_f32 v52, v144, v148
    v_mfma_f32_16x16x32_bf16 v[112:115], v[16:19], a[52:55], v[112:115]
    v_rcp_f32 v40, v40
    v_mfma_f32_16x16x32_bf16 v[120:123], v[16:19], a[56:59], v[120:123]
    buffer_load_dwordx4 v2, s[12:15], s27 offen offset:1024 sc1 lds
    v_mfma_f32_16x16x32_bf16 v[128:131], v[16:19], a[60:63], v[128:131]
    v_exp_f32 v44, v44
    v_mfma_f32_16x16x32_bf16 v[108:111], v[20:23], a[48:51], v[108:111]
    ds_read_b128 v[16:19], v3 offset:12288
    v_fma_f32 v41, v41, v12, v12
    v_mfma_f32_16x16x32_bf16 v[116:119], v[20:23], a[52:55], v[116:119]
    v_rcp_f32 v41, v41
    v_mfma_f32_16x16x32_bf16 v[124:127], v[20:23], a[56:59], v[124:127]
    buffer_load_dwordx4 v2, s[12:15], s27 offen offset:2048 sc1 lds
    v_mfma_f32_16x16x32_bf16 v[132:135], v[20:23], a[60:63], v[132:135]
    v_mul_f32 v45, v9, v145
    s_waitcnt lgkmcnt(3)
    v_mfma_f32_16x16x32_bf16 v[104:107], v[24:27], a[64:67], v[104:107]
    ds_read_b128 v[20:23], v3 offset:13312
    v_mul_f32 v53, v145, v149
    v_mfma_f32_16x16x32_bf16 v[112:115], v[24:27], a[68:71], v[112:115]
    v_exp_f32 v45, v45
    v_mfma_f32_16x16x32_bf16 v[120:123], v[24:27], a[72:75], v[120:123]
    buffer_load_dwordx4 v2, s[12:15], s27 offen offset:3072 sc1 lds
    v_mfma_f32_16x16x32_bf16 v[128:131], v[24:27], a[76:79], v[128:131]
    v_fma_f32 v42, v42, v12, v12
    v_mul_f32 v46, v9, v146
    v_mul_f32 v54, v146, v150
    v_mfma_f32_16x16x32_bf16 v[108:111], v[28:31], a[64:67], v[108:111]
    ds_read_b128 v[24:27], v3 offset:14336
    v_fma_f32 v43, v43, v12, v12
    v_mfma_f32_16x16x32_bf16 v[116:119], v[28:31], a[68:71], v[116:119]
    s_add_u32 m0, s49, 8192
    s_add_u32 s27, s48, 8192
    v_mfma_f32_16x16x32_bf16 v[124:127], v[28:31], a[72:75], v[124:127]
    buffer_load_dwordx4 v2, s[12:15], s27 offen offset:0 sc1 lds
    v_mfma_f32_16x16x32_bf16 v[132:135], v[28:31], a[76:79], v[132:135]
    s_add_u32 s48, s48, 36864
    s_add_u32 s49, s49, 36864
    s_cmp_ge_u32 s49, 147456
    s_cselect_b32 s27, 147456, 0
    s_sub_u32 s49, s49, s27
    s_waitcnt lgkmcnt(3)
    v_mfma_f32_16x16x32_bf16 v[104:107], v[32:35], a[80:83], v[104:107]
    ds_read_b128 v[28:31], v3 offset:15360
    v_mul_f32 v48, v48, v40
    v_mfma_f32_16x16x32_bf16 v[112:115], v[32:35], a[84:87], v[112:115]
    v_rcp_f32 v42, v42
    v_mfma_f32_16x16x32_bf16 v[120:123], v[32:35], a[88:91], v[120:123]
    v_exp_f32 v46, v46
    v_mfma_f32_16x16x32_bf16 v[128:131], v[32:35], a[92:95], v[128:131]
    v_rcp_f32 v43, v43
    v_mfma_f32_16x16x32_bf16 v[108:111], v[36:39], a[80:83], v[108:111]
    ds_read_b128 v[32:35], v3 offset:16384
    v_mul_f32 v47, v9, v147
    v_mfma_f32_16x16x32_bf16 v[116:119], v[36:39], a[84:87], v[116:119]
    v_exp_f32 v47, v47
    v_mfma_f32_16x16x32_bf16 v[124:127], v[36:39], a[88:91], v[124:127]
    v_mul_f32 v55, v147, v151
    v_fma_f32 v44, v44, v13, v13
    v_mfma_f32_16x16x32_bf16 v[132:135], v[36:39], a[92:95], v[132:135]
    v_mul_f32 v49, v49, v41
    s_waitcnt vmcnt(9)
    v_cmp_gt_u32 vcc, 5, v245
    s_nop 4
    s_cbranch_vccz Lfok48
    s_mov_b32 s67, 0x40000
Lflp49:
    s_sub_u32 s67, s67, 1
    s_cbranch_scc1 Lfok48
    buffer_load_dword v245, v244, s[12:15], 0 offen sc1
    s_waitcnt vmcnt(0)
    v_cmp_gt_u32 vcc, 5, v245
    s_nop 4
    s_cbranch_vccnz Lflp49
Lfok48:
    s_waitcnt lgkmcnt(3)
    v_mfma_f32_16x16x32_bf16 v[104:107], v[16:19], a[96:99], v[104:107]
    ds_read_b128 v[36:39], v3 offset:17408
    v_fma_f32 v45, v45, v13, v13
    v_mfma_f32_16x16x32_bf16 v[112:115], v[16:19], a[100:103], v[112:115]
    v_rcp_f32 v44, v44
    v_mfma_f32_16x16x32_bf16 v[120:123], v[16:19], a[104:107], v[120:123]
    buffer_load_dwordx4 a[0:3], v2, s[12:15], s56 offen offset:0 sc1
    v_mfma_f32_16x16x32_bf16 v[128:131], v[16:19], a[108:111], v[128:131]
    v_rcp_f32 v45, v45
    v_mfma_f32_16x16x32_bf16 v[108:111], v[20:23], a[96:99], v[108:111]
    ds_read_b128 v[16:19], v3 offset:18432
    v_mul_f32 v50, v50, v42
    v_mfma_f32_16x16x32_bf16 v[116:119], v[20:23], a[100:103], v[116:119]
    v_fma_f32 v46, v46, v13, v13
    v_mul_f32 v51, v51, v43
    v_mfma_f32_16x16x32_bf16 v[124:127], v[20:23], a[104:107], v[124:127]
    buffer_load_dwordx4 a[4:7], v254, s[12:15], s56 offen offset:0 sc1
    v_mfma_f32_16x16x32_bf16 v[132:135], v[20:23], a[108:111], v[132:135]
    v_fma_f32 v47, v47, v13, v13
    s_waitcnt lgkmcnt(3)
    v_mfma_f32_16x16x32_bf16 v[104:107], v[24:27], a[112:115], v[104:107]
    ds_read_b128 v[20:23], v3 offset:19456
    v_mul_f32 v52, v52, v44
    v_mfma_f32_16x16x32_bf16 v[112:115], v[24:27], a[116:119], v[112:115]
    v_rcp_f32 v46, v46
    v_mfma_f32_16x16x32_bf16 v[120:123], v[24:27], a[120:123], v[120:123]
    buffer_load_dwordx4 a[8:11], v2, s[12:15], s56 offen offset:1024 sc1
    v_mfma_f32_16x16x32_bf16 v[128:131], v[24:27], a[124:127], v[128:131]
    v_rcp_f32 v47, v47
    v_mul_f32 v53, v53, v45
    v_mfma_f32_16x16x32_bf16 v[108:111], v[28:31], a[112:115], v[108:111]
    ds_read_b128 v[24:27], v3 offset:20480
    v_mul_f32 v54, v54, v46
    v_mfma_f32_16x16x32_bf16 v[116:119], v[28:31], a[116:119], v[116:119]
    v_mul_f32 v55, v55, v47
    v_cvt_pk_bf16_f32 v40, v48, v49
    v_mfma_f32_16x16x32_bf16 v[124:127], v[28:31], a[120:123], v[124:127]
    buffer_load_dwordx4 a[12:15], v254, s[12:15], s56 offen offset:1024 sc1
    v_mfma_f32_16x16x32_bf16 v[132:135], v[28:31], a[124:127], v[132:135]
    v_cvt_pk_bf16_f32 v42, v52, v53
    s_waitcnt lgkmcnt(3)
    v_mfma_f32_16x16x32_bf16 v[104:107], v[32:35], a[128:131], v[104:107]
    ds_read_b128 v[28:31], v3 offset:21504
    v_cvt_pk_bf16_f32 v41, v50, v51
    v_mfma_f32_16x16x32_bf16 v[112:115], v[32:35], a[132:135], v[112:115]
    v_cvt_pk_bf16_f32 v43, v54, v55
    v_permlane16_swap_b32 v40, v42
    v_mfma_f32_16x16x32_bf16 v[120:123], v[32:35], a[136:139], v[120:123]
    buffer_load_dwordx4 a[16:19], v2, s[12:15], s56 offen offset:2048 sc1
    v_mfma_f32_16x16x32_bf16 v[128:131], v[32:35], a[140:143], v[128:131]
    v_permlane16_swap_b32 v41, v43
    v_mul_f32 v56, v10, v152
    v_mfma_f32_16x16x32_bf16 v[108:111], v[36:39], a[128:131], v[108:111]
    ds_read_b128 v[32:35], v3 offset:22528
    v_mul_f32 v64, v152, v156
    v_mfma_f32_16x16x32_bf16 v[116:119], v[36:39], a[132:135], v[116:119]
    buffer_store_dwordx4 v[40:43], v5, s[12:15], s30 offen sc1
    v_mfma_f32_16x16x32_bf16 v[124:127], v[36:39], a[136:139], v[124:127]
    buffer_load_dwordx4 a[20:23], v254, s[12:15], s56 offen offset:2048 sc1
    v_mfma_f32_16x16x32_bf16 v[132:135], v[36:39], a[140:143], v[132:135]
    s_add_u32 s30, s30, 4096
    s_waitcnt lgkmcnt(3)
    v_mfma_f32_16x16x32_bf16 v[104:107], v[16:19], a[144:147], v[104:107]
    ds_read_b128 v[36:39], v3 offset:23552
    v_mul_f32 v57, v10, v153
    v_mfma_f32_16x16x32_bf16 v[112:115], v[16:19], a[148:151], v[112:115]
    v_exp_f32 v56, v56
    v_mfma_f32_16x16x32_bf16 v[120:123], v[16:19], a[152:155], v[120:123]
    buffer_load_dwordx4 a[24:27], v2, s[12:15], s56 offen offset:3072 sc1
    v_mfma_f32_16x16x32_bf16 v[128:131], v[16:19], a[156:159], v[128:131]
    v_exp_f32 v57, v57
    v_mfma_f32_16x16x32_bf16 v[108:111], v[20:23], a[144:147], v[108:111]
    ds_read_b128 v[16:19], v3 offset:24576
    v_mul_f32 v65, v153, v157
    v_mfma_f32_16x16x32_bf16 v[116:119], v[20:23], a[148:151], v[116:119]
    v_mul_f32 v58, v10, v154
    v_mul_f32 v66, v154, v158
    v_mfma_f32_16x16x32_bf16 v[124:127], v[20:23], a[152:155], v[124:127]
    buffer_load_dwordx4 a[28:31], v254, s[12:15], s56 offen offset:3072 sc1
    v_mfma_f32_16x16x32_bf16 v[132:135], v[20:23], a[156:159], v[132:135]
    s_add_u32 s56, s56, 4096
    s_waitcnt lgkmcnt(3)
    v_mfma_f32_16x16x32_bf16 v[104:107], v[24:27], a[160:163], v[104:107]
    ds_read_b128 v[20:23], v3 offset:25600
    v_mul_f32 v59, v10, v155
    v_mfma_f32_16x16x32_bf16 v[112:115], v[24:27], a[164:167], v[112:115]
    v_exp_f32 v58, v58
    v_mfma_f32_16x16x32_bf16 v[120:123], v[24:27], a[168:171], v[120:123]
    buffer_load_dwordx4 a[32:35], v2, s[12:15], s56 offen offset:0 sc1
    v_mfma_f32_16x16x32_bf16 v[128:131], v[24:27], a[172:175], v[128:131]
    v_exp_f32 v59, v59
    v_mfma_f32_16x16x32_bf16 v[108:111], v[28:31], a[160:163], v[108:111]
    ds_read_b128 v[24:27], v3 offset:26624
    v_mul_f32 v67, v155, v159
    v_mfma_f32_16x16x32_bf16 v[116:119], v[28:31], a[164:167], v[116:119]
    v_fma_f32 v56, v56, v14, v14
    v_mul_f32 v60, v11, v160
    v_mul_f32 v68, v160, v164
    v_mfma_f32_16x16x32_bf16 v[124:127], v[28:31], a[168:171], v[124:127]
    buffer_load_dwordx4 a[36:39], v254, s[12:15], s56 offen offset:0 sc1
    v_mfma_f32_16x16x32_bf16 v[132:135], v[28:31], a[172:175], v[132:135]
    v_fma_f32 v57, v57, v14, v14
    s_waitcnt lgkmcnt(3)
    v_mfma_f32_16x16x32_bf16 v[104:107], v[32:35], a[176:179], v[104:107]
    ds_read_b128 v[28:31], v3 offset:27648
    v_mul_f32 v61, v11, v161
    v_mfma_f32_16x16x32_bf16 v[112:115], v[32:35], a[180:183], v[112:115]
    v_rcp_f32 v56, v56
    v_mfma_f32_16x16x32_bf16 v[120:123], v[32:35], a[184:187], v[120:123]
    buffer_load_dwordx4 a[40:43], v2, s[12:15], s56 offen offset:1024 sc1
    v_mfma_f32_16x16x32_bf16 v[128:131], v[32:35], a[188:191], v[128:131]
    v_exp_f32 v60, v60
    v_mfma_f32_16x16x32_bf16 v[108:111], v[36:39], a[176:179], v[108:111]
    ds_read_b128 v[32:35], v3 offset:28672
    v_mul_f32 v69, v161, v165
    v_mfma_f32_16x16x32_bf16 v[116:119], v[36:39], a[180:183], v[116:119]
    v_rcp_f32 v57, v57
    v_mfma_f32_16x16x32_bf16 v[124:127], v[36:39], a[184:187], v[124:127]
    buffer_load_dwordx4 a[44:47], v254, s[12:15], s56 offen offset:1024 sc1
    v_mfma_f32_16x16x32_bf16 v[132:135], v[36:39], a[188:191], v[132:135]
    v_fma_f32 v58, v58, v14, v14
    s_waitcnt lgkmcnt(3)
    v_mfma_f32_16x16x32_bf16 v[104:107], v[16:19], a[192:195], v[104:107]
    ds_read_b128 v[36:39], v3 offset:29696
    v_mul_f32 v62, v11, v162
    v_mfma_f32_16x16x32_bf16 v[112:115], v[16:19], a[196:199], v[112:115]
    v_exp_f32 v61, v61
    v_mfma_f32_16x16x32_bf16 v[120:123], v[16:19], a[200:203], v[120:123]
    buffer_load_dwordx4 a[48:51], v2, s[12:15], s56 offen offset:2048 sc1
    v_mfma_f32_16x16x32_bf16 v[128:131], v[16:19], a[204:207], v[128:131]
    v_rcp_f32 v58, v58
    v_mfma_f32_16x16x32_bf16 v[108:111], v[20:23], a[192:195], v[108:111]
    ds_read_b128 v[16:19], v3 offset:30720
    v_mul_f32 v70, v162, v166
    v_mfma_f32_16x16x32_bf16 v[116:119], v[20:23], a[196:199], v[116:119]
    v_exp_f32 v62, v62
    v_mfma_f32_16x16x32_bf16 v[124:127], v[20:23], a[200:203], v[124:127]
    buffer_load_dwordx4 a[52:55], v254, s[12:15], s56 offen offset:2048 sc1
    v_mfma_f32_16x16x32_bf16 v[132:135], v[20:23], a[204:207], v[132:135]
    v_fma_f32 v59, v59, v14, v14
    s_waitcnt lgkmcnt(3)
    v_mfma_f32_16x16x32_bf16 v[104:107], v[24:27], a[208:211], v[104:107]
    ds_read_b128 v[20:23], v3 offset:31744
    v_mul_f32 v64, v64, v56
    v_mfma_f32_16x16x32_bf16 v[112:115], v[24:27], a[212:215], v[112:115]
    v_rcp_f32 v59, v59
    v_mfma_f32_16x16x32_bf16 v[120:123], v[24:27], a[216:219], v[120:123]
    buffer_load_dwordx4 a[56:59], v2, s[12:15], s56 offen offset:3072 sc1
    v_mfma_f32_16x16x32_bf16 v[128:131], v[24:27], a[220:223], v[128:131]
    v_mul_f32 v63, v11, v163
    v_mul_f32 v71, v163, v167
    v_mfma_f32_16x16x32_bf16 v[108:111], v[28:31], a[208:211], v[108:111]
    ds_read_b128 v[24:27], v3 offset:32768
    v_fma_f32 v60, v60, v15, v15
    v_mfma_f32_16x16x32_bf16 v[116:119], v[28:31], a[212:215], v[116:119]
    v_exp_f32 v63, v63
    v_mfma_f32_16x16x32_bf16 v[124:127], v[28:31], a[216:219], v[124:127]
    buffer_load_dwordx4 a[60:63], v254, s[12:15], s56 offen offset:3072 sc1
    v_mfma_f32_16x16x32_bf16 v[132:135], v[28:31], a[220:223], v[132:135]
    s_add_u32 s56, s56, 4096
    s_waitcnt lgkmcnt(3)
    v_mfma_f32_16x16x32_bf16 v[104:107], v[32:35], a[224:227], v[104:107]
    ds_read_b128 v[28:31], v3 offset:33792
    v_mul_f32 v65, v65, v57
    v_mfma_f32_16x16x32_bf16 v[112:115], v[32:35], a[228:231], v[112:115]
    v_rcp_f32 v60, v60
    v_fma_f32 v61, v61, v15, v15
    v_mfma_f32_16x16x32_bf16 v[120:123], v[32:35], a[232:235], v[120:123]
    buffer_load_dwordx4 a[64:67], v2, s[12:15], s56 offen offset:0 sc1
    v_mfma_f32_16x16x32_bf16 v[128:131], v[32:35], a[236:239], v[128:131]
    v_rcp_f32 v61, v61
    v_mfma_f32_16x16x32_bf16 v[108:111], v[36:39], a[224:227], v[108:111]
    ds_read_b128 v[32:35], v3 offset:34816
    v_mul_f32 v66, v66, v58
    v_mfma_f32_16x16x32_bf16 v[116:119], v[36:39], a[228:231], v[116:119]
    v_fma_f32 v62, v62, v15, v15
    v_mul_f32 v67, v67, v59
    v_mfma_f32_16x16x32_bf16 v[124:127], v[36:39], a[232:235], v[124:127]
    buffer_load_dwordx4 a[68:71], v254, s[12:15], s56 offen offset:0 sc1
    v_mfma_f32_16x16x32_bf16 v[132:135], v[36:39], a[236:239], v[132:135]
    v_fma_f32 v63, v63, v15, v15
    s_waitcnt lgkmcnt(3)
    v_mfma_f32_16x16x32_bf16 v[104:107], v[16:19], a[240:243], v[104:107]
    ds_read_b128 v[36:39], v3 offset:35840
    v_mul_f32 v68, v68, v60
    v_mfma_f32_16x16x32_bf16 v[112:115], v[16:19], a[244:247], v[112:115]
    v_rcp_f32 v62, v62
    v_mfma_f32_16x16x32_bf16 v[120:123], v[16:19], a[248:251], v[120:123]
    buffer_load_dwordx4 a[72:75], v2, s[12:15], s56 offen offset:1024 sc1
    v_mfma_f32_16x16x32_bf16 v[128:131], v[16:19], a[252:255], v[128:131]
    s_waitcnt vmcnt(30)
    s_barrier
    s_cmp_lg_u32 s3, 0
    s_cbranch_scc1 Lnp50
    v_mov_b32 v255, 7
    s_mov_b64 exec, 1
    buffer_store_dword v255, v246, s[12:15], s35 offen sc1
    s_mov_b64 exec, -1
Lnp50:
    v_mfma_f32_16x16x32_bf16 v[108:111], v[20:23], a[240:243], v[108:111]
    ds_read_b128 v[16:19], v241 offset:0
    v_mul_f32 v69, v69, v61
    v_mfma_f32_16x16x32_bf16 v[116:119], v[20:23], a[244:247], v[116:119]
    v_rcp_f32 v63, v63
    v_mfma_f32_16x16x32_bf16 v[124:127], v[20:23], a[248:251], v[124:127]
    buffer_load_dwordx4 a[76:79], v254, s[12:15], s56 offen offset:1024 sc1
    v_mfma_f32_16x16x32_bf16 v[132:135], v[20:23], a[252:255], v[132:135]
    v_mul_f32 v70, v70, v62
    s_waitcnt lgkmcnt(1)
    v_mfma_f32_16x16x32_bf16 v[104:107], v[24:27], v[72:75], v[104:107]
    ds_read_b128 v[20:23], v241 offset:1024
    v_mul_f32 v71, v71, v63
    v_mfma_f32_16x16x32_bf16 v[112:115], v[24:27], v[76:79], v[112:115]
    v_cvt_pk_bf16_f32 v56, v64, v65
    v_cvt_pk_bf16_f32 v58, v68, v69
    v_mfma_f32_16x16x32_bf16 v[120:123], v[24:27], v[80:83], v[120:123]
    buffer_load_dwordx4 a[80:83], v2, s[12:15], s56 offen offset:2048 sc1
    v_mfma_f32_16x16x32_bf16 v[128:131], v[24:27], v[84:87], v[128:131]
    v_cvt_pk_bf16_f32 v57, v66, v67
    v_cvt_pk_bf16_f32 v59, v70, v71
    v_mfma_f32_16x16x32_bf16 v[108:111], v[28:31], v[72:75], v[108:111]
    ds_read_b128 v[24:27], v241 offset:2048
    v_permlane16_swap_b32 v56, v58
    v_mfma_f32_16x16x32_bf16 v[116:119], v[28:31], v[76:79], v[116:119]
    v_permlane16_swap_b32 v57, v59
    v_mfma_f32_16x16x32_bf16 v[124:127], v[28:31], v[80:83], v[124:127]
    buffer_load_dwordx4 a[84:87], v254, s[12:15], s56 offen offset:2048 sc1
    v_mfma_f32_16x16x32_bf16 v[132:135], v[28:31], v[84:87], v[132:135]
    v_mfma_f32_16x16x32_bf16 v[104:107], v[32:35], v[88:91], v[104:107]
    ds_read_b128 v[28:31], v241 offset:3072
    v_mfma_f32_16x16x32_bf16 v[112:115], v[32:35], v[92:95], v[112:115]
    buffer_store_dwordx4 v[56:59], v5, s[12:15], s31 offen sc1
    v_mfma_f32_16x16x32_bf16 v[120:123], v[32:35], v[96:99], v[120:123]
    buffer_load_dwordx4 a[88:91], v2, s[12:15], s56 offen offset:3072 sc1
    v_mfma_f32_16x16x32_bf16 v[128:131], v[32:35], v[100:103], v[128:131]
    s_add_u32 s31, s31, 4096
    v_mfma_f32_16x16x32_bf16 v[108:111], v[36:39], v[88:91], v[108:111]
    ds_read_b128 v[32:35], v241 offset:4096
    v_mfma_f32_16x16x32_bf16 v[116:119], v[36:39], v[92:95], v[116:119]
    v_mfma_f32_16x16x32_bf16 v[124:127], v[36:39], v[96:99], v[124:127]
    buffer_load_dwordx4 a[92:95], v254, s[12:15], s56 offen offset:3072 sc1
    v_mfma_f32_16x16x32_bf16 v[132:135], v[36:39], v[100:103], v[132:135]
    s_add_u32 s56, s56, 4096
p5_start:
    v_add_u32 v3, 4096, v2
    v_add_u32 v4, 8192, v2
    s_waitcnt vmcnt(24) lgkmcnt(2)
    v_mfma_f32_16x16x32_bf16 v[168:171], v[16:19], a[0:3], 0
    ds_read_b128 v[36:39], v241 offset:5120
    s_add_u32 m0, s55, 110592
    v_mfma_f32_16x16x32_bf16 v[172:175], v[16:19], a[4:7], 0
    buffer_load_dwordx4 v2, s[12:15], s48 offen offset:0 sc1 lds
    v_mfma_f32_16x16x32_bf16 v[176:179], v[20:23], a[0:3], 0
    ds_read_b128 v[248:251], v241 offset:6144
    v_mfma_f32_16x16x32_bf16 v[180:183], v[20:23], a[4:7], 0
    ds_read_b128 v[136:139], v241 offset:7168
    v_mfma_f32_16x16x32_bf16 v[184:187], v[24:27], a[0:3], 0
    ds_read_b128 v[140:143], v241 offset:8192
    v_mul_f32 v40, v8, v104
    v_mul_f32 v48, v104, v108
    v_mul_f32 v41, v8, v105
    v_mul_f32 v49, v105, v109
    v_mfma_f32_16x16x32_bf16 v[188:191], v[24:27], a[4:7], 0
    buffer_load_dwordx4 v2, s[12:15], s48 offen offset:1024 sc1 lds
    v_exp_f32 v40, v40
    v_mul_f32 v42, v8, v106
    s_waitcnt lgkmcnt(3)
    v_mfma_f32_16x16x32_bf16 v[192:195], v[28:31], a[0:3], 0
    ds_read_b128 v[144:147], v241 offset:9216
    v_exp_f32 v41, v41
    v_mul_f32 v50, v106, v110
    v_mul_f32 v43, v8, v107
    v_mfma_f32_16x16x32_bf16 v[196:199], v[28:31], a[4:7], 0
    ds_read_b128 v[148:151], v241 offset:10240
    v_exp_f32 v42, v42
    v_mul_f32 v51, v107, v111
    v_fma_f32 v40, v40, v12, v12
    v_mfma_f32_16x16x32_bf16 v[200:203], v[32:35], a[0:3], 0
    ds_read_b128 v[152:155], v241 offset:11264
    v_exp_f32 v43, v43
    v_mul_f32 v44, v9, v112
    v_mul_f32 v52, v112, v116
    v_mfma_f32_16x16x32_bf16 v[204:207], v[32:35], a[4:7], 0
    buffer_load_dwordx4 v2, s[12:15], s48 offen offset:2048 sc1 lds
    v_rcp_f32 v40, v40
    v_fma_f32 v41, v41, v12, v12
    s_waitcnt vmcnt(25)
    v_mfma_f32_16x16x32_bf16 v[168:171], v[36:39], a[8:11], v[168:171]
    ds_read_b128 v[16:19], v241 offset:12288
    v_exp_f32 v44, v44
    v_mul_f32 v45, v9, v113
    v_mul_f32 v53, v113, v117
    v_mfma_f32_16x16x32_bf16 v[172:175], v[36:39], a[12:15], v[172:175]
    v_rcp_f32 v41, v41
    v_fma_f32 v42, v42, v12, v12
    v_mul_f32 v46, v9, v114
    s_waitcnt lgkmcnt(4)
    v_mfma_f32_16x16x32_bf16 v[176:179], v[248:251], a[8:11], v[176:179]
    ds_read_b128 v[20:23], v241 offset:13312
    v_exp_f32 v45, v45
    v_mul_f32 v54, v114, v118
    v_fma_f32 v43, v43, v12, v12
    v_mfma_f32_16x16x32_bf16 v[180:183], v[248:251], a[12:15], v[180:183]
    buffer_load_dwordx4 v2, s[12:15], s48 offen offset:3072 sc1 lds
    v_rcp_f32 v42, v42
    v_mul_f32 v48, v48, v40
    v_mfma_f32_16x16x32_bf16 v[184:187], v[136:139], a[8:11], v[184:187]
    ds_read_b128 v[24:27], v241 offset:14336
    v_exp_f32 v46, v46
    v_mul_f32 v47, v9, v115
    v_mul_f32 v55, v115, v119
    v_mfma_f32_16x16x32_bf16 v[188:191], v[136:139], a[12:15], v[188:191]
    v_rcp_f32 v43, v43
    v_fma_f32 v44, v44, v13, v13
    v_mul_f32 v49, v49, v41
    v_mfma_f32_16x16x32_bf16 v[192:195], v[140:143], a[8:11], v[192:195]
    ds_read_b128 v[28:31], v241 offset:15360
    s_add_u32 m0, s55, 114688
    v_exp_f32 v47, v47
    v_mfma_f32_16x16x32_bf16 v[196:199], v[140:143], a[12:15], v[196:199]
    buffer_load_dwordx4 v3, s[12:15], s48 offen offset:0 sc1 lds
    v_rcp_f32 v44, v44
    v_fma_f32 v45, v45, v13, v13
    s_waitcnt lgkmcnt(4)
    v_mfma_f32_16x16x32_bf16 v[200:203], v[144:147], a[8:11], v[200:203]
    ds_read_b128 v[32:35], v241 offset:16384
    v_rcp_f32 v45, v45
    v_mul_f32 v50, v50, v42
    v_fma_f32 v46, v46, v13, v13
    v_mfma_f32_16x16x32_bf16 v[204:207], v[144:147], a[12:15], v[204:207]
    buffer_load_dwordx4 v3, s[12:15], s48 offen offset:1024 sc1 lds
    v_rcp_f32 v46, v46
    v_mul_f32 v51, v51, v43
    s_waitcnt vmcnt(25)
    v_mfma_f32_16x16x32_bf16 v[168:171], v[148:151], a[16:19], v[168:171]
    ds_read_b128 v[36:39], v241 offset:17408
    v_fma_f32 v47, v47, v13, v13
    v_mul_f32 v52, v52, v44
    v_mul_f32 v53, v53, v45
    v_mul_f32 v54, v54, v46
    v_mfma_f32_16x16x32_bf16 v[172:175], v[148:151], a[20:23], v[172:175]
    v_rcp_f32 v47, v47
    v_cvt_pk_bf16_f32 v40, v48, v49
    v_cvt_pk_bf16_f32 v42, v52, v53
    v_mfma_f32_16x16x32_bf16 v[176:179], v[152:155], a[16:19], v[176:179]
    ds_read_b128 v[248:251], v241 offset:18432
    v_mul_f32 v55, v55, v47
    v_cvt_pk_bf16_f32 v41, v50, v51
    v_permlane16_swap_b32 v40, v42
    v_mul_f32 v56, v10, v120
    v_mfma_f32_16x16x32_bf16 v[180:183], v[152:155], a[20:23], v[180:183]
    buffer_load_dwordx4 a[96:99], v2, s[12:15], s56 offen offset:0 sc1
    v_exp_f32 v56, v56
    v_cvt_pk_bf16_f32 v43, v54, v55
    s_waitcnt lgkmcnt(4)
    v_mfma_f32_16x16x32_bf16 v[184:187], v[16:19], a[16:19], v[184:187]
    ds_read_b128 v[136:139], v241 offset:19456
    v_permlane16_swap_b32 v41, v43
    v_mul_f32 v64, v120, v124
    v_mul_f32 v57, v10, v121
    v_mul_f32 v65, v121, v125
    v_mfma_f32_16x16x32_bf16 v[188:191], v[16:19], a[20:23], v[188:191]
    buffer_store_dwordx4 v[40:43], v5, s[12:15], s30 offen sc1
    s_add_u32 s30, s30, 4096
    v_mul_f32 v58, v10, v122
    v_mfma_f32_16x16x32_bf16 v[192:195], v[20:23], a[16:19], v[192:195]
    ds_read_b128 v[140:143], v241 offset:20480
    v_exp_f32 v57, v57
    v_mul_f32 v66, v122, v126
    v_mul_f32 v59, v10, v123
    v_mfma_f32_16x16x32_bf16 v[196:199], v[20:23], a[20:23], v[196:199]
    buffer_load_dwordx4 a[100:103], v254, s[12:15], s56 offen offset:0 sc1
    v_exp_f32 v58, v58
    v_mul_f32 v67, v123, v127
    v_mfma_f32_16x16x32_bf16 v[200:203], v[24:27], a[16:19], v[200:203]
    ds_read_b128 v[144:147], v241 offset:21504
    v_exp_f32 v59, v59
    v_fma_f32 v56, v56, v14, v14
    v_mul_f32 v60, v11, v128
    v_mfma_f32_16x16x32_bf16 v[204:207], v[24:27], a[20:23], v[204:207]
    v_rcp_f32 v56, v56
    v_mul_f32 v68, v128, v132
    v_fma_f32 v57, v57, v14, v14
    s_waitcnt vmcnt(26) lgkmcnt(4)
    v_mfma_f32_16x16x32_bf16 v[168:171], v[28:31], a[24:27], v[168:171]
    ds_read_b128 v[148:151], v241 offset:22528
    v_exp_f32 v60, v60
    v_mul_f32 v61, v11, v129
    v_mul_f32 v69, v129, v133
    v_mfma_f32_16x16x32_bf16 v[172:175], v[28:31], a[28:31], v[172:175]
    buffer_load_dwordx4 v3, s[12:15], s48 offen offset:2048 sc1 lds
    v_rcp_f32 v57, v57
    v_fma_f32 v58, v58, v14, v14
    v_mfma_f32_16x16x32_bf16 v[176:179], v[32:35], a[24:27], v[176:179]
    ds_read_b128 v[152:155], v241 offset:23552
    v_exp_f32 v61, v61
    v_mul_f32 v62, v11, v130
    v_mul_f32 v70, v130, v134
    v_mfma_f32_16x16x32_bf16 v[180:183], v[32:35], a[28:31], v[180:183]
    v_rcp_f32 v58, v58
    v_fma_f32 v59, v59, v14, v14
    v_mul_f32 v64, v64, v56
    v_mfma_f32_16x16x32_bf16 v[184:187], v[36:39], a[24:27], v[184:187]
    ds_read_b128 v[16:19], v241 offset:24576
    v_exp_f32 v62, v62
    v_mul_f32 v63, v11, v131
    v_mul_f32 v71, v131, v135
    v_mfma_f32_16x16x32_bf16 v[188:191], v[36:39], a[28:31], v[188:191]
    buffer_load_dwordx4 v3, s[12:15], s48 offen offset:3072 sc1 lds
    v_rcp_f32 v59, v59
    v_fma_f32 v60, v60, v15, v15
    s_waitcnt lgkmcnt(4)
    v_mfma_f32_16x16x32_bf16 v[192:195], v[248:251], a[24:27], v[192:195]
    ds_read_b128 v[20:23], v241 offset:25600
    v_exp_f32 v63, v63
    v_mul_f32 v65, v65, v57
    v_fma_f32 v61, v61, v15, v15
    v_mfma_f32_16x16x32_bf16 v[196:199], v[248:251], a[28:31], v[196:199]
    v_rcp_f32 v60, v60
    v_mul_f32 v66, v66, v58
    v_fma_f32 v62, v62, v15, v15
    v_mfma_f32_16x16x32_bf16 v[200:203], v[136:139], a[24:27], v[200:203]
    ds_read_b128 v[24:27], v241 offset:26624
    s_add_u32 m0, s55, 118784
    v_rcp_f32 v61, v61
    v_mfma_f32_16x16x32_bf16 v[204:207], v[136:139], a[28:31], v[204:207]
    buffer_load_dwordx4 v4, s[12:15], s48 offen offset:0 sc1 lds
    s_add_u32 s48, s48, 36864
    v_rcp_f32 v62, v62
    v_mul_f32 v67, v67, v59
    s_waitcnt vmcnt(27)
    v_mfma_f32_16x16x32_bf16 v[168:171], v[140:143], a[32:35], v[168:171]
    ds_read_b128 v[28:31], v241 offset:27648
    v_fma_f32 v63, v63, v15, v15
    v_mul_f32 v68, v68, v60
    v_mul_f32 v69, v69, v61
    v_mul_f32 v70, v70, v62
    v_mfma_f32_16x16x32_bf16 v[172:175], v[140:143], a[36:39], v[172:175]
    buffer_load_dwordx4 a[104:107], v2, s[12:15], s56 offen offset:1024 sc1
    v_rcp_f32 v63, v63
    v_cvt_pk_bf16_f32 v56, v64, v65
    buffer_load_dword v245, v244, s[12:15], 0 offen sc1
    s_waitcnt lgkmcnt(4)
    v_mfma_f32_16x16x32_bf16 v[176:179], v[144:147], a[32:35], v[176:179]
    ds_read_b128 v[32:35], v241 offset:28672
    v_mul_f32 v71, v71, v63
    v_cvt_pk_bf16_f32 v58, v68, v69
    v_cvt_pk_bf16_f32 v57, v66, v67
    v_mfma_f32_16x16x32_bf16 v[180:183], v[144:147], a[36:39], v[180:183]
    v_cvt_pk_bf16_f32 v59, v70, v71
    v_permlane16_swap_b32 v56, v58
    v_mfma_f32_16x16x32_bf16 v[184:187], v[148:151], a[32:35], v[184:187]
    ds_read_b128 v[36:39], v241 offset:29696
    v_permlane16_swap_b32 v57, v59
    v_mfma_f32_16x16x32_bf16 v[188:191], v[148:151], a[36:39], v[188:191]
    buffer_load_dwordx4 a[108:111], v254, s[12:15], s56 offen offset:1024 sc1
    buffer_store_dwordx4 v[56:59], v5, s[12:15], s31 offen sc1
    s_add_u32 s31, s31, 4096
    v_mfma_f32_16x16x32_bf16 v[192:195], v[152:155], a[32:35], v[192:195]
    ds_read_b128 v[248:251], v241 offset:30720
    v_mfma_f32_16x16x32_bf16 v[196:199], v[152:155], a[36:39], v[196:199]
    v_add_u32 v6, 18432, v240
    s_waitcnt lgkmcnt(4)
    v_mfma_f32_16x16x32_bf16 v[200:203], v[16:19], a[32:35], v[200:203]
    ds_read_b128 v[136:139], v241 offset:31744
    v_mfma_f32_16x16x32_bf16 v[204:207], v[16:19], a[36:39], v[204:207]
    buffer_load_dwordx4 a[112:115], v2, s[12:15], s56 offen offset:2048 sc1
    s_waitcnt vmcnt(30)
    v_mfma_f32_16x16x32_bf16 v[168:171], v[20:23], a[40:43], v[168:171]
    ds_read_b128 v[140:143], v241 offset:32768
    v_mfma_f32_16x16x32_bf16 v[172:175], v[20:23], a[44:47], v[172:175]
    v_lshl_add_u32 v7, v247, 5, v252
    v_mul_u32_u24 v5, 18432, v247
    v_mfma_f32_16x16x32_bf16 v[176:179], v[24:27], a[40:43], v[176:179]
    ds_read_b128 v[144:147], v241 offset:33792
    v_mfma_f32_16x16x32_bf16 v[180:183], v[24:27], a[44:47], v[180:183]
    buffer_load_dwordx4 a[116:119], v254, s[12:15], s56 offen offset:2048 sc1
    s_waitcnt lgkmcnt(4)
    v_mfma_f32_16x16x32_bf16 v[184:187], v[28:31], a[40:43], v[184:187]
    ds_read_b128 v[148:151], v241 offset:34816
    v_mfma_f32_16x16x32_bf16 v[188:191], v[28:31], a[44:47], v[188:191]
    v_add_u32 v5, v5, v252
    v_mfma_f32_16x16x32_bf16 v[192:195], v[32:35], a[40:43], v[192:195]
    ds_read_b128 v[152:155], v241 offset:35840
    v_mfma_f32_16x16x32_bf16 v[196:199], v[32:35], a[44:47], v[196:199]
    buffer_load_dwordx4 a[120:123], v2, s[12:15], s56 offen offset:3072 sc1
    v_mfma_f32_16x16x32_bf16 v[200:203], v[36:39], a[40:43], v[200:203]
    s_waitcnt vmcnt(45)
    s_barrier
    ds_read_b128 v[16:19], v242 offset:0
    v_mfma_f32_16x16x32_bf16 v[204:207], v[36:39], a[44:47], v[204:207]
    s_waitcnt vmcnt(30) lgkmcnt(4)
    v_mfma_f32_16x16x32_bf16 v[168:171], v[248:251], a[48:51], v[168:171]
    ds_read_b128 v[20:23], v242 offset:1024
    v_mfma_f32_16x16x32_bf16 v[172:175], v[248:251], a[52:55], v[172:175]
    buffer_load_dwordx4 a[124:127], v254, s[12:15], s56 offen offset:3072 sc1
    s_add_u32 s56, s56, 4096
    v_mfma_f32_16x16x32_bf16 v[176:179], v[136:139], a[48:51], v[176:179]
    ds_read_b128 v[24:27], v242 offset:2048
    v_mfma_f32_16x16x32_bf16 v[180:183], v[136:139], a[52:55], v[180:183]
    buffer_load_dwordx4 a[128:131], v2, s[12:15], s56 offen offset:0 sc1
    v_mfma_f32_16x16x32_bf16 v[184:187], v[140:143], a[48:51], v[184:187]
    ds_read_b128 v[28:31], v242 offset:3072
    v_mfma_f32_16x16x32_bf16 v[188:191], v[140:143], a[52:55], v[188:191]
    s_waitcnt lgkmcnt(4)
    v_mfma_f32_16x16x32_bf16 v[192:195], v[144:147], a[48:51], v[192:195]
    ds_read_b128 v[32:35], v242 offset:4096
    v_mfma_f32_16x16x32_bf16 v[196:199], v[144:147], a[52:55], v[196:199]
    buffer_load_dwordx4 a[132:135], v254, s[12:15], s56 offen offset:0 sc1
    v_mfma_f32_16x16x32_bf16 v[200:203], v[148:151], a[48:51], v[200:203]
    ds_read_b128 v[36:39], v242 offset:5120
    v_mfma_f32_16x16x32_bf16 v[204:207], v[148:151], a[52:55], v[204:207]
    s_waitcnt vmcnt(31)
    v_mfma_f32_16x16x32_bf16 v[168:171], v[152:155], a[56:59], v[168:171]
    ds_read_b128 v[248:251], v242 offset:6144
    s_add_u32 m0, s55, 0
    v_mfma_f32_16x16x32_bf16 v[172:175], v[152:155], a[60:63], v[172:175]
    buffer_load_dwordx4 v2, s[12:15], s48 offen offset:0 sc1 lds
    s_waitcnt lgkmcnt(4)
    v_mfma_f32_16x16x32_bf16 v[176:179], v[16:19], a[56:59], v[176:179]
    ds_read_b128 v[136:139], v242 offset:7168
    v_mfma_f32_16x16x32_bf16 v[180:183], v[16:19], a[60:63], v[180:183]
    v_mfma_f32_16x16x32_bf16 v[184:187], v[20:23], a[56:59], v[184:187]
    ds_read_b128 v[140:143], v242 offset:8192
    v_mfma_f32_16x16x32_bf16 v[188:191], v[20:23], a[60:63], v[188:191]
    buffer_load_dwordx4 a[136:139], v2, s[12:15], s56 offen offset:1024 sc1
    v_mfma_f32_16x16x32_bf16 v[192:195], v[24:27], a[56:59], v[192:195]
    ds_read_b128 v[144:147], v242 offset:9216
    v_mfma_f32_16x16x32_bf16 v[196:199], v[24:27], a[60:63], v[196:199]
    s_waitcnt lgkmcnt(4)
    v_mfma_f32_16x16x32_bf16 v[200:203], v[28:31], a[56:59], v[200:203]
    ds_read_b128 v[148:151], v242 offset:10240
    v_mfma_f32_16x16x32_bf16 v[204:207], v[28:31], a[60:63], v[204:207]
    buffer_load_dwordx4 a[140:143], v254, s[12:15], s56 offen offset:1024 sc1
    s_waitcnt vmcnt(32)
    v_mfma_f32_16x16x32_bf16 v[168:171], v[32:35], a[64:67], v[168:171]
    ds_read_b128 v[152:155], v242 offset:11264
    v_mfma_f32_16x16x32_bf16 v[172:175], v[32:35], a[68:71], v[172:175]
    buffer_load_dwordx4 v2, s[12:15], s48 offen offset:1024 sc1 lds
    v_mfma_f32_16x16x32_bf16 v[176:179], v[36:39], a[64:67], v[176:179]
    ds_read_b128 v[16:19], v242 offset:12288
    v_mfma_f32_16x16x32_bf16 v[180:183], v[36:39], a[68:71], v[180:183]
    s_waitcnt lgkmcnt(4)
    v_mfma_f32_16x16x32_bf16 v[184:187], v[248:251], a[64:67], v[184:187]
    ds_read_b128 v[20:23], v242 offset:13312
    v_mfma_f32_16x16x32_bf16 v[188:191], v[248:251], a[68:71], v[188:191]
    buffer_load_dwordx4 v2, s[12:15], s48 offen offset:2048 sc1 lds
    v_mfma_f32_16x16x32_bf16 v[192:195], v[136:139], a[64:67], v[192:195]
    ds_read_b128 v[24:27], v242 offset:14336
    v_mfma_f32_16x16x32_bf16 v[196:199], v[136:139], a[68:71], v[196:199]
    v_mfma_f32_16x16x32_bf16 v[200:203], v[140:143], a[64:67], v[200:203]
    ds_read_b128 v[28:31], v242 offset:15360
    v_mfma_f32_16x16x32_bf16 v[204:207], v[140:143], a[68:71], v[204:207]
    buffer_load_dwordx4 a[144:147], v2, s[12:15], s56 offen offset:2048 sc1
    s_waitcnt vmcnt(33) lgkmcnt(4)
    v_mfma_f32_16x16x32_bf16 v[168:171], v[144:147], a[72:75], v[168:171]
    ds_read_b128 v[32:35], v242 offset:16384
    v_mfma_f32_16x16x32_bf16 v[172:175], v[144:147], a[76:79], v[172:175]
    v_mfma_f32_16x16x32_bf16 v[176:179], v[148:151], a[72:75], v[176:179]
    ds_read_b128 v[36:39], v242 offset:17408
    v_mfma_f32_16x16x32_bf16 v[180:183], v[148:151], a[76:79], v[180:183]
    buffer_load_dwordx4 a[148:151], v254, s[12:15], s56 offen offset:2048 sc1
    v_mfma_f32_16x16x32_bf16 v[184:187], v[152:155], a[72:75], v[184:187]
    ds_read_b128 v[248:251], v242 offset:18432
    v_mfma_f32_16x16x32_bf16 v[188:191], v[152:155], a[76:79], v[188:191]
    s_waitcnt lgkmcnt(4)
    v_mfma_f32_16x16x32_bf16 v[192:195], v[16:19], a[72:75], v[192:195]
    ds_read_b128 v[136:139], v242 offset:19456
    v_mfma_f32_16x16x32_bf16 v[196:199], v[16:19], a[76:79], v[196:199]
    buffer_load_dwordx4 v2, s[12:15], s48 offen offset:3072 sc1 lds
    v_mfma_f32_16x16x32_bf16 v[200:203], v[20:23], a[72:75], v[200:203]
    ds_read_b128 v[140:143], v242 offset:20480
    s_add_u32 m0, s55, 4096
    v_mfma_f32_16x16x32_bf16 v[204:207], v[20:23], a[76:79], v[204:207]
    buffer_load_dwordx4 v3, s[12:15], s48 offen offset:0 sc1 lds
    s_waitcnt vmcnt(34)
    v_mfma_f32_16x16x32_bf16 v[168:171], v[24:27], a[80:83], v[168:171]
    ds_read_b128 v[144:147], v242 offset:21504
    v_mfma_f32_16x16x32_bf16 v[172:175], v[24:27], a[84:87], v[172:175]
    s_waitcnt vmcnt(17)
    v_cmp_gt_u32 vcc, 7, v245
    s_nop 4
    s_cbranch_vccz Lfok51
    s_mov_b32 s67, 0x40000
Lflp52:
    s_sub_u32 s67, s67, 1
    s_cbranch_scc1 Lfok51
    buffer_load_dword v245, v244, s[12:15], 0 offen sc1
    s_waitcnt vmcnt(0)
    v_cmp_gt_u32 vcc, 7, v245
    s_nop 4
    s_cbranch_vccnz Lflp52
Lfok51:
    s_waitcnt lgkmcnt(4)
    v_mfma_f32_16x16x32_bf16 v[176:179], v[28:31], a[80:83], v[176:179]
    ds_read_b128 v[148:151], v242 offset:22528
    v_mfma_f32_16x16x32_bf16 v[180:183], v[28:31], a[84:87], v[180:183]
    buffer_load_dwordx4 v3, s[12:15], s48 offen offset:1024 sc1 lds
    v_mfma_f32_16x16x32_bf16 v[184:187], v[32:35], a[80:83], v[184:187]
    ds_read_b128 v[152:155], v242 offset:23552
    v_mfma_f32_16x16x32_bf16 v[188:191], v[32:35], a[84:87], v[188:191]
    v_mfma_f32_16x16x32_bf16 v[192:195], v[36:39], a[80:83], v[192:195]
    ds_read_b128 v[16:19], v242 offset:24576
    v_mfma_f32_16x16x32_bf16 v[196:199], v[36:39], a[84:87], v[196:199]
    buffer_load_dwordx4 a[152:155], v2, s[12:15], s56 offen offset:3072 sc1
    s_waitcnt lgkmcnt(4)
    v_mfma_f32_16x16x32_bf16 v[200:203], v[248:251], a[80:83], v[200:203]
    ds_read_b128 v[20:23], v242 offset:25600
    v_mfma_f32_16x16x32_bf16 v[204:207], v[248:251], a[84:87], v[204:207]
    s_waitcnt vmcnt(33)
    v_mfma_f32_16x16x32_bf16 v[168:171], v[136:139], a[88:91], v[168:171]
    ds_read_b128 v[24:27], v242 offset:26624
    v_mfma_f32_16x16x32_bf16 v[172:175], v[136:139], a[92:95], v[172:175]
    buffer_load_dwordx4 a[156:159], v254, s[12:15], s56 offen offset:3072 sc1
    s_add_u32 s56, s56, 4096
    v_mfma_f32_16x16x32_bf16 v[176:179], v[140:143], a[88:91], v[176:179]
    ds_read_b128 v[28:31], v242 offset:27648
    v_mfma_f32_16x16x32_bf16 v[180:183], v[140:143], a[92:95], v[180:183]
    s_waitcnt lgkmcnt(4)
    v_mfma_f32_16x16x32_bf16 v[184:187], v[144:147], a[88:91], v[184:187]
    ds_read_b128 v[32:35], v242 offset:28672
    v_mfma_f32_16x16x32_bf16 v[188:191], v[144:147], a[92:95], v[188:191]
    buffer_load_dwordx4 v3, s[12:15], s48 offen offset:2048 sc1 lds
    v_mfma_f32_16x16x32_bf16 v[192:195], v[148:151], a[88:91], v[192:195]
    ds_read_b128 v[36:39], v242 offset:29696
    v_mfma_f32_16x16x32_bf16 v[196:199], v[148:151], a[92:95], v[196:199]
    buffer_load_dwordx4 v3, s[12:15], s48 offen offset:3072 sc1 lds
    v_mfma_f32_16x16x32_bf16 v[200:203], v[152:155], a[88:91], v[200:203]
    ds_read_b128 v[248:251], v242 offset:30720
    v_mfma_f32_16x16x32_bf16 v[204:207], v[152:155], a[92:95], v[204:207]
    s_waitcnt vmcnt(27) lgkmcnt(4)
    v_mfma_f32_16x16x32_bf16 v[168:171], v[16:19], a[96:99], v[168:171]
    ds_read_b128 v[136:139], v242 offset:31744
    v_mfma_f32_16x16x32_bf16 v[172:175], v[16:19], a[100:103], v[172:175]
    buffer_load_dwordx4 a[160:163], v2, s[12:15], s56 offen offset:0 sc1
    v_mfma_f32_16x16x32_bf16 v[176:179], v[20:23], a[96:99], v[176:179]
    ds_read_b128 v[140:143], v242 offset:32768
    v_mfma_f32_16x16x32_bf16 v[180:183], v[20:23], a[100:103], v[180:183]
    v_mfma_f32_16x16x32_bf16 v[184:187], v[24:27], a[96:99], v[184:187]
    ds_read_b128 v[144:147], v242 offset:33792
    v_mfma_f32_16x16x32_bf16 v[188:191], v[24:27], a[100:103], v[188:191]
    buffer_load_dwordx4 a[164:167], v254, s[12:15], s56 offen offset:0 sc1
    s_waitcnt lgkmcnt(4)
    v_mfma_f32_16x16x32_bf16 v[192:195], v[28:31], a[96:99], v[192:195]
    ds_read_b128 v[148:151], v242 offset:34816
    v_mfma_f32_16x16x32_bf16 v[196:199], v[28:31], a[100:103], v[196:199]
    v_mfma_f32_16x16x32_bf16 v[200:203], v[32:35], a[96:99], v[200:203]
    ds_read_b128 v[152:155], v242 offset:35840
    s_add_u32 m0, s55, 8192
    v_mfma_f32_16x16x32_bf16 v[204:207], v[32:35], a[100:103], v[204:207]
    buffer_load_dwordx4 v4, s[12:15], s48 offen offset:0 sc1 lds
    s_add_u32 s48, s48, 36864
    s_waitcnt vmcnt(24)
    v_mfma_f32_16x16x32_bf16 v[168:171], v[36:39], a[104:107], v[168:171]
    s_waitcnt vmcnt(23)
    s_barrier
    s_cmp_lg_u32 s3, 0
    s_cbranch_scc1 Lnp53
    v_mov_b32 v255, 9
    s_mov_b64 exec, 1
    buffer_store_dword v255, v246, s[12:15], s35 offen sc1
    s_mov_b64 exec, -1
Lnp53:
    ds_read_b128 v[16:19], v243 offset:0
    v_mfma_f32_16x16x32_bf16 v[172:175], v[36:39], a[108:111], v[172:175]
    s_waitcnt lgkmcnt(4)
    v_mfma_f32_16x16x32_bf16 v[176:179], v[248:251], a[104:107], v[176:179]
    ds_read_b128 v[20:23], v243 offset:1024
    v_mfma_f32_16x16x32_bf16 v[180:183], v[248:251], a[108:111], v[180:183]
    buffer_load_dwordx4 a[168:171], v2, s[12:15], s56 offen offset:1024 sc1
    v_mfma_f32_16x16x32_bf16 v[184:187], v[136:139], a[104:107], v[184:187]
    ds_read_b128 v[24:27], v243 offset:2048
    v_mfma_f32_16x16x32_bf16 v[188:191], v[136:139], a[108:111], v[188:191]
    buffer_load_dwordx4 a[172:175], v254, s[12:15], s56 offen offset:1024 sc1
    v_mfma_f32_16x16x32_bf16 v[192:195], v[140:143], a[104:107], v[192:195]
    ds_read_b128 v[28:31], v243 offset:3072
    v_mfma_f32_16x16x32_bf16 v[196:199], v[140:143], a[108:111], v[196:199]
    s_waitcnt lgkmcnt(4)
    v_mfma_f32_16x16x32_bf16 v[200:203], v[144:147], a[104:107], v[200:203]
    ds_read_b128 v[32:35], v243 offset:4096
    v_mfma_f32_16x16x32_bf16 v[204:207], v[144:147], a[108:111], v[204:207]
    buffer_load_dwordx4 a[176:179], v2, s[12:15], s56 offen offset:2048 sc1
    s_waitcnt vmcnt(24)
    v_mfma_f32_16x16x32_bf16 v[168:171], v[148:151], a[112:115], v[168:171]
    ds_read_b128 v[36:39], v243 offset:5120
    v_mfma_f32_16x16x32_bf16 v[172:175], v[148:151], a[116:119], v[172:175]
    v_mfma_f32_16x16x32_bf16 v[176:179], v[152:155], a[112:115], v[176:179]
    ds_read_b128 v[248:251], v243 offset:6144
    v_mfma_f32_16x16x32_bf16 v[180:183], v[152:155], a[116:119], v[180:183]
    buffer_load_dwordx4 a[180:183], v254, s[12:15], s56 offen offset:2048 sc1
    s_waitcnt lgkmcnt(4)
    v_mfma_f32_16x16x32_bf16 v[184:187], v[16:19], a[112:115], v[184:187]
    ds_read_b128 v[136:139], v243 offset:7168
    v_mfma_f32_16x16x32_bf16 v[188:191], v[16:19], a[116:119], v[188:191]
    v_mfma_f32_16x16x32_bf16 v[192:195], v[20:23], a[112:115], v[192:195]
    ds_read_b128 v[140:143], v243 offset:8192
    v_mfma_f32_16x16x32_bf16 v[196:199], v[20:23], a[116:119], v[196:199]
    buffer_load_dwordx4 a[184:187], v2, s[12:15], s56 offen offset:3072 sc1
    v_mfma_f32_16x16x32_bf16 v[200:203], v[24:27], a[112:115], v[200:203]
    ds_read_b128 v[144:147], v243 offset:9216
    v_mfma_f32_16x16x32_bf16 v[204:207], v[24:27], a[116:119], v[204:207]
    s_waitcnt vmcnt(24) lgkmcnt(4)
    v_mfma_f32_16x16x32_bf16 v[168:171], v[28:31], a[120:123], v[168:171]
    ds_read_b128 v[148:151], v243 offset:10240
    v_mfma_f32_16x16x32_bf16 v[172:175], v[28:31], a[124:127], v[172:175]
    buffer_load_dwordx4 a[188:191], v254, s[12:15], s56 offen offset:3072 sc1
    s_add_u32 s56, s56, 4096
    v_mfma_f32_16x16x32_bf16 v[176:179], v[32:35], a[120:123], v[176:179]
    ds_read_b128 v[152:155], v243 offset:11264
    v_mfma_f32_16x16x32_bf16 v[180:183], v[32:35], a[124:127], v[180:183]
    buffer_load_dwordx4 a[192:195], v2, s[12:15], s56 offen offset:0 sc1
    v_mfma_f32_16x16x32_bf16 v[184:187], v[36:39], a[120:123], v[184:187]
    ds_read_b128 v[16:19], v243 offset:12288
    v_mfma_f32_16x16x32_bf16 v[188:191], v[36:39], a[124:127], v[188:191]
    s_waitcnt lgkmcnt(4)
    v_mfma_f32_16x16x32_bf16 v[192:195], v[248:251], a[120:123], v[192:195]
    ds_read_b128 v[20:23], v243 offset:13312
    v_mfma_f32_16x16x32_bf16 v[196:199], v[248:251], a[124:127], v[196:199]
    buffer_load_dwordx4 a[196:199], v254, s[12:15], s56 offen offset:0 sc1
    v_mfma_f32_16x16x32_bf16 v[200:203], v[136:139], a[120:123], v[200:203]
    ds_read_b128 v[24:27], v243 offset:14336
    v_mfma_f32_16x16x32_bf16 v[204:207], v[136:139], a[124:127], v[204:207]
    s_waitcnt vmcnt(25)
    v_mfma_f32_16x16x32_bf16 v[168:171], v[140:143], a[128:131], v[168:171]
    ds_read_b128 v[28:31], v243 offset:15360
    s_add_u32 m0, s55, 36864
    v_mfma_f32_16x16x32_bf16 v[172:175], v[140:143], a[132:135], v[172:175]
    buffer_load_dwordx4 v2, s[12:15], s48 offen offset:0 sc1 lds
    s_waitcnt lgkmcnt(4)
    v_mfma_f32_16x16x32_bf16 v[176:179], v[144:147], a[128:131], v[176:179]
    ds_read_b128 v[32:35], v243 offset:16384
    v_mfma_f32_16x16x32_bf16 v[180:183], v[144:147], a[132:135], v[180:183]
    v_mfma_f32_16x16x32_bf16 v[184:187], v[148:151], a[128:131], v[184:187]
    ds_read_b128 v[36:39], v243 offset:17408
    v_mfma_f32_16x16x32_bf16 v[188:191], v[148:151], a[132:135], v[188:191]
    buffer_load_dwordx4 v2, s[12:15], s48 offen offset:1024 sc1 lds
    v_mfma_f32_16x16x32_bf16 v[192:195], v[152:155], a[128:131], v[192:195]
    ds_read_b128 v[248:251], v243 offset:18432
    v_mfma_f32_16x16x32_bf16 v[196:199], v[152:155], a[132:135], v[196:199]
    s_waitcnt lgkmcnt(4)
    v_mfma_f32_16x16x32_bf16 v[200:203], v[16:19], a[128:131], v[200:203]
    ds_read_b128 v[136:139], v243 offset:19456
    v_mfma_f32_16x16x32_bf16 v[204:207], v[16:19], a[132:135], v[204:207]
    buffer_load_dwordx4 v2, s[12:15], s48 offen offset:2048 sc1 lds
    s_waitcnt vmcnt(25)
    v_mfma_f32_16x16x32_bf16 v[168:171], v[20:23], a[136:139], v[168:171]
    ds_read_b128 v[140:143], v243 offset:20480
    v_mfma_f32_16x16x32_bf16 v[172:175], v[20:23], a[140:143], v[172:175]
    buffer_load_dwordx4 a[200:203], v2, s[12:15], s56 offen offset:1024 sc1
    v_mfma_f32_16x16x32_bf16 v[176:179], v[24:27], a[136:139], v[176:179]
    ds_read_b128 v[144:147], v243 offset:21504
    v_mfma_f32_16x16x32_bf16 v[180:183], v[24:27], a[140:143], v[180:183]
    s_waitcnt lgkmcnt(4)
    v_mfma_f32_16x16x32_bf16 v[184:187], v[28:31], a[136:139], v[184:187]
    ds_read_b128 v[148:151], v243 offset:22528
    v_mfma_f32_16x16x32_bf16 v[188:191], v[28:31], a[140:143], v[188:191]
    buffer_load_dwordx4 a[204:207], v254, s[12:15], s56 offen offset:1024 sc1
    v_mfma_f32_16x16x32_bf16 v[192:195], v[32:35], a[136:139], v[192:195]
    ds_read_b128 v[152:155], v243 offset:23552
    v_mfma_f32_16x16x32_bf16 v[196:199], v[32:35], a[140:143], v[196:199]
    v_mfma_f32_16x16x32_bf16 v[200:203], v[36:39], a[136:139], v[200:203]
    ds_read_b128 v[16:19], v243 offset:24576
    v_mfma_f32_16x16x32_bf16 v[204:207], v[36:39], a[140:143], v[204:207]
    buffer_load_dwordx4 v2, s[12:15], s48 offen offset:3072 sc1 lds
    s_waitcnt vmcnt(24) lgkmcnt(4)
    v_mfma_f32_16x16x32_bf16 v[168:171], v[248:251], a[144:147], v[168:171]
    ds_read_b128 v[20:23], v243 offset:25600
    v_mfma_f32_16x16x32_bf16 v[172:175], v[248:251], a[148:151], v[172:175]
    v_mfma_f32_16x16x32_bf16 v[176:179], v[136:139], a[144:147], v[176:179]
    ds_read_b128 v[24:27], v243 offset:26624
    s_add_u32 m0, s55, 40960
    v_mfma_f32_16x16x32_bf16 v[180:183], v[136:139], a[148:151], v[180:183]
    buffer_load_dwordx4 v3, s[12:15], s48 offen offset:0 sc1 lds
    v_mfma_f32_16x16x32_bf16 v[184:187], v[140:143], a[144:147], v[184:187]
    ds_read_b128 v[28:31], v243 offset:27648
    v_mfma_f32_16x16x32_bf16 v[188:191], v[140:143], a[148:151], v[188:191]
    s_waitcnt lgkmcnt(4)
    v_mfma_f32_16x16x32_bf16 v[192:195], v[144:147], a[144:147], v[192:195]
    ds_read_b128 v[32:35], v243 offset:28672
    v_mfma_f32_16x16x32_bf16 v[196:199], v[144:147], a[148:151], v[196:199]
    buffer_load_dwordx4 a[208:211], v2, s[12:15], s56 offen offset:2048 sc1
    v_mfma_f32_16x16x32_bf16 v[200:203], v[148:151], a[144:147], v[200:203]
    ds_read_b128 v[36:39], v243 offset:29696
    v_mfma_f32_16x16x32_bf16 v[204:207], v[148:151], a[148:151], v[204:207]
    buffer_load_dwordx4 a[212:215], v254, s[12:15], s56 offen offset:2048 sc1
    s_waitcnt vmcnt(22)
    v_mfma_f32_16x16x32_bf16 v[168:171], v[152:155], a[152:155], v[168:171]
    ds_read_b128 v[248:251], v243 offset:30720
    v_mfma_f32_16x16x32_bf16 v[172:175], v[152:155], a[156:159], v[172:175]
    s_waitcnt lgkmcnt(4)
    v_mfma_f32_16x16x32_bf16 v[176:179], v[16:19], a[152:155], v[176:179]
    ds_read_b128 v[136:139], v243 offset:31744
    v_mfma_f32_16x16x32_bf16 v[180:183], v[16:19], a[156:159], v[180:183]
    buffer_load_dwordx4 v3, s[12:15], s48 offen offset:1024 sc1 lds
    buffer_load_dword v245, v244, s[12:15], 0 offen sc1
    v_mfma_f32_16x16x32_bf16 v[184:187], v[20:23], a[152:155], v[184:187]
    ds_read_b128 v[140:143], v243 offset:32768
    v_mfma_f32_16x16x32_bf16 v[188:191], v[20:23], a[156:159], v[188:191]
    v_mfma_f32_16x16x32_bf16 v[192:195], v[24:27], a[152:155], v[192:195]
    ds_read_b128 v[144:147], v243 offset:33792
    v_mfma_f32_16x16x32_bf16 v[196:199], v[24:27], a[156:159], v[196:199]
    buffer_load_dwordx4 v3, s[12:15], s48 offen offset:2048 sc1 lds
    s_waitcnt lgkmcnt(4)
    v_mfma_f32_16x16x32_bf16 v[200:203], v[28:31], a[152:155], v[200:203]
    ds_read_b128 v[148:151], v243 offset:34816
    v_mfma_f32_16x16x32_bf16 v[204:207], v[28:31], a[156:159], v[204:207]
    s_waitcnt vmcnt(21)
    v_mfma_f32_16x16x32_bf16 v[168:171], v[32:35], a[160:163], v[168:171]
    ds_read_b128 v[152:155], v243 offset:35840
    v_mfma_f32_16x16x32_bf16 v[172:175], v[32:35], a[164:167], v[172:175]
    buffer_load_dwordx4 v3, s[12:15], s48 offen offset:3072 sc1 lds
    v_mfma_f32_16x16x32_bf16 v[176:179], v[36:39], a[160:163], v[176:179]
    s_waitcnt vmcnt(21)
    s_barrier
    ds_read_b128 v[16:19], v2 offset:0
    v_mfma_f32_16x16x32_bf16 v[180:183], v[36:39], a[164:167], v[180:183]
    s_waitcnt lgkmcnt(4)
    v_mfma_f32_16x16x32_bf16 v[184:187], v[248:251], a[160:163], v[184:187]
    ds_read_b128 v[20:23], v2 offset:1024
    v_mfma_f32_16x16x32_bf16 v[188:191], v[248:251], a[164:167], v[188:191]
    buffer_load_dwordx4 a[216:219], v2, s[12:15], s56 offen offset:3072 sc1
    v_mfma_f32_16x16x32_bf16 v[192:195], v[136:139], a[160:163], v[192:195]
    ds_read_b128 v[24:27], v2 offset:2048
    v_mfma_f32_16x16x32_bf16 v[196:199], v[136:139], a[164:167], v[196:199]
    buffer_load_dwordx4 a[220:223], v254, s[12:15], s56 offen offset:3072 sc1
    s_add_u32 s56, s56, 4096
    v_mfma_f32_16x16x32_bf16 v[200:203], v[140:143], a[160:163], v[200:203]
    ds_read_b128 v[28:31], v2 offset:3072
    v_mfma_f32_16x16x32_bf16 v[204:207], v[140:143], a[164:167], v[204:207]
    s_waitcnt vmcnt(21) lgkmcnt(4)
    v_mfma_f32_16x16x32_bf16 v[168:171], v[144:147], a[168:171], v[168:171]
    ds_read_b128 v[32:35], v2 offset:4096
    s_add_u32 m0, s55, 45056
    v_mfma_f32_16x16x32_bf16 v[172:175], v[144:147], a[172:175], v[172:175]
    buffer_load_dwordx4 v4, s[12:15], s48 offen offset:0 sc1 lds
    s_add_u32 s48, s48, 36864
    v_mfma_f32_16x16x32_bf16 v[176:179], v[148:151], a[168:171], v[176:179]
    ds_read_b128 v[36:39], v2 offset:5120
    v_mfma_f32_16x16x32_bf16 v[180:183], v[148:151], a[172:175], v[180:183]
    v_mfma_f32_16x16x32_bf16 v[184:187], v[152:155], a[168:171], v[184:187]
    ds_read_b128 v[248:251], v2 offset:6144
    s_add_u32 m0, s55, 73728
    v_mfma_f32_16x16x32_bf16 v[188:191], v[152:155], a[172:175], v[188:191]
    buffer_load_dwordx4 v2, s[12:15], s48 offen offset:0 sc1 lds
    s_waitcnt lgkmcnt(4)
    v_mfma_f32_16x16x32_bf16 v[192:195], v[16:19], a[168:171], v[192:195]
    ds_read_b128 v[136:139], v2 offset:7168
    v_mfma_f32_16x16x32_bf16 v[196:199], v[16:19], a[172:175], v[196:199]
    v_mfma_f32_16x16x32_bf16 v[200:203], v[20:23], a[168:171], v[200:203]
    ds_read_b128 v[140:143], v2 offset:8192
    v_mfma_f32_16x16x32_bf16 v[204:207], v[20:23], a[172:175], v[204:207]
    buffer_load_dwordx4 v2, s[12:15], s48 offen offset:1024 sc1 lds
    s_waitcnt vmcnt(22)
    v_mfma_f32_16x16x32_bf16 v[168:171], v[24:27], a[176:179], v[168:171]
    ds_read_b128 v[144:147], v2 offset:9216
    v_mfma_f32_16x16x32_bf16 v[172:175], v[24:27], a[180:183], v[172:175]
    s_waitcnt lgkmcnt(4)
    v_mfma_f32_16x16x32_bf16 v[176:179], v[28:31], a[176:179], v[176:179]
    ds_read_b128 v[148:151], v2 offset:10240
    v_mfma_f32_16x16x32_bf16 v[180:183], v[28:31], a[180:183], v[180:183]
    buffer_load_dwordx4 v2, s[12:15], s48 offen offset:2048 sc1 lds
    v_mfma_f32_16x16x32_bf16 v[184:187], v[32:35], a[176:179], v[184:187]
    ds_read_b128 v[152:155], v2 offset:11264
    v_mfma_f32_16x16x32_bf16 v[188:191], v[32:35], a[180:183], v[188:191]
    buffer_load_dwordx4 v2, s[12:15], s48 offen offset:3072 sc1 lds
    v_mfma_f32_16x16x32_bf16 v[192:195], v[36:39], a[176:179], v[192:195]
    ds_read_b128 v[16:19], v2 offset:12288
    v_mfma_f32_16x16x32_bf16 v[196:199], v[36:39], a[180:183], v[196:199]
    s_waitcnt lgkmcnt(4)
    v_mfma_f32_16x16x32_bf16 v[200:203], v[248:251], a[176:179], v[200:203]
    ds_read_b128 v[20:23], v2 offset:13312
    s_add_u32 m0, s55, 77824
    v_mfma_f32_16x16x32_bf16 v[204:207], v[248:251], a[180:183], v[204:207]
    buffer_load_dwordx4 v3, s[12:15], s48 offen offset:0 sc1 lds
    s_waitcnt vmcnt(23)
    v_mfma_f32_16x16x32_bf16 v[168:171], v[136:139], a[184:187], v[168:171]
    ds_read_b128 v[24:27], v2 offset:14336
    v_mfma_f32_16x16x32_bf16 v[172:175], v[136:139], a[188:191], v[172:175]
    v_mfma_f32_16x16x32_bf16 v[176:179], v[140:143], a[184:187], v[176:179]
    ds_read_b128 v[28:31], v2 offset:15360
    v_mfma_f32_16x16x32_bf16 v[180:183], v[140:143], a[188:191], v[180:183]
    buffer_load_dwordx4 v3, s[12:15], s48 offen offset:1024 sc1 lds
    s_waitcnt lgkmcnt(4)
    v_mfma_f32_16x16x32_bf16 v[184:187], v[144:147], a[184:187], v[184:187]
    ds_read_b128 v[32:35], v2 offset:16384
    v_mfma_f32_16x16x32_bf16 v[188:191], v[144:147], a[188:191], v[188:191]
    v_mfma_f32_16x16x32_bf16 v[192:195], v[148:151], a[184:187], v[192:195]
    ds_read_b128 v[36:39], v2 offset:17408
    v_mfma_f32_16x16x32_bf16 v[196:199], v[148:151], a[188:191], v[196:199]
    buffer_load_dwordx4 v3, s[12:15], s48 offen offset:2048 sc1 lds
    s_waitcnt vmcnt(12)
    v_cmp_gt_u32 vcc, 9, v245
    s_nop 4
    s_cbranch_vccz Lfok54
    s_mov_b32 s67, 0x40000
Lflp55:
    s_sub_u32 s67, s67, 1
    s_cbranch_scc1 Lfok54
    buffer_load_dword v245, v244, s[12:15], 0 offen sc1
    s_waitcnt vmcnt(0)
    v_cmp_gt_u32 vcc, 9, v245
    s_nop 4
    s_cbranch_vccnz Lflp55
Lfok54:
    v_mfma_f32_16x16x32_bf16 v[200:203], v[152:155], a[184:187], v[200:203]
    ds_read_b128 v[248:251], v2 offset:18432
    v_mfma_f32_16x16x32_bf16 v[204:207], v[152:155], a[188:191], v[204:207]
    s_waitcnt vmcnt(23) lgkmcnt(4)
    v_mfma_f32_16x16x32_bf16 v[168:171], v[16:19], a[192:195], v[168:171]
    ds_read_b128 v[136:139], v2 offset:19456
    v_mfma_f32_16x16x32_bf16 v[172:175], v[16:19], a[196:199], v[172:175]
    buffer_load_dwordx4 a[224:227], v2, s[12:15], s56 offen offset:0 sc1
    v_mfma_f32_16x16x32_bf16 v[176:179], v[20:23], a[192:195], v[176:179]
    ds_read_b128 v[140:143], v2 offset:20480
    v_mfma_f32_16x16x32_bf16 v[180:183], v[20:23], a[196:199], v[180:183]
    buffer_load_dwordx4 a[228:231], v254, s[12:15], s56 offen offset:0 sc1
    v_mfma_f32_16x16x32_bf16 v[184:187], v[24:27], a[192:195], v[184:187]
    ds_read_b128 v[144:147], v2 offset:21504
    v_mfma_f32_16x16x32_bf16 v[188:191], v[24:27], a[196:199], v[188:191]
    s_waitcnt lgkmcnt(4)
    v_mfma_f32_16x16x32_bf16 v[192:195], v[28:31], a[192:195], v[192:195]
    ds_read_b128 v[148:151], v2 offset:22528
    v_mfma_f32_16x16x32_bf16 v[196:199], v[28:31], a[196:199], v[196:199]
    buffer_load_dwordx4 a[232:235], v2, s[12:15], s56 offen offset:1024 sc1
    v_mfma_f32_16x16x32_bf16 v[200:203], v[32:35], a[192:195], v[200:203]
    ds_read_b128 v[152:155], v2 offset:23552
    v_mfma_f32_16x16x32_bf16 v[204:207], v[32:35], a[196:199], v[204:207]
    s_waitcnt vmcnt(21)
    v_mfma_f32_16x16x32_bf16 v[168:171], v[36:39], a[200:203], v[168:171]
    ds_read_b128 v[16:19], v2 offset:24576
    v_mfma_f32_16x16x32_bf16 v[172:175], v[36:39], a[204:207], v[172:175]
    buffer_load_dwordx4 a[236:239], v254, s[12:15], s56 offen offset:1024 sc1
    s_waitcnt lgkmcnt(4)
    v_mfma_f32_16x16x32_bf16 v[176:179], v[248:251], a[200:203], v[176:179]
    ds_read_b128 v[20:23], v2 offset:25600
    v_mfma_f32_16x16x32_bf16 v[180:183], v[248:251], a[204:207], v[180:183]
    v_mfma_f32_16x16x32_bf16 v[184:187], v[136:139], a[200:203], v[184:187]
    ds_read_b128 v[24:27], v2 offset:26624
    v_mfma_f32_16x16x32_bf16 v[188:191], v[136:139], a[204:207], v[188:191]
    buffer_load_dwordx4 a[240:243], v2, s[12:15], s56 offen offset:2048 sc1
    v_mfma_f32_16x16x32_bf16 v[192:195], v[140:143], a[200:203], v[192:195]
    ds_read_b128 v[28:31], v2 offset:27648
    v_mfma_f32_16x16x32_bf16 v[196:199], v[140:143], a[204:207], v[196:199]
    s_waitcnt lgkmcnt(4)
    v_mfma_f32_16x16x32_bf16 v[200:203], v[144:147], a[200:203], v[200:203]
    ds_read_b128 v[32:35], v2 offset:28672
    v_mfma_f32_16x16x32_bf16 v[204:207], v[144:147], a[204:207], v[204:207]
    buffer_load_dwordx4 a[244:247], v254, s[12:15], s56 offen offset:2048 sc1
    s_waitcnt vmcnt(20)
    v_mfma_f32_16x16x32_bf16 v[168:171], v[148:151], a[208:211], v[168:171]
    ds_read_b128 v[36:39], v2 offset:29696
    v_mfma_f32_16x16x32_bf16 v[172:175], v[148:151], a[212:215], v[172:175]
    buffer_load_dwordx4 a[248:251], v2, s[12:15], s56 offen offset:3072 sc1
    v_mfma_f32_16x16x32_bf16 v[176:179], v[152:155], a[208:211], v[176:179]
    ds_read_b128 v[248:251], v2 offset:30720
    v_mfma_f32_16x16x32_bf16 v[180:183], v[152:155], a[212:215], v[180:183]
    s_waitcnt lgkmcnt(4)
    v_mfma_f32_16x16x32_bf16 v[184:187], v[16:19], a[208:211], v[184:187]
    ds_read_b128 v[136:139], v2 offset:31744
    v_mfma_f32_16x16x32_bf16 v[188:191], v[16:19], a[212:215], v[188:191]
    buffer_load_dwordx4 a[252:255], v254, s[12:15], s56 offen offset:3072 sc1
    s_add_u32 s56, s56, 4096
    v_mfma_f32_16x16x32_bf16 v[192:195], v[20:23], a[208:211], v[192:195]
    ds_read_b128 v[140:143], v2 offset:32768
    v_mfma_f32_16x16x32_bf16 v[196:199], v[20:23], a[212:215], v[196:199]
    v_mfma_f32_16x16x32_bf16 v[200:203], v[24:27], a[208:211], v[200:203]
    ds_read_b128 v[144:147], v2 offset:33792
    v_mfma_f32_16x16x32_bf16 v[204:207], v[24:27], a[212:215], v[204:207]
    buffer_load_dwordx4 v[72:75], v2, s[12:15], s56 offen offset:0 sc1
    s_waitcnt vmcnt(17) lgkmcnt(4)
    v_mfma_f32_16x16x32_bf16 v[168:171], v[28:31], a[216:219], v[168:171]
    ds_read_b128 v[148:151], v2 offset:34816
    v_mfma_f32_16x16x32_bf16 v[172:175], v[28:31], a[220:223], v[172:175]
    v_mfma_f32_16x16x32_bf16 v[176:179], v[32:35], a[216:219], v[176:179]
    ds_read_b128 v[152:155], v2 offset:35840
    v_mfma_f32_16x16x32_bf16 v[180:183], v[32:35], a[220:223], v[180:183]
    buffer_load_dwordx4 v[76:79], v254, s[12:15], s56 offen offset:0 sc1
    v_mfma_f32_16x16x32_bf16 v[184:187], v[36:39], a[216:219], v[184:187]
    s_waitcnt vmcnt(17)
    s_barrier
    ds_read_b128 v[16:19], v241 offset:0
    v_mfma_f32_16x16x32_bf16 v[188:191], v[36:39], a[220:223], v[188:191]
    s_waitcnt lgkmcnt(4)
    v_mfma_f32_16x16x32_bf16 v[192:195], v[248:251], a[216:219], v[192:195]
    ds_read_b128 v[20:23], v241 offset:1024
    v_mfma_f32_16x16x32_bf16 v[196:199], v[248:251], a[220:223], v[196:199]
    buffer_load_dwordx4 v[80:83], v2, s[12:15], s56 offen offset:1024 sc1
    v_mfma_f32_16x16x32_bf16 v[200:203], v[136:139], a[216:219], v[200:203]
    ds_read_b128 v[24:27], v241 offset:2048
    v_mfma_f32_16x16x32_bf16 v[204:207], v[136:139], a[220:223], v[204:207]
    s_waitcnt vmcnt(9)
    v_mfma_f32_16x16x32_bf16 v[168:171], v[140:143], a[224:227], v[168:171]
    ds_read_b128 v[28:31], v241 offset:3072
    v_mfma_f32_16x16x32_bf16 v[172:175], v[140:143], a[228:231], v[172:175]
    buffer_load_dwordx4 v[84:87], v254, s[12:15], s56 offen offset:1024 sc1
    s_waitcnt lgkmcnt(4)
    v_mfma_f32_16x16x32_bf16 v[176:179], v[144:147], a[224:227], v[176:179]
    ds_read_b128 v[32:35], v241 offset:4096
    v_mfma_f32_16x16x32_bf16 v[180:183], v[144:147], a[228:231], v[180:183]
    buffer_load_dwordx4 v[88:91], v2, s[12:15], s56 offen offset:2048 sc1
    v_mfma_f32_16x16x32_bf16 v[184:187], v[148:151], a[224:227], v[184:187]
    ds_read_b128 v[36:39], v241 offset:5120
    v_mfma_f32_16x16x32_bf16 v[188:191], v[148:151], a[228:231], v[188:191]
    v_mfma_f32_16x16x32_bf16 v[192:195], v[152:155], a[224:227], v[192:195]
    ds_read_b128 v[248:251], v241 offset:6144
    v_mfma_f32_16x16x32_bf16 v[196:199], v[152:155], a[228:231], v[196:199]
    buffer_load_dwordx4 v[92:95], v254, s[12:15], s56 offen offset:2048 sc1
    s_waitcnt lgkmcnt(4)
    v_mfma_f32_16x16x32_bf16 v[200:203], v[16:19], a[224:227], v[200:203]
    ds_read_b128 v[136:139], v241 offset:7168
    v_mfma_f32_16x16x32_bf16 v[204:207], v[16:19], a[228:231], v[204:207]
    s_waitcnt vmcnt(10)
    v_mfma_f32_16x16x32_bf16 v[168:171], v[20:23], a[232:235], v[168:171]
    ds_read_b128 v[140:143], v241 offset:8192
    v_mfma_f32_16x16x32_bf16 v[172:175], v[20:23], a[236:239], v[172:175]
    buffer_load_dwordx4 v3, s[12:15], s48 offen offset:3072 sc1 lds
    v_mfma_f32_16x16x32_bf16 v[176:179], v[24:27], a[232:235], v[176:179]
    ds_read_b128 v[144:147], v241 offset:9216
    v_mfma_f32_16x16x32_bf16 v[180:183], v[24:27], a[236:239], v[180:183]
    s_waitcnt lgkmcnt(4)
    v_mfma_f32_16x16x32_bf16 v[184:187], v[28:31], a[232:235], v[184:187]
    ds_read_b128 v[148:151], v241 offset:10240
    s_add_u32 m0, s55, 81920
    v_mfma_f32_16x16x32_bf16 v[188:191], v[28:31], a[236:239], v[188:191]
    buffer_load_dwordx4 v4, s[12:15], s48 offen offset:0 sc1 lds
    s_add_u32 s48, s48, 36864
    v_mfma_f32_16x16x32_bf16 v[192:195], v[32:35], a[232:235], v[192:195]
    ds_read_b128 v[152:155], v241 offset:11264
    v_mfma_f32_16x16x32_bf16 v[196:199], v[32:35], a[236:239], v[196:199]
    v_mfma_f32_16x16x32_bf16 v[200:203], v[36:39], a[232:235], v[200:203]
    ds_read_b128 v[16:19], v241 offset:12288
    v_mfma_f32_16x16x32_bf16 v[204:207], v[36:39], a[236:239], v[204:207]
    buffer_load_dwordx4 v[96:99], v2, s[12:15], s56 offen offset:3072 sc1
    s_waitcnt vmcnt(11) lgkmcnt(4)
    v_mfma_f32_16x16x32_bf16 v[168:171], v[248:251], a[240:243], v[168:171]
    ds_read_b128 v[20:23], v241 offset:13312
    v_mfma_f32_16x16x32_bf16 v[172:175], v[248:251], a[244:247], v[172:175]
    v_mfma_f32_16x16x32_bf16 v[176:179], v[136:139], a[240:243], v[176:179]
    ds_read_b128 v[24:27], v241 offset:14336
    v_mfma_f32_16x16x32_bf16 v[180:183], v[136:139], a[244:247], v[180:183]
    buffer_load_dwordx4 v[100:103], v254, s[12:15], s56 offen offset:3072 sc1
    s_add_u32 s56, s56, 4096
    v_mfma_f32_16x16x32_bf16 v[184:187], v[140:143], a[240:243], v[184:187]
    ds_read_b128 v[28:31], v241 offset:15360
    s_add_u32 m0, s55, 110592
    v_mfma_f32_16x16x32_bf16 v[188:191], v[140:143], a[244:247], v[188:191]
    buffer_load_dwordx4 v2, s[12:15], s48 offen offset:0 sc1 lds
    s_waitcnt lgkmcnt(4)
    v_mfma_f32_16x16x32_bf16 v[192:195], v[144:147], a[240:243], v[192:195]
    ds_read_b128 v[32:35], v241 offset:16384
    v_mfma_f32_16x16x32_bf16 v[196:199], v[144:147], a[244:247], v[196:199]
    v_mfma_f32_16x16x32_bf16 v[200:203], v[148:151], a[240:243], v[200:203]
    ds_read_b128 v[36:39], v241 offset:17408
    v_mfma_f32_16x16x32_bf16 v[204:207], v[148:151], a[244:247], v[204:207]
    buffer_load_dwordx4 v2, s[12:15], s48 offen offset:1024 sc1 lds
    s_waitcnt vmcnt(12)
    v_mfma_f32_16x16x32_bf16 v[168:171], v[152:155], a[248:251], v[168:171]
    ds_read_b128 v[248:251], v241 offset:18432
    v_mfma_f32_16x16x32_bf16 v[172:175], v[152:155], a[252:255], v[172:175]
    s_waitcnt lgkmcnt(4)
    v_mfma_f32_16x16x32_bf16 v[176:179], v[16:19], a[248:251], v[176:179]
    ds_read_b128 v[136:139], v241 offset:19456
    v_mfma_f32_16x16x32_bf16 v[180:183], v[16:19], a[252:255], v[180:183]
    buffer_load_dwordx4 v2, s[12:15], s48 offen offset:2048 sc1 lds
    v_mfma_f32_16x16x32_bf16 v[184:187], v[20:23], a[248:251], v[184:187]
    ds_read_b128 v[140:143], v241 offset:20480
    v_mfma_f32_16x16x32_bf16 v[188:191], v[20:23], a[252:255], v[188:191]
    v_mfma_f32_16x16x32_bf16 v[192:195], v[24:27], a[248:251], v[192:195]
    ds_read_b128 v[144:147], v241 offset:21504
    v_mfma_f32_16x16x32_bf16 v[196:199], v[24:27], a[252:255], v[196:199]
    buffer_load_dwordx4 v2, s[12:15], s48 offen offset:3072 sc1 lds
    s_waitcnt lgkmcnt(4)
    v_mfma_f32_16x16x32_bf16 v[200:203], v[28:31], a[248:251], v[200:203]
    ds_read_b128 v[148:151], v241 offset:22528
    v_mfma_f32_16x16x32_bf16 v[204:207], v[28:31], a[252:255], v[204:207]
    s_waitcnt vmcnt(12)
    v_mfma_f32_16x16x32_bf16 v[168:171], v[32:35], v[72:75], v[168:171]
    ds_read_b128 v[152:155], v241 offset:23552
    s_add_u32 m0, s55, 114688
    v_mfma_f32_16x16x32_bf16 v[172:175], v[32:35], v[76:79], v[172:175]
    buffer_load_dwordx4 v3, s[12:15], s48 offen offset:0 sc1 lds
    v_mfma_f32_16x16x32_bf16 v[176:179], v[36:39], v[72:75], v[176:179]
    ds_read_b128 v[16:19], v241 offset:24576
    v_mfma_f32_16x16x32_bf16 v[180:183], v[36:39], v[76:79], v[180:183]
    s_waitcnt lgkmcnt(4)
    v_mfma_f32_16x16x32_bf16 v[184:187], v[248:251], v[72:75], v[184:187]
    ds_read_b128 v[20:23], v241 offset:25600
    v_mfma_f32_16x16x32_bf16 v[188:191], v[248:251], v[76:79], v[188:191]
    buffer_load_dwordx4 v3, s[12:15], s48 offen offset:1024 sc1 lds
    v_mfma_f32_16x16x32_bf16 v[192:195], v[136:139], v[72:75], v[192:195]
    ds_read_b128 v[24:27], v241 offset:26624
    v_mfma_f32_16x16x32_bf16 v[196:199], v[136:139], v[76:79], v[196:199]
    buffer_load_dwordx4 v3, s[12:15], s48 offen offset:2048 sc1 lds
    v_mfma_f32_16x16x32_bf16 v[200:203], v[140:143], v[72:75], v[200:203]
    ds_read_b128 v[28:31], v241 offset:27648
    v_mfma_f32_16x16x32_bf16 v[204:207], v[140:143], v[76:79], v[204:207]
    s_waitcnt vmcnt(13) lgkmcnt(4)
    v_mfma_f32_16x16x32_bf16 v[168:171], v[144:147], v[80:83], v[168:171]
    ds_read_b128 v[32:35], v241 offset:28672
    v_mfma_f32_16x16x32_bf16 v[172:175], v[144:147], v[84:87], v[172:175]
    buffer_load_dwordx4 v3, s[12:15], s48 offen offset:3072 sc1 lds
    v_mfma_f32_16x16x32_bf16 v[176:179], v[148:151], v[80:83], v[176:179]
    ds_read_b128 v[36:39], v241 offset:29696
    v_mfma_f32_16x16x32_bf16 v[180:183], v[148:151], v[84:87], v[180:183]
    v_mfma_f32_16x16x32_bf16 v[184:187], v[152:155], v[80:83], v[184:187]
    ds_read_b128 v[248:251], v241 offset:30720
    s_add_u32 m0, s55, 118784
    v_mfma_f32_16x16x32_bf16 v[188:191], v[152:155], v[84:87], v[188:191]
    buffer_load_dwordx4 v4, s[12:15], s48 offen offset:0 sc1 lds
    s_add_u32 s48, s48, 36864
    s_waitcnt lgkmcnt(4)
    v_mfma_f32_16x16x32_bf16 v[192:195], v[16:19], v[80:83], v[192:195]
    ds_read_b128 v[136:139], v241 offset:31744
    v_mfma_f32_16x16x32_bf16 v[196:199], v[16:19], v[84:87], v[196:199]
    v_mfma_f32_16x16x32_bf16 v[200:203], v[20:23], v[80:83], v[200:203]
    ds_read_b128 v[140:143], v241 offset:32768
    v_mfma_f32_16x16x32_bf16 v[204:207], v[20:23], v[84:87], v[204:207]
    buffer_load_dwordx2 v[104:105], v240, s[12:15], s64 offen offset:0 sc1
    s_waitcnt vmcnt(14)
    v_mfma_f32_16x16x32_bf16 v[168:171], v[24:27], v[88:91], v[168:171]
    ds_read_b128 v[144:147], v241 offset:33792
    v_mfma_f32_16x16x32_bf16 v[172:175], v[24:27], v[92:95], v[172:175]
    s_waitcnt lgkmcnt(4)
    v_mfma_f32_16x16x32_bf16 v[176:179], v[28:31], v[88:91], v[176:179]
    ds_read_b128 v[148:151], v241 offset:34816
    v_mfma_f32_16x16x32_bf16 v[180:183], v[28:31], v[92:95], v[180:183]
    buffer_load_dwordx2 v[108:109], v240, s[12:15], s64 offen offset:512 sc1
    v_mfma_f32_16x16x32_bf16 v[184:187], v[32:35], v[88:91], v[184:187]
    ds_read_b128 v[152:155], v241 offset:35840
    v_mfma_f32_16x16x32_bf16 v[188:191], v[32:35], v[92:95], v[188:191]
    v_mfma_f32_16x16x32_bf16 v[192:195], v[36:39], v[88:91], v[192:195]
    s_waitcnt vmcnt(13)
    s_barrier
    ds_read_b128 v[16:19], v242 offset:0
    v_mfma_f32_16x16x32_bf16 v[196:199], v[36:39], v[92:95], v[196:199]
    buffer_load_dwordx2 v[112:113], v240, s[12:15], s57 offen sc1
    s_waitcnt lgkmcnt(4)
    v_mfma_f32_16x16x32_bf16 v[200:203], v[248:251], v[88:91], v[200:203]
    ds_read_b128 v[20:23], v242 offset:1024
    s_add_u32 m0, s55, 0
    v_mfma_f32_16x16x32_bf16 v[204:207], v[248:251], v[92:95], v[204:207]
    buffer_load_dwordx4 v2, s[12:15], s48 offen offset:0 sc1 lds
    s_waitcnt vmcnt(13)
    v_mfma_f32_16x16x32_bf16 v[168:171], v[136:139], v[96:99], v[168:171]
    ds_read_b128 v[24:27], v242 offset:2048
    v_mfma_f32_16x16x32_bf16 v[172:175], v[136:139], v[100:103], v[172:175]
    v_mfma_f32_16x16x32_bf16 v[176:179], v[140:143], v[96:99], v[176:179]
    ds_read_b128 v[28:31], v242 offset:3072
    v_mfma_f32_16x16x32_bf16 v[180:183], v[140:143], v[100:103], v[180:183]
    buffer_load_dwordx4 v2, s[12:15], s48 offen offset:1024 sc1 lds
    s_waitcnt lgkmcnt(4)
    v_mfma_f32_16x16x32_bf16 v[184:187], v[144:147], v[96:99], v[184:187]
    ds_read_b128 v[32:35], v242 offset:4096
    v_mfma_f32_16x16x32_bf16 v[188:191], v[144:147], v[100:103], v[188:191]
    v_mfma_f32_16x16x32_bf16 v[192:195], v[148:151], v[96:99], v[192:195]
    ds_read_b128 v[36:39], v242 offset:5120
    v_mfma_f32_16x16x32_bf16 v[196:199], v[148:151], v[100:103], v[196:199]
    buffer_load_dwordx4 v2, s[12:15], s48 offen offset:2048 sc1 lds
    v_mfma_f32_16x16x32_bf16 v[200:203], v[152:155], v[96:99], v[200:203]
    ds_read_b128 v[248:251], v242 offset:6144
    v_mfma_f32_16x16x32_bf16 v[204:207], v[152:155], v[100:103], v[204:207]
    s_waitcnt lgkmcnt(4)
    v_mfma_f32_16x16x32_bf16 v[208:211], v[16:19], a[0:3], 0
    ds_read_b128 v[136:139], v242 offset:7168
    v_mfma_f32_16x16x32_bf16 v[212:215], v[16:19], a[4:7], 0
    buffer_load_dwordx4 v2, s[12:15], s48 offen offset:3072 sc1 lds
    v_mfma_f32_16x16x32_bf16 v[216:219], v[20:23], a[0:3], 0
    ds_read_b128 v[140:143], v242 offset:8192
    v_mfma_f32_16x16x32_bf16 v[220:223], v[20:23], a[4:7], 0
    v_mfma_f32_16x16x32_bf16 v[208:211], v[24:27], a[8:11], v[208:211]
    ds_read_b128 v[144:147], v242 offset:9216
    s_add_u32 m0, s55, 4096
    v_mfma_f32_16x16x32_bf16 v[212:215], v[24:27], a[12:15], v[212:215]
    buffer_load_dwordx4 v3, s[12:15], s48 offen offset:0 sc1 lds
    s_waitcnt lgkmcnt(4)
    v_mfma_f32_16x16x32_bf16 v[216:219], v[28:31], a[8:11], v[216:219]
    ds_read_b128 v[148:151], v242 offset:10240
    v_mfma_f32_16x16x32_bf16 v[220:223], v[28:31], a[12:15], v[220:223]
    v_cvt_pk_bf16_f32 v40, v168, v169
    v_cvt_pk_bf16_f32 v41, v170, v171
    v_mfma_f32_16x16x32_bf16 v[208:211], v[32:35], a[16:19], v[208:211]
    ds_read_b128 v[152:155], v242 offset:11264
    v_mfma_f32_16x16x32_bf16 v[212:215], v[32:35], a[20:23], v[212:215]
    buffer_load_dwordx4 v3, s[12:15], s48 offen offset:1024 sc1 lds
    v_mfma_f32_16x16x32_bf16 v[216:219], v[36:39], a[16:19], v[216:219]
    ds_read_b128 v[16:19], v242 offset:12288
    v_mfma_f32_16x16x32_bf16 v[220:223], v[36:39], a[20:23], v[220:223]
    buffer_load_dwordx4 v3, s[12:15], s48 offen offset:2048 sc1 lds
    s_waitcnt lgkmcnt(4)
    v_mfma_f32_16x16x32_bf16 v[208:211], v[248:251], a[24:27], v[208:211]
    ds_read_b128 v[20:23], v242 offset:13312
    v_mfma_f32_16x16x32_bf16 v[212:215], v[248:251], a[28:31], v[212:215]
    v_cvt_pk_bf16_f32 v42, v172, v173
    v_cvt_pk_bf16_f32 v43, v174, v175
    v_mfma_f32_16x16x32_bf16 v[216:219], v[136:139], a[24:27], v[216:219]
    ds_read_b128 v[24:27], v242 offset:14336
    v_mfma_f32_16x16x32_bf16 v[220:223], v[136:139], a[28:31], v[220:223]
    buffer_load_dwordx4 v3, s[12:15], s48 offen offset:3072 sc1 lds
    v_mfma_f32_16x16x32_bf16 v[208:211], v[140:143], a[32:35], v[208:211]
    ds_read_b128 v[28:31], v242 offset:15360
    v_mfma_f32_16x16x32_bf16 v[212:215], v[140:143], a[36:39], v[212:215]
    v_min_u32 v40, -2, v40
    s_waitcnt lgkmcnt(4)
    v_mfma_f32_16x16x32_bf16 v[216:219], v[144:147], a[32:35], v[216:219]
    ds_read_b128 v[32:35], v242 offset:16384
    s_add_u32 m0, s55, 8192
    v_mfma_f32_16x16x32_bf16 v[220:223], v[144:147], a[36:39], v[220:223]
    buffer_load_dwordx4 v4, s[12:15], s48 offen offset:0 sc1 lds
    s_add_u32 s48, s48, 36864
    v_mfma_f32_16x16x32_bf16 v[208:211], v[148:151], a[40:43], v[208:211]
    ds_read_b128 v[36:39], v242 offset:17408
    v_mfma_f32_16x16x32_bf16 v[212:215], v[148:151], a[44:47], v[212:215]
    v_min_u32 v41, -2, v41
    v_min_u32 v42, -2, v42
    v_mfma_f32_16x16x32_bf16 v[216:219], v[152:155], a[40:43], v[216:219]
    ds_read_b128 v[248:251], v242 offset:18432
    v_mfma_f32_16x16x32_bf16 v[220:223], v[152:155], a[44:47], v[220:223]
    v_min_u32 v43, -2, v43
    s_waitcnt lgkmcnt(4)
    v_mfma_f32_16x16x32_bf16 v[208:211], v[16:19], a[48:51], v[208:211]
    ds_read_b128 v[136:139], v242 offset:19456
    v_mfma_f32_16x16x32_bf16 v[212:215], v[16:19], a[52:55], v[212:215]
    buffer_store_dwordx4 v[40:43], v2, s[12:15], s40 offen offset:0 sc1
    v_mfma_f32_16x16x32_bf16 v[216:219], v[20:23], a[48:51], v[216:219]
    ds_read_b128 v[140:143], v242 offset:20480
    v_mfma_f32_16x16x32_bf16 v[220:223], v[20:23], a[52:55], v[220:223]
    v_cvt_pk_bf16_f32 v44, v176, v177
    v_cvt_pk_bf16_f32 v45, v178, v179
    v_mfma_f32_16x16x32_bf16 v[208:211], v[24:27], a[56:59], v[208:211]
    ds_read_b128 v[144:147], v242 offset:21504
    v_mfma_f32_16x16x32_bf16 v[212:215], v[24:27], a[60:63], v[212:215]
    v_cvt_pk_bf16_f32 v46, v180, v181
    s_waitcnt lgkmcnt(4)
    v_mfma_f32_16x16x32_bf16 v[216:219], v[28:31], a[56:59], v[216:219]
    ds_read_b128 v[148:151], v242 offset:22528
    v_mfma_f32_16x16x32_bf16 v[220:223], v[28:31], a[60:63], v[220:223]
    v_cvt_pk_bf16_f32 v47, v182, v183
    v_min_u32 v44, -2, v44
    v_mfma_f32_16x16x32_bf16 v[208:211], v[32:35], a[64:67], v[208:211]
    ds_read_b128 v[152:155], v242 offset:23552
    v_mfma_f32_16x16x32_bf16 v[212:215], v[32:35], a[68:71], v[212:215]
    v_min_u32 v45, -2, v45
    v_min_u32 v46, -2, v46
    v_mfma_f32_16x16x32_bf16 v[216:219], v[36:39], a[64:67], v[216:219]
    ds_read_b128 v[16:19], v242 offset:24576
    v_mfma_f32_16x16x32_bf16 v[220:223], v[36:39], a[68:71], v[220:223]
    v_min_u32 v47, -2, v47
    s_waitcnt lgkmcnt(4)
    v_mfma_f32_16x16x32_bf16 v[208:211], v[248:251], a[72:75], v[208:211]
    ds_read_b128 v[20:23], v242 offset:25600
    v_mfma_f32_16x16x32_bf16 v[212:215], v[248:251], a[76:79], v[212:215]
    buffer_store_dwordx4 v[44:47], v2, s[12:15], s40 offen offset:1024 sc1
    v_mfma_f32_16x16x32_bf16 v[216:219], v[136:139], a[72:75], v[216:219]
    ds_read_b128 v[24:27], v242 offset:26624
    v_mfma_f32_16x16x32_bf16 v[220:223], v[136:139], a[76:79], v[220:223]
    v_cvt_pk_bf16_f32 v48, v184, v185
    v_cvt_pk_bf16_f32 v49, v186, v187
    v_mfma_f32_16x16x32_bf16 v[208:211], v[140:143], a[80:83], v[208:211]
    ds_read_b128 v[28:31], v242 offset:27648
    v_mfma_f32_16x16x32_bf16 v[212:215], v[140:143], a[84:87], v[212:215]
    v_cvt_pk_bf16_f32 v50, v188, v189
    s_waitcnt lgkmcnt(4)
    v_mfma_f32_16x16x32_bf16 v[216:219], v[144:147], a[80:83], v[216:219]
    ds_read_b128 v[32:35], v242 offset:28672
    v_mfma_f32_16x16x32_bf16 v[220:223], v[144:147], a[84:87], v[220:223]
    v_cvt_pk_bf16_f32 v51, v190, v191
    v_min_u32 v48, -2, v48
    v_mfma_f32_16x16x32_bf16 v[208:211], v[148:151], a[88:91], v[208:211]
    ds_read_b128 v[36:39], v242 offset:29696
    v_mfma_f32_16x16x32_bf16 v[212:215], v[148:151], a[92:95], v[212:215]
    v_min_u32 v49, -2, v49
    v_min_u32 v50, -2, v50
    v_mfma_f32_16x16x32_bf16 v[216:219], v[152:155], a[88:91], v[216:219]
    ds_read_b128 v[248:251], v242 offset:30720
    v_mfma_f32_16x16x32_bf16 v[220:223], v[152:155], a[92:95], v[220:223]
    v_min_u32 v51, -2, v51
    s_waitcnt lgkmcnt(4)
    v_mfma_f32_16x16x32_bf16 v[208:211], v[16:19], a[96:99], v[208:211]
    ds_read_b128 v[136:139], v242 offset:31744
    v_mfma_f32_16x16x32_bf16 v[212:215], v[16:19], a[100:103], v[212:215]
    buffer_store_dwordx4 v[48:51], v2, s[12:15], s41 offen offset:0 sc1
    v_mfma_f32_16x16x32_bf16 v[216:219], v[20:23], a[96:99], v[216:219]
    ds_read_b128 v[140:143], v242 offset:32768
    v_mfma_f32_16x16x32_bf16 v[220:223], v[20:23], a[100:103], v[220:223]
    v_cvt_pk_bf16_f32 v52, v192, v193
    v_cvt_pk_bf16_f32 v53, v194, v195
    v_mfma_f32_16x16x32_bf16 v[208:211], v[24:27], a[104:107], v[208:211]
    ds_read_b128 v[144:147], v242 offset:33792
    v_mfma_f32_16x16x32_bf16 v[212:215], v[24:27], a[108:111], v[212:215]
    v_cvt_pk_bf16_f32 v54, v196, v197
    s_waitcnt lgkmcnt(4)
    v_mfma_f32_16x16x32_bf16 v[216:219], v[28:31], a[104:107], v[216:219]
    ds_read_b128 v[148:151], v242 offset:34816
    v_mfma_f32_16x16x32_bf16 v[220:223], v[28:31], a[108:111], v[220:223]
    v_cvt_pk_bf16_f32 v55, v198, v199
    v_min_u32 v52, -2, v52
    v_mfma_f32_16x16x32_bf16 v[208:211], v[32:35], a[112:115], v[208:211]
    ds_read_b128 v[152:155], v242 offset:35840
    v_mfma_f32_16x16x32_bf16 v[212:215], v[32:35], a[116:119], v[212:215]
    v_min_u32 v53, -2, v53
    v_min_u32 v54, -2, v54
    v_mfma_f32_16x16x32_bf16 v[216:219], v[36:39], a[112:115], v[216:219]
    s_waitcnt vmcnt(15)
    s_barrier
    ds_read_b128 v[16:19], v243 offset:0
    v_mfma_f32_16x16x32_bf16 v[220:223], v[36:39], a[116:119], v[220:223]
    v_min_u32 v55, -2, v55
    s_waitcnt lgkmcnt(4)
    v_mfma_f32_16x16x32_bf16 v[208:211], v[248:251], a[120:123], v[208:211]
    ds_read_b128 v[20:23], v243 offset:1024
    s_add_u32 m0, s55, 36864
    v_mfma_f32_16x16x32_bf16 v[212:215], v[248:251], a[124:127], v[212:215]
    buffer_load_dwordx4 v2, s[12:15], s48 offen offset:0 sc1 lds
    v_mfma_f32_16x16x32_bf16 v[216:219], v[136:139], a[120:123], v[216:219]
    ds_read_b128 v[24:27], v243 offset:2048
    v_mfma_f32_16x16x32_bf16 v[220:223], v[136:139], a[124:127], v[220:223]
    buffer_load_dwordx4 v2, s[12:15], s48 offen offset:1024 sc1 lds
    v_mfma_f32_16x16x32_bf16 v[208:211], v[140:143], a[128:131], v[208:211]
    ds_read_b128 v[28:31], v243 offset:3072
    v_mfma_f32_16x16x32_bf16 v[212:215], v[140:143], a[132:135], v[212:215]
    s_waitcnt lgkmcnt(4)
    v_mfma_f32_16x16x32_bf16 v[216:219], v[144:147], a[128:131], v[216:219]
    ds_read_b128 v[32:35], v243 offset:4096
    v_mfma_f32_16x16x32_bf16 v[220:223], v[144:147], a[132:135], v[220:223]
    buffer_load_dwordx4 v2, s[12:15], s48 offen offset:2048 sc1 lds
    v_mfma_f32_16x16x32_bf16 v[208:211], v[148:151], a[136:139], v[208:211]
    ds_read_b128 v[36:39], v243 offset:5120
    v_mfma_f32_16x16x32_bf16 v[212:215], v[148:151], a[140:143], v[212:215]
    buffer_store_dwordx4 v[52:55], v2, s[12:15], s41 offen offset:1024 sc1
    v_mfma_f32_16x16x32_bf16 v[216:219], v[152:155], a[136:139], v[216:219]
    ds_read_b128 v[248:251], v243 offset:6144
    v_mfma_f32_16x16x32_bf16 v[220:223], v[152:155], a[140:143], v[220:223]
    buffer_load_dwordx4 v2, s[12:15], s48 offen offset:3072 sc1 lds
    s_waitcnt lgkmcnt(4)
    v_mfma_f32_16x16x32_bf16 v[208:211], v[16:19], a[144:147], v[208:211]
    ds_read_b128 v[136:139], v243 offset:7168
    v_mfma_f32_16x16x32_bf16 v[212:215], v[16:19], a[148:151], v[212:215]
    v_cvt_pk_bf16_f32 v64, v200, v201
    v_cvt_pk_bf16_f32 v65, v202, v203
    v_mfma_f32_16x16x32_bf16 v[216:219], v[20:23], a[144:147], v[216:219]
    ds_read_b128 v[140:143], v243 offset:8192
    s_add_u32 m0, s55, 40960
    v_mfma_f32_16x16x32_bf16 v[220:223], v[20:23], a[148:151], v[220:223]
    buffer_load_dwordx4 v3, s[12:15], s48 offen offset:0 sc1 lds
    v_mfma_f32_16x16x32_bf16 v[208:211], v[24:27], a[152:155], v[208:211]
    ds_read_b128 v[144:147], v243 offset:9216
    v_mfma_f32_16x16x32_bf16 v[212:215], v[24:27], a[156:159], v[212:215]
    v_cvt_pk_bf16_f32 v66, v204, v205
    s_waitcnt lgkmcnt(4)
    v_mfma_f32_16x16x32_bf16 v[216:219], v[28:31], a[152:155], v[216:219]
    ds_read_b128 v[148:151], v243 offset:10240
    v_mfma_f32_16x16x32_bf16 v[220:223], v[28:31], a[156:159], v[220:223]
    buffer_load_dwordx4 v3, s[12:15], s48 offen offset:1024 sc1 lds
    v_mfma_f32_16x16x32_bf16 v[208:211], v[32:35], a[160:163], v[208:211]
    ds_read_b128 v[152:155], v243 offset:11264
    v_mfma_f32_16x16x32_bf16 v[212:215], v[32:35], a[164:167], v[212:215]
    v_cvt_pk_bf16_f32 v67, v206, v207
    v_min_u32 v64, -2, v64
    v_mfma_f32_16x16x32_bf16 v[216:219], v[36:39], a[160:163], v[216:219]
    ds_read_b128 v[16:19], v243 offset:12288
    v_mfma_f32_16x16x32_bf16 v[220:223], v[36:39], a[164:167], v[220:223]
    buffer_load_dwordx4 v3, s[12:15], s48 offen offset:2048 sc1 lds
    s_waitcnt lgkmcnt(4)
    v_mfma_f32_16x16x32_bf16 v[208:211], v[248:251], a[168:171], v[208:211]
    ds_read_b128 v[20:23], v243 offset:13312
    v_mfma_f32_16x16x32_bf16 v[212:215], v[248:251], a[172:175], v[212:215]
    buffer_load_dwordx4 v3, s[12:15], s48 offen offset:3072 sc1 lds
    v_mfma_f32_16x16x32_bf16 v[216:219], v[136:139], a[168:171], v[216:219]
    ds_read_b128 v[24:27], v243 offset:14336
    v_mfma_f32_16x16x32_bf16 v[220:223], v[136:139], a[172:175], v[220:223]
    v_min_u32 v65, -2, v65
    v_min_u32 v66, -2, v66
    v_mfma_f32_16x16x32_bf16 v[208:211], v[140:143], a[176:179], v[208:211]
    ds_read_b128 v[28:31], v243 offset:15360
    s_add_u32 m0, s55, 45056
    v_mfma_f32_16x16x32_bf16 v[212:215], v[140:143], a[180:183], v[212:215]
    buffer_load_dwordx4 v4, s[12:15], s48 offen offset:0 sc1 lds
    s_add_u32 s48, s48, 36864
    s_waitcnt lgkmcnt(4)
    v_mfma_f32_16x16x32_bf16 v[216:219], v[144:147], a[176:179], v[216:219]
    ds_read_b128 v[32:35], v243 offset:16384
    v_mfma_f32_16x16x32_bf16 v[220:223], v[144:147], a[180:183], v[220:223]
    v_min_u32 v67, -2, v67
    v_mfma_f32_16x16x32_bf16 v[208:211], v[148:151], a[184:187], v[208:211]
    ds_read_b128 v[36:39], v243 offset:17408
    v_mfma_f32_16x16x32_bf16 v[212:215], v[148:151], a[188:191], v[212:215]
    buffer_store_dwordx4 v[64:67], v2, s[12:15], s43 offen offset:0 sc1
    v_mfma_f32_16x16x32_bf16 v[216:219], v[152:155], a[184:187], v[216:219]
    ds_read_b128 v[248:251], v243 offset:18432
    v_mfma_f32_16x16x32_bf16 v[220:223], v[152:155], a[188:191], v[220:223]
    buffer_load_dword v116, v253, s[12:15], s61 offen offset:0 sc1
    s_waitcnt lgkmcnt(4)
    v_mfma_f32_16x16x32_bf16 v[208:211], v[16:19], a[192:195], v[208:211]
    ds_read_b128 v[136:139], v243 offset:19456
    v_mfma_f32_16x16x32_bf16 v[212:215], v[16:19], a[196:199], v[212:215]
    buffer_load_dwordx2 v[106:107], v6, s[12:15], s64 offen offset:0 sc1
    v_mfma_f32_16x16x32_bf16 v[216:219], v[20:23], a[192:195], v[216:219]
    ds_read_b128 v[140:143], v243 offset:20480
    v_mfma_f32_16x16x32_bf16 v[220:223], v[20:23], a[196:199], v[220:223]
    v_mfma_f32_16x16x32_bf16 v[208:211], v[24:27], a[200:203], v[208:211]
    ds_read_b128 v[144:147], v243 offset:21504
    v_mfma_f32_16x16x32_bf16 v[212:215], v[24:27], a[204:207], v[212:215]
    buffer_load_dwordx2 v[110:111], v6, s[12:15], s64 offen offset:512 sc1
    s_waitcnt lgkmcnt(4)
    v_mfma_f32_16x16x32_bf16 v[216:219], v[28:31], a[200:203], v[216:219]
    ds_read_b128 v[148:151], v243 offset:22528
    v_mfma_f32_16x16x32_bf16 v[220:223], v[28:31], a[204:207], v[220:223]
    v_mfma_f32_16x16x32_bf16 v[208:211], v[32:35], a[208:211], v[208:211]
    ds_read_b128 v[152:155], v243 offset:23552
    v_mfma_f32_16x16x32_bf16 v[212:215], v[32:35], a[212:215], v[212:215]
    buffer_load_dwordx2 v[114:115], v6, s[12:15], s57 offen sc1
    v_mfma_f32_16x16x32_bf16 v[216:219], v[36:39], a[208:211], v[216:219]
    ds_read_b128 v[16:19], v243 offset:24576
    v_mfma_f32_16x16x32_bf16 v[220:223], v[36:39], a[212:215], v[220:223]
    s_waitcnt lgkmcnt(4)
    v_mfma_f32_16x16x32_bf16 v[208:211], v[248:251], a[216:219], v[208:211]
    ds_read_b128 v[20:23], v243 offset:25600
    v_mfma_f32_16x16x32_bf16 v[212:215], v[248:251], a[220:223], v[212:215]
    buffer_load_dword v117, v253, s[12:15], s61 offen offset:64 sc1
    v_mfma_f32_16x16x32_bf16 v[216:219], v[136:139], a[216:219], v[216:219]
    ds_read_b128 v[24:27], v243 offset:26624
    v_mfma_f32_16x16x32_bf16 v[220:223], v[136:139], a[220:223], v[220:223]
    v_mfma_f32_16x16x32_bf16 v[208:211], v[140:143], a[224:227], v[208:211]
    ds_read_b128 v[28:31], v243 offset:27648
    v_mfma_f32_16x16x32_bf16 v[212:215], v[140:143], a[228:231], v[212:215]
    s_waitcnt lgkmcnt(4)
    v_mfma_f32_16x16x32_bf16 v[216:219], v[144:147], a[224:227], v[216:219]
    ds_read_b128 v[32:35], v243 offset:28672
    v_mfma_f32_16x16x32_bf16 v[220:223], v[144:147], a[228:231], v[220:223]
    v_mfma_f32_16x16x32_bf16 v[208:211], v[148:151], a[232:235], v[208:211]
    ds_read_b128 v[36:39], v243 offset:29696
    v_mfma_f32_16x16x32_bf16 v[212:215], v[148:151], a[236:239], v[212:215]
    v_mfma_f32_16x16x32_bf16 v[216:219], v[152:155], a[232:235], v[216:219]
    ds_read_b128 v[248:251], v243 offset:30720
    v_mfma_f32_16x16x32_bf16 v[220:223], v[152:155], a[236:239], v[220:223]
    s_waitcnt lgkmcnt(4)
    v_mfma_f32_16x16x32_bf16 v[208:211], v[16:19], a[240:243], v[208:211]
    ds_read_b128 v[136:139], v243 offset:31744
    v_mfma_f32_16x16x32_bf16 v[212:215], v[16:19], a[244:247], v[212:215]
    v_mfma_f32_16x16x32_bf16 v[216:219], v[20:23], a[240:243], v[216:219]
    ds_read_b128 v[140:143], v243 offset:32768
    v_mfma_f32_16x16x32_bf16 v[220:223], v[20:23], a[244:247], v[220:223]
    v_mfma_f32_16x16x32_bf16 v[208:211], v[24:27], a[248:251], v[208:211]
    ds_read_b128 v[144:147], v243 offset:33792
    v_mfma_f32_16x16x32_bf16 v[212:215], v[24:27], a[252:255], v[212:215]
    s_waitcnt lgkmcnt(4)
    v_mfma_f32_16x16x32_bf16 v[216:219], v[28:31], a[248:251], v[216:219]
    ds_read_b128 v[148:151], v243 offset:34816
    v_mfma_f32_16x16x32_bf16 v[220:223], v[28:31], a[252:255], v[220:223]
    v_mfma_f32_16x16x32_bf16 v[208:211], v[32:35], v[72:75], v[208:211]
    ds_read_b128 v[152:155], v243 offset:35840
    v_mfma_f32_16x16x32_bf16 v[212:215], v[32:35], v[76:79], v[212:215]
    v_mfma_f32_16x16x32_bf16 v[216:219], v[36:39], v[72:75], v[216:219]
    s_waitcnt vmcnt(19)
    s_barrier
    ds_read_b128 v[16:19], v2 offset:0
    v_mfma_f32_16x16x32_bf16 v[220:223], v[36:39], v[76:79], v[220:223]
    s_waitcnt lgkmcnt(4)
    v_mfma_f32_16x16x32_bf16 v[208:211], v[248:251], v[80:83], v[208:211]
    ds_read_b128 v[20:23], v2 offset:1024
    v_mfma_f32_16x16x32_bf16 v[212:215], v[248:251], v[84:87], v[212:215]
    v_mfma_f32_16x16x32_bf16 v[216:219], v[136:139], v[80:83], v[216:219]
    ds_read_b128 v[24:27], v2 offset:2048
    v_mfma_f32_16x16x32_bf16 v[220:223], v[136:139], v[84:87], v[220:223]
    v_mfma_f32_16x16x32_bf16 v[208:211], v[140:143], v[88:91], v[208:211]
    ds_read_b128 v[28:31], v2 offset:3072
    v_mfma_f32_16x16x32_bf16 v[212:215], v[140:143], v[92:95], v[212:215]
    s_waitcnt lgkmcnt(4)
    v_mfma_f32_16x16x32_bf16 v[216:219], v[144:147], v[88:91], v[216:219]
    ds_read_b128 v[32:35], v2 offset:4096
    v_mfma_f32_16x16x32_bf16 v[220:223], v[144:147], v[92:95], v[220:223]
    v_mfma_f32_16x16x32_bf16 v[208:211], v[148:151], v[96:99], v[208:211]
    ds_read_b128 v[36:39], v2 offset:5120
    v_mfma_f32_16x16x32_bf16 v[212:215], v[148:151], v[100:103], v[212:215]
    v_mfma_f32_16x16x32_bf16 v[216:219], v[152:155], v[96:99], v[216:219]
    ds_read_b128 v[248:251], v2 offset:6144
    v_mfma_f32_16x16x32_bf16 v[220:223], v[152:155], v[100:103], v[220:223]
    s_waitcnt lgkmcnt(4)
    v_mfma_f32_16x16x32_bf16 v[224:227], v[16:19], a[0:3], 0
    ds_read_b128 v[136:139], v2 offset:7168
    v_mfma_f32_16x16x32_bf16 v[228:231], v[16:19], a[4:7], 0
    v_mfma_f32_16x16x32_bf16 v[232:235], v[20:23], a[0:3], 0
    ds_read_b128 v[140:143], v2 offset:8192
    v_mfma_f32_16x16x32_bf16 v[236:239], v[20:23], a[4:7], 0
    v_mfma_f32_16x16x32_bf16 v[224:227], v[24:27], a[8:11], v[224:227]
    ds_read_b128 v[144:147], v2 offset:9216
    v_mfma_f32_16x16x32_bf16 v[228:231], v[24:27], a[12:15], v[228:231]
    s_waitcnt lgkmcnt(4)
    v_mfma_f32_16x16x32_bf16 v[232:235], v[28:31], a[8:11], v[232:235]
    ds_read_b128 v[148:151], v2 offset:10240
    v_mfma_f32_16x16x32_bf16 v[236:239], v[28:31], a[12:15], v[236:239]
    v_cvt_pk_bf16_f32 v56, v208, v209
    v_cvt_pk_bf16_f32 v57, v210, v211
    v_mfma_f32_16x16x32_bf16 v[224:227], v[32:35], a[16:19], v[224:227]
    ds_read_b128 v[152:155], v2 offset:11264
    v_mfma_f32_16x16x32_bf16 v[228:231], v[32:35], a[20:23], v[228:231]
    v_cvt_pk_bf16_f32 v58, v212, v213
    v_cvt_pk_bf16_f32 v59, v214, v215
    v_mfma_f32_16x16x32_bf16 v[232:235], v[36:39], a[16:19], v[232:235]
    ds_read_b128 v[16:19], v2 offset:12288
    v_mfma_f32_16x16x32_bf16 v[236:239], v[36:39], a[20:23], v[236:239]
    v_min_u32 v56, -2, v56
    s_waitcnt lgkmcnt(4)
    v_mfma_f32_16x16x32_bf16 v[224:227], v[248:251], a[24:27], v[224:227]
    ds_read_b128 v[20:23], v2 offset:13312
    v_mfma_f32_16x16x32_bf16 v[228:231], v[248:251], a[28:31], v[228:231]
    v_min_u32 v57, -2, v57
    v_min_u32 v58, -2, v58
    v_mfma_f32_16x16x32_bf16 v[232:235], v[136:139], a[24:27], v[232:235]
    ds_read_b128 v[24:27], v2 offset:14336
    v_mfma_f32_16x16x32_bf16 v[236:239], v[136:139], a[28:31], v[236:239]
    v_min_u32 v59, -2, v59
    v_mfma_f32_16x16x32_bf16 v[224:227], v[140:143], a[32:35], v[224:227]
    ds_read_b128 v[28:31], v2 offset:15360
    v_mfma_f32_16x16x32_bf16 v[228:231], v[140:143], a[36:39], v[228:231]
    s_waitcnt lgkmcnt(4)
    v_mfma_f32_16x16x32_bf16 v[232:235], v[144:147], a[32:35], v[232:235]
    ds_read_b128 v[32:35], v2 offset:16384
    v_mfma_f32_16x16x32_bf16 v[236:239], v[144:147], a[36:39], v[236:239]
    buffer_store_dwordx4 v[56:59], v2, s[12:15], s42 offen offset:0 sc1
    v_mfma_f32_16x16x32_bf16 v[224:227], v[148:151], a[40:43], v[224:227]
    ds_read_b128 v[36:39], v2 offset:17408
    v_mfma_f32_16x16x32_bf16 v[228:231], v[148:151], a[44:47], v[228:231]
    v_cvt_pk_bf16_f32 v60, v216, v217
    v_cvt_pk_bf16_f32 v61, v218, v219
    v_mfma_f32_16x16x32_bf16 v[232:235], v[152:155], a[40:43], v[232:235]
    ds_read_b128 v[248:251], v2 offset:18432
    v_mfma_f32_16x16x32_bf16 v[236:239], v[152:155], a[44:47], v[236:239]
    v_cvt_pk_bf16_f32 v62, v220, v221
    s_waitcnt lgkmcnt(4)
    v_mfma_f32_16x16x32_bf16 v[224:227], v[16:19], a[48:51], v[224:227]
    ds_read_b128 v[136:139], v2 offset:19456
    v_mfma_f32_16x16x32_bf16 v[228:231], v[16:19], a[52:55], v[228:231]
    v_cvt_pk_bf16_f32 v63, v222, v223
    v_min_u32 v60, -2, v60
    v_mfma_f32_16x16x32_bf16 v[232:235], v[20:23], a[48:51], v[232:235]
    ds_read_b128 v[140:143], v2 offset:20480
    v_mfma_f32_16x16x32_bf16 v[236:239], v[20:23], a[52:55], v[236:239]
    v_min_u32 v61, -2, v61
    v_min_u32 v62, -2, v62
    v_mfma_f32_16x16x32_bf16 v[224:227], v[24:27], a[56:59], v[224:227]
    ds_read_b128 v[144:147], v2 offset:21504
    v_mfma_f32_16x16x32_bf16 v[228:231], v[24:27], a[60:63], v[228:231]
    v_min_u32 v63, -2, v63
    s_waitcnt lgkmcnt(4)
    v_mfma_f32_16x16x32_bf16 v[232:235], v[28:31], a[56:59], v[232:235]
    ds_read_b128 v[148:151], v2 offset:22528
    v_mfma_f32_16x16x32_bf16 v[236:239], v[28:31], a[60:63], v[236:239]
    buffer_store_dwordx4 v[60:63], v2, s[12:15], s42 offen offset:1024 sc1
    v_mfma_f32_16x16x32_bf16 v[224:227], v[32:35], a[64:67], v[224:227]
    ds_read_b128 v[152:155], v2 offset:23552
    v_mfma_f32_16x16x32_bf16 v[228:231], v[32:35], a[68:71], v[228:231]
    v_mfma_f32_16x16x32_bf16 v[232:235], v[36:39], a[64:67], v[232:235]
    ds_read_b128 v[16:19], v2 offset:24576
    v_mfma_f32_16x16x32_bf16 v[236:239], v[36:39], a[68:71], v[236:239]
    s_waitcnt lgkmcnt(4)
    v_mfma_f32_16x16x32_bf16 v[224:227], v[248:251], a[72:75], v[224:227]
    ds_read_b128 v[20:23], v2 offset:25600
    v_mfma_f32_16x16x32_bf16 v[228:231], v[248:251], a[76:79], v[228:231]
    v_mfma_f32_16x16x32_bf16 v[232:235], v[136:139], a[72:75], v[232:235]
    ds_read_b128 v[24:27], v2 offset:26624
    v_mfma_f32_16x16x32_bf16 v[236:239], v[136:139], a[76:79], v[236:239]
    v_mfma_f32_16x16x32_bf16 v[224:227], v[140:143], a[80:83], v[224:227]
    ds_read_b128 v[28:31], v2 offset:27648
    v_mfma_f32_16x16x32_bf16 v[228:231], v[140:143], a[84:87], v[228:231]
    s_waitcnt lgkmcnt(4)
    v_mfma_f32_16x16x32_bf16 v[232:235], v[144:147], a[80:83], v[232:235]
    ds_read_b128 v[32:35], v2 offset:28672
    v_mfma_f32_16x16x32_bf16 v[236:239], v[144:147], a[84:87], v[236:239]
    v_mfma_f32_16x16x32_bf16 v[224:227], v[148:151], a[88:91], v[224:227]
    ds_read_b128 v[36:39], v2 offset:29696
    v_mfma_f32_16x16x32_bf16 v[228:231], v[148:151], a[92:95], v[228:231]
    v_mfma_f32_16x16x32_bf16 v[232:235], v[152:155], a[88:91], v[232:235]
    ds_read_b128 v[248:251], v2 offset:30720
    v_mfma_f32_16x16x32_bf16 v[236:239], v[152:155], a[92:95], v[236:239]
    s_waitcnt lgkmcnt(4)
    v_mfma_f32_16x16x32_bf16 v[224:227], v[16:19], a[96:99], v[224:227]
    ds_read_b128 v[136:139], v2 offset:31744
    v_mfma_f32_16x16x32_bf16 v[228:231], v[16:19], a[100:103], v[228:231]
    v_mfma_f32_16x16x32_bf16 v[232:235], v[20:23], a[96:99], v[232:235]
    ds_read_b128 v[140:143], v2 offset:32768
    v_mfma_f32_16x16x32_bf16 v[236:239], v[20:23], a[100:103], v[236:239]
    v_mfma_f32_16x16x32_bf16 v[224:227], v[24:27], a[104:107], v[224:227]
    ds_read_b128 v[144:147], v2 offset:33792
    v_mfma_f32_16x16x32_bf16 v[228:231], v[24:27], a[108:111], v[228:231]
    s_waitcnt lgkmcnt(4)
    v_mfma_f32_16x16x32_bf16 v[232:235], v[28:31], a[104:107], v[232:235]
    ds_read_b128 v[148:151], v2 offset:34816
    v_mfma_f32_16x16x32_bf16 v[236:239], v[28:31], a[108:111], v[236:239]
    v_mfma_f32_16x16x32_bf16 v[224:227], v[32:35], a[112:115], v[224:227]
    ds_read_b128 v[152:155], v2 offset:35840
    v_mfma_f32_16x16x32_bf16 v[228:231], v[32:35], a[116:119], v[228:231]
    v_mfma_f32_16x16x32_bf16 v[232:235], v[36:39], a[112:115], v[232:235]
    s_waitcnt vmcnt(8)
    s_barrier
    ds_read_b128 v[16:19], v241 offset:0
    v_mfma_f32_16x16x32_bf16 v[236:239], v[36:39], a[116:119], v[236:239]
    s_waitcnt lgkmcnt(4)
    v_mfma_f32_16x16x32_bf16 v[224:227], v[248:251], a[120:123], v[224:227]
    ds_read_b128 v[20:23], v241 offset:1024
    v_mfma_f32_16x16x32_bf16 v[228:231], v[248:251], a[124:127], v[228:231]
    v_mfma_f32_16x16x32_bf16 v[232:235], v[136:139], a[120:123], v[232:235]
    ds_read_b128 v[24:27], v241 offset:2048
    v_mfma_f32_16x16x32_bf16 v[236:239], v[136:139], a[124:127], v[236:239]
    v_mfma_f32_16x16x32_bf16 v[224:227], v[140:143], a[128:131], v[224:227]
    ds_read_b128 v[28:31], v241 offset:3072
    v_mfma_f32_16x16x32_bf16 v[228:231], v[140:143], a[132:135], v[228:231]
    s_waitcnt lgkmcnt(4)
    v_mfma_f32_16x16x32_bf16 v[232:235], v[144:147], a[128:131], v[232:235]
    ds_read_b128 v[32:35], v241 offset:4096
    v_mfma_f32_16x16x32_bf16 v[236:239], v[144:147], a[132:135], v[236:239]
    v_mfma_f32_16x16x32_bf16 v[224:227], v[148:151], a[136:139], v[224:227]
    ds_read_b128 v[36:39], v241 offset:5120
    v_mfma_f32_16x16x32_bf16 v[228:231], v[148:151], a[140:143], v[228:231]
    v_mfma_f32_16x16x32_bf16 v[232:235], v[152:155], a[136:139], v[232:235]
    ds_read_b128 v[248:251], v241 offset:6144
    v_mfma_f32_16x16x32_bf16 v[236:239], v[152:155], a[140:143], v[236:239]
    s_waitcnt lgkmcnt(4)
    v_mfma_f32_16x16x32_bf16 v[224:227], v[16:19], a[144:147], v[224:227]
    ds_read_b128 v[136:139], v241 offset:7168
    v_mfma_f32_16x16x32_bf16 v[228:231], v[16:19], a[148:151], v[228:231]
    v_mfma_f32_16x16x32_bf16 v[232:235], v[20:23], a[144:147], v[232:235]
    ds_read_b128 v[140:143], v241 offset:8192
    v_mfma_f32_16x16x32_bf16 v[236:239], v[20:23], a[148:151], v[236:239]
    v_mfma_f32_16x16x32_bf16 v[224:227], v[24:27], a[152:155], v[224:227]
    ds_read_b128 v[144:147], v241 offset:9216
    v_mfma_f32_16x16x32_bf16 v[228:231], v[24:27], a[156:159], v[228:231]
    s_waitcnt lgkmcnt(4)
    v_mfma_f32_16x16x32_bf16 v[232:235], v[28:31], a[152:155], v[232:235]
    ds_read_b128 v[148:151], v241 offset:10240
    v_mfma_f32_16x16x32_bf16 v[236:239], v[28:31], a[156:159], v[236:239]
    v_mfma_f32_16x16x32_bf16 v[224:227], v[32:35], a[160:163], v[224:227]
    ds_read_b128 v[152:155], v241 offset:11264
    v_mfma_f32_16x16x32_bf16 v[228:231], v[32:35], a[164:167], v[228:231]
    v_mfma_f32_16x16x32_bf16 v[232:235], v[36:39], a[160:163], v[232:235]
    ds_read_b128 v[16:19], v241 offset:12288
    v_mfma_f32_16x16x32_bf16 v[236:239], v[36:39], a[164:167], v[236:239]
    s_waitcnt lgkmcnt(4)
    v_mfma_f32_16x16x32_bf16 v[224:227], v[248:251], a[168:171], v[224:227]
    ds_read_b128 v[20:23], v241 offset:13312
    v_mfma_f32_16x16x32_bf16 v[228:231], v[248:251], a[172:175], v[228:231]
    v_mfma_f32_16x16x32_bf16 v[232:235], v[136:139], a[168:171], v[232:235]
    ds_read_b128 v[24:27], v241 offset:14336
    v_mfma_f32_16x16x32_bf16 v[236:239], v[136:139], a[172:175], v[236:239]
    v_mfma_f32_16x16x32_bf16 v[224:227], v[140:143], a[176:179], v[224:227]
    ds_read_b128 v[28:31], v241 offset:15360
    v_mfma_f32_16x16x32_bf16 v[228:231], v[140:143], a[180:183], v[228:231]
    s_waitcnt lgkmcnt(4)
    v_mfma_f32_16x16x32_bf16 v[232:235], v[144:147], a[176:179], v[232:235]
    ds_read_b128 v[32:35], v241 offset:16384
    v_mfma_f32_16x16x32_bf16 v[236:239], v[144:147], a[180:183], v[236:239]
    v_mfma_f32_16x16x32_bf16 v[224:227], v[148:151], a[184:187], v[224:227]
    ds_read_b128 v[36:39], v241 offset:17408
    v_mfma_f32_16x16x32_bf16 v[228:231], v[148:151], a[188:191], v[228:231]
    v_mfma_f32_16x16x32_bf16 v[232:235], v[152:155], a[184:187], v[232:235]
    ds_read_b128 v[248:251], v241 offset:18432
    v_mfma_f32_16x16x32_bf16 v[236:239], v[152:155], a[188:191], v[236:239]
    s_waitcnt lgkmcnt(4)
    v_mfma_f32_16x16x32_bf16 v[224:227], v[16:19], a[192:195], v[224:227]
    ds_read_b128 v[136:139], v241 offset:19456
    v_mfma_f32_16x16x32_bf16 v[228:231], v[16:19], a[196:199], v[228:231]
    v_mfma_f32_16x16x32_bf16 v[232:235], v[20:23], a[192:195], v[232:235]
    ds_read_b128 v[140:143], v241 offset:20480
    v_mfma_f32_16x16x32_bf16 v[236:239], v[20:23], a[196:199], v[236:239]
    v_mfma_f32_16x16x32_bf16 v[224:227], v[24:27], a[200:203], v[224:227]
    ds_read_b128 v[144:147], v241 offset:21504
    v_mfma_f32_16x16x32_bf16 v[228:231], v[24:27], a[204:207], v[228:231]
    s_waitcnt lgkmcnt(4)
    v_mfma_f32_16x16x32_bf16 v[232:235], v[28:31], a[200:203], v[232:235]
    ds_read_b128 v[148:151], v241 offset:22528
    v_mfma_f32_16x16x32_bf16 v[236:239], v[28:31], a[204:207], v[236:239]
    v_mfma_f32_16x16x32_bf16 v[224:227], v[32:35], a[208:211], v[224:227]
    ds_read_b128 v[152:155], v241 offset:23552
    v_mfma_f32_16x16x32_bf16 v[228:231], v[32:35], a[212:215], v[228:231]
    v_mfma_f32_16x16x32_bf16 v[232:235], v[36:39], a[208:211], v[232:235]
    ds_read_b128 v[16:19], v241 offset:24576
    v_mfma_f32_16x16x32_bf16 v[236:239], v[36:39], a[212:215], v[236:239]
    s_waitcnt lgkmcnt(4)
    v_mfma_f32_16x16x32_bf16 v[224:227], v[248:251], a[216:219], v[224:227]
    ds_read_b128 v[20:23], v241 offset:25600
    v_mfma_f32_16x16x32_bf16 v[228:231], v[248:251], a[220:223], v[228:231]
    v_mfma_f32_16x16x32_bf16 v[232:235], v[136:139], a[216:219], v[232:235]
    ds_read_b128 v[24:27], v241 offset:26624
    v_mfma_f32_16x16x32_bf16 v[236:239], v[136:139], a[220:223], v[236:239]
    v_mfma_f32_16x16x32_bf16 v[224:227], v[140:143], a[224:227], v[224:227]
    ds_read_b128 v[28:31], v241 offset:27648
    v_mfma_f32_16x16x32_bf16 v[228:231], v[140:143], a[228:231], v[228:231]
    s_waitcnt lgkmcnt(4)
    v_mfma_f32_16x16x32_bf16 v[232:235], v[144:147], a[224:227], v[232:235]
    ds_read_b128 v[32:35], v241 offset:28672
    v_mfma_f32_16x16x32_bf16 v[236:239], v[144:147], a[228:231], v[236:239]
    v_mfma_f32_16x16x32_bf16 v[224:227], v[148:151], a[232:235], v[224:227]
    ds_read_b128 v[36:39], v241 offset:29696
    v_mfma_f32_16x16x32_bf16 v[228:231], v[148:151], a[236:239], v[228:231]
    buffer_load_dwordx4 v[8:11], v2, s[12:15], s66 offen offset:0 sc1
    v_mfma_f32_16x16x32_bf16 v[232:235], v[152:155], a[232:235], v[232:235]
    ds_read_b128 v[248:251], v241 offset:30720
    v_mfma_f32_16x16x32_bf16 v[236:239], v[152:155], a[236:239], v[236:239]
    buffer_load_dwordx4 v[12:15], v2, s[12:15], s66 offen offset:1024 sc1
    s_waitcnt lgkmcnt(4)
    v_mfma_f32_16x16x32_bf16 v[224:227], v[16:19], a[240:243], v[224:227]
    ds_read_b128 v[136:139], v241 offset:31744
    v_mfma_f32_16x16x32_bf16 v[228:231], v[16:19], a[244:247], v[228:231]
    buffer_load_dwordx4 v[164:167], v2, s[12:15], s66 offen offset:2048 sc1
    v_mfma_f32_16x16x32_bf16 v[232:235], v[20:23], a[240:243], v[232:235]
    ds_read_b128 v[140:143], v241 offset:32768
    v_mfma_f32_16x16x32_bf16 v[236:239], v[20:23], a[244:247], v[236:239]
    buffer_load_dwordx4 v[120:123], v2, s[12:15], s36 offen offset:0 sc1
    v_mfma_f32_16x16x32_bf16 v[224:227], v[24:27], a[248:251], v[224:227]
    ds_read_b128 v[144:147], v241 offset:33792
    v_mfma_f32_16x16x32_bf16 v[228:231], v[24:27], a[252:255], v[228:231]
    buffer_load_dwordx4 v[124:127], v2, s[12:15], s36 offen offset:1024 sc1
    s_waitcnt lgkmcnt(4)
    v_mfma_f32_16x16x32_bf16 v[232:235], v[28:31], a[248:251], v[232:235]
    ds_read_b128 v[148:151], v241 offset:34816
    v_mfma_f32_16x16x32_bf16 v[236:239], v[28:31], a[252:255], v[236:239]
    buffer_load_dwordx4 v[128:131], v2, s[12:15], s36 offen offset:2048 sc1
    v_mfma_f32_16x16x32_bf16 v[224:227], v[32:35], v[72:75], v[224:227]
    ds_read_b128 v[152:155], v241 offset:35840
    v_mfma_f32_16x16x32_bf16 v[228:231], v[32:35], v[76:79], v[228:231]
    buffer_load_dwordx4 v[132:135], v2, s[12:15], s36 offen offset:3072 sc1
    v_mfma_f32_16x16x32_bf16 v[232:235], v[36:39], v[72:75], v[232:235]
    v_mfma_f32_16x16x32_bf16 v[236:239], v[36:39], v[76:79], v[236:239]
    buffer_load_dwordx4 v[156:159], v2, s[12:15], s37 offen offset:0 sc1
    s_waitcnt lgkmcnt(3)
    v_mfma_f32_16x16x32_bf16 v[224:227], v[248:251], v[80:83], v[224:227]
    v_mfma_f32_16x16x32_bf16 v[228:231], v[248:251], v[84:87], v[228:231]
    buffer_load_dwordx4 v[160:163], v2, s[12:15], s37 offen offset:1024 sc1
    v_mfma_f32_16x16x32_bf16 v[232:235], v[136:139], v[80:83], v[232:235]
    v_mfma_f32_16x16x32_bf16 v[236:239], v[136:139], v[84:87], v[236:239]
    v_mfma_f32_16x16x32_bf16 v[224:227], v[140:143], v[88:91], v[224:227]
    v_mfma_f32_16x16x32_bf16 v[228:231], v[140:143], v[92:95], v[228:231]
    s_waitcnt lgkmcnt(0)
    v_mfma_f32_16x16x32_bf16 v[232:235], v[144:147], v[88:91], v[232:235]
    v_mfma_f32_16x16x32_bf16 v[236:239], v[144:147], v[92:95], v[236:239]
    v_mfma_f32_16x16x32_bf16 v[224:227], v[148:151], v[96:99], v[224:227]
    v_mfma_f32_16x16x32_bf16 v[228:231], v[148:151], v[100:103], v[228:231]
    v_mfma_f32_16x16x32_bf16 v[232:235], v[152:155], v[96:99], v[232:235]
    v_mfma_f32_16x16x32_bf16 v[236:239], v[152:155], v[100:103], v[236:239]
    s_mov_b32 s67, 0x40000
    s_cmp_lg_u32 s3, s50
    s_cbranch_scc1 Lnox56
Lrxa57:
    s_waitcnt vmcnt(0)
    v_max3_u32 v32, v8, v9, v10
    v_max3_u32 v33, v11, v12, v13
    v_max3_u32 v32, v32, v14, v15
    v_max3_u32 v33, v33, v164, v165
    v_max3_u32 v32, v32, v166, v167
    v_max_u32 v32, v32, v33
    v_cmp_eq_u32 vcc, -1, v32
    s_nop 4
    s_cbranch_vccz Lrxg58
    s_sub_u32 s67, s67, 1
    s_cbranch_scc1 Lrxg58
    buffer_load_dwordx4 v[8:11], v2, s[12:15], s66 offen offset:0 sc1
    buffer_load_dwordx4 v[12:15], v2, s[12:15], s66 offen offset:1024 sc1
    buffer_load_dwordx4 v[164:167], v2, s[12:15], s66 offen offset:2048 sc1
    s_branch Lrxa57
Lrxg58:
Lnox56:
    s_waitcnt vmcnt(9)
    v_lshlrev_b32 v16, 16, v104
    v_and_b32 v17, s63, v104
    v_lshlrev_b32 v18, 16, v105
    v_and_b32 v19, s63, v105
    v_pk_add_f32 v[224:225], v[224:225], v[16:17]
    v_pk_add_f32 v[226:227], v[226:227], v[18:19]
    v_pk_add_f32 v[224:225], v[224:225], v[116:117] op_sel:[0,0] op_sel_hi:[1,0]
    v_pk_add_f32 v[226:227], v[226:227], v[116:117] op_sel:[0,0] op_sel_hi:[1,0]
    v_lshlrev_b32 v20, 16, v106
    v_and_b32 v21, s63, v106
    v_lshlrev_b32 v22, 16, v107
    v_and_b32 v23, s63, v107
    v_pk_add_f32 v[228:229], v[228:229], v[20:21]
    v_pk_add_f32 v[230:231], v[230:231], v[22:23]
    v_pk_add_f32 v[228:229], v[228:229], v[116:117] op_sel:[0,1] op_sel_hi:[1,1]
    v_pk_add_f32 v[230:231], v[230:231], v[116:117] op_sel:[0,1] op_sel_hi:[1,1]
    v_lshlrev_b32 v24, 16, v108
    v_and_b32 v25, s63, v108
    v_lshlrev_b32 v26, 16, v109
    v_and_b32 v27, s63, v109
    v_pk_add_f32 v[232:233], v[232:233], v[24:25]
    v_pk_add_f32 v[234:235], v[234:235], v[26:27]
    v_pk_add_f32 v[232:233], v[232:233], v[116:117] op_sel:[0,0] op_sel_hi:[1,0]
    v_pk_add_f32 v[234:235], v[234:235], v[116:117] op_sel:[0,0] op_sel_hi:[1,0]
    v_lshlrev_b32 v28, 16, v110
    v_and_b32 v29, s63, v110
    v_lshlrev_b32 v30, 16, v111
    v_and_b32 v31, s63, v111
    v_pk_add_f32 v[236:237], v[236:237], v[28:29]
    v_pk_add_f32 v[238:239], v[238:239], v[30:31]
    v_pk_add_f32 v[236:237], v[236:237], v[116:117] op_sel:[0,1] op_sel_hi:[1,1]
    v_pk_add_f32 v[238:239], v[238:239], v[116:117] op_sel:[0,1] op_sel_hi:[1,1]
Lrxa59:
    s_waitcnt vmcnt(0)
    v_max3_u32 v32, v120, v121, v122
    v_max3_u32 v33, v123, v124, v125
    v_max3_u32 v32, v32, v126, v127
    v_max3_u32 v33, v33, v128, v129
    v_max3_u32 v32, v32, v130, v131
    v_max3_u32 v33, v33, v132, v133
    v_max3_u32 v32, v32, v134, v135
    v_max3_u32 v33, v33, v156, v157
    v_max3_u32 v32, v32, v158, v159
    v_max3_u32 v33, v33, v160, v161
    v_max3_u32 v32, v32, v162, v163
    v_max_u32 v32, v32, v33
    v_cmp_eq_u32 vcc, -1, v32
    s_nop 4
    s_cbranch_vccz Lrxg60
    s_sub_u32 s67, s67, 1
    s_cbranch_scc1 Lrxg60
    buffer_load_dwordx4 v[120:123], v2, s[12:15], s36 offen offset:0 sc1
    buffer_load_dwordx4 v[124:127], v2, s[12:15], s36 offen offset:1024 sc1
    buffer_load_dwordx4 v[128:131], v2, s[12:15], s36 offen offset:2048 sc1
    buffer_load_dwordx4 v[132:135], v2, s[12:15], s36 offen offset:3072 sc1
    buffer_load_dwordx4 v[156:159], v2, s[12:15], s37 offen offset:0 sc1
    buffer_load_dwordx4 v[160:163], v2, s[12:15], s37 offen offset:1024 sc1
    s_branch Lrxa59
Lrxg60:
    v_lshlrev_b32 v16, 16, v120
    v_and_b32 v17, s63, v120
    v_lshlrev_b32 v18, 16, v121
    v_and_b32 v19, s63, v121
    v_pk_add_f32 v[224:225], v[224:225], v[16:17]
    v_pk_add_f32 v[226:227], v[226:227], v[18:19]
    v_lshlrev_b32 v20, 16, v128
    v_and_b32 v21, s63, v128
    v_lshlrev_b32 v22, 16, v129
    v_and_b32 v23, s63, v129
    v_pk_add_f32 v[224:225], v[224:225], v[20:21]
    v_pk_add_f32 v[226:227], v[226:227], v[22:23]
    v_lshlrev_b32 v24, 16, v156
    v_and_b32 v25, s63, v156
    v_lshlrev_b32 v26, 16, v157
    v_and_b32 v27, s63, v157
    v_pk_add_f32 v[224:225], v[224:225], v[24:25]
    v_pk_add_f32 v[226:227], v[226:227], v[26:27]
    v_cvt_pk_bf16_f32 v140, v224, v225
    v_cvt_pk_bf16_f32 v141, v226, v227
    v_lshlrev_b32 v16, 16, v124
    v_and_b32 v17, s63, v124
    v_lshlrev_b32 v18, 16, v125
    v_and_b32 v19, s63, v125
    v_pk_add_f32 v[232:233], v[232:233], v[16:17]
    v_pk_add_f32 v[234:235], v[234:235], v[18:19]
    v_lshlrev_b32 v20, 16, v132
    v_and_b32 v21, s63, v132
    v_lshlrev_b32 v22, 16, v133
    v_and_b32 v23, s63, v133
    v_pk_add_f32 v[232:233], v[232:233], v[20:21]
    v_pk_add_f32 v[234:235], v[234:235], v[22:23]
    v_lshlrev_b32 v24, 16, v160
    v_and_b32 v25, s63, v160
    v_lshlrev_b32 v26, 16, v161
    v_and_b32 v27, s63, v161
    v_pk_add_f32 v[232:233], v[232:233], v[24:25]
    v_pk_add_f32 v[234:235], v[234:235], v[26:27]
    v_cvt_pk_bf16_f32 v142, v232, v233
    v_cvt_pk_bf16_f32 v143, v234, v235
    s_nop 0
    v_permlane16_swap_b32 v140, v142
    v_permlane16_swap_b32 v141, v143
    buffer_store_dwordx4 v[140:143], v7, s[16:19], s65 offen sc1
    v_lshlrev_b32 v16, 16, v122
    v_and_b32 v17, s63, v122
    v_lshlrev_b32 v18, 16, v123
    v_and_b32 v19, s63, v123
    v_pk_add_f32 v[228:229], v[228:229], v[16:17]
    v_pk_add_f32 v[230:231], v[230:231], v[18:19]
    v_lshlrev_b32 v20, 16, v130
    v_and_b32 v21, s63, v130
    v_lshlrev_b32 v22, 16, v131
    v_and_b32 v23, s63, v131
    v_pk_add_f32 v[228:229], v[228:229], v[20:21]
    v_pk_add_f32 v[230:231], v[230:231], v[22:23]
    v_lshlrev_b32 v24, 16, v158
    v_and_b32 v25, s63, v158
    v_lshlrev_b32 v26, 16, v159
    v_and_b32 v27, s63, v159
    v_pk_add_f32 v[228:229], v[228:229], v[24:25]
    v_pk_add_f32 v[230:231], v[230:231], v[26:27]
    v_cvt_pk_bf16_f32 v144, v228, v229
    v_cvt_pk_bf16_f32 v145, v230, v231
    v_lshlrev_b32 v16, 16, v126
    v_and_b32 v17, s63, v126
    v_lshlrev_b32 v18, 16, v127
    v_and_b32 v19, s63, v127
    v_pk_add_f32 v[236:237], v[236:237], v[16:17]
    v_pk_add_f32 v[238:239], v[238:239], v[18:19]
    v_lshlrev_b32 v20, 16, v134
    v_and_b32 v21, s63, v134
    v_lshlrev_b32 v22, 16, v135
    v_and_b32 v23, s63, v135
    v_pk_add_f32 v[236:237], v[236:237], v[20:21]
    v_pk_add_f32 v[238:239], v[238:239], v[22:23]
    v_lshlrev_b32 v24, 16, v162
    v_and_b32 v25, s63, v162
    v_lshlrev_b32 v26, 16, v163
    v_and_b32 v27, s63, v163
    v_pk_add_f32 v[236:237], v[236:237], v[24:25]
    v_pk_add_f32 v[238:239], v[238:239], v[26:27]
    v_cvt_pk_bf16_f32 v146, v236, v237
    v_cvt_pk_bf16_f32 v147, v238, v239
    s_nop 0
    v_permlane16_swap_b32 v144, v146
    v_permlane16_swap_b32 v145, v147
    s_add_u32 s65, s65, 18432
    buffer_store_dwordx4 v[144:147], v7, s[16:19], s65 offen sc1
    s_cmp_lg_u32 s3, s50
    s_cbranch_scc1 Lnox261
    v_lshlrev_b32 v16, 16, v112
    v_and_b32 v17, s63, v112
    v_lshlrev_b32 v18, 16, v113
    v_and_b32 v19, s63, v113
    v_pk_add_f32 v[200:201], v[200:201], v[16:17]
    v_pk_add_f32 v[202:203], v[202:203], v[18:19]
    v_pk_add_f32 v[200:201], v[200:201], v[116:117] op_sel:[0,0] op_sel_hi:[1,0]
    v_pk_add_f32 v[202:203], v[202:203], v[116:117] op_sel:[0,0] op_sel_hi:[1,0]
    v_lshlrev_b32 v20, 16, v8
    v_and_b32 v21, s63, v8
    v_lshlrev_b32 v22, 16, v9
    v_and_b32 v23, s63, v9
    v_pk_add_f32 v[200:201], v[200:201], v[20:21]
    v_pk_add_f32 v[202:203], v[202:203], v[22:23]
    v_lshlrev_b32 v24, 16, v12
    v_and_b32 v25, s63, v12
    v_lshlrev_b32 v26, 16, v13
    v_and_b32 v27, s63, v13
    v_pk_add_f32 v[200:201], v[200:201], v[24:25]
    v_pk_add_f32 v[202:203], v[202:203], v[26:27]
    v_lshlrev_b32 v28, 16, v164
    v_and_b32 v29, s63, v164
    v_lshlrev_b32 v30, 16, v165
    v_and_b32 v31, s63, v165
    v_pk_add_f32 v[200:201], v[200:201], v[28:29]
    v_pk_add_f32 v[202:203], v[202:203], v[30:31]
    v_cvt_pk_bf16_f32 v136, v200, v201
    v_cvt_pk_bf16_f32 v137, v202, v203
    v_lshlrev_b32 v16, 16, v114
    v_and_b32 v17, s63, v114
    v_lshlrev_b32 v18, 16, v115
    v_and_b32 v19, s63, v115
    v_pk_add_f32 v[204:205], v[204:205], v[16:17]
    v_pk_add_f32 v[206:207], v[206:207], v[18:19]
    v_pk_add_f32 v[204:205], v[204:205], v[116:117] op_sel:[0,1] op_sel_hi:[1,1]
    v_pk_add_f32 v[206:207], v[206:207], v[116:117] op_sel:[0,1] op_sel_hi:[1,1]
    v_lshlrev_b32 v20, 16, v10
    v_and_b32 v21, s63, v10
    v_lshlrev_b32 v22, 16, v11
    v_and_b32 v23, s63, v11
    v_pk_add_f32 v[204:205], v[204:205], v[20:21]
    v_pk_add_f32 v[206:207], v[206:207], v[22:23]
    v_lshlrev_b32 v24, 16, v14
    v_and_b32 v25, s63, v14
    v_lshlrev_b32 v26, 16, v15
    v_and_b32 v27, s63, v15
    v_pk_add_f32 v[204:205], v[204:205], v[24:25]
    v_pk_add_f32 v[206:207], v[206:207], v[26:27]
    v_lshlrev_b32 v28, 16, v166
    v_and_b32 v29, s63, v166
    v_lshlrev_b32 v30, 16, v167
    v_and_b32 v31, s63, v167
    v_pk_add_f32 v[204:205], v[204:205], v[28:29]
    v_pk_add_f32 v[206:207], v[206:207], v[30:31]
    v_cvt_pk_bf16_f32 v138, v204, v205
    v_cvt_pk_bf16_f32 v139, v206, v207
    s_nop 0
    v_permlane16_swap_b32 v136, v138
    v_permlane16_swap_b32 v137, v139
    buffer_store_dwordx4 v[136:139], v5, s[16:19], s58 offen sc1
Lnox261:
Ldone1:
    s_endpgm
code_end:
Lslow27:
    s_lshl_b32 s27, s3, 1
    s_add_u32 s27, s27, 2
    s_sub_u32 s27, s27, s33
    s_mul_i32 s27, s27, 1536
    v_add_u32 v9, s27, v5
    v_lshl_add_u32 v10, v1, 3, s27
    ds_read_b128 v[28:31], v9 offset:0
    ds_read_b64 v[32:33], v10 offset:1024
    v_mov_b32 v18, 0xff800000
    s_waitcnt lgkmcnt(0)
    v_cndmask_b32 v33, v33, 0, s[66:67]
    v_mov_b32 v76, 0
    v_mov_b32 v77, 0
    v_mov_b32 v78, 0
    v_mov_b32 v79, 0
    v_mov_b32 v80, 0
    v_mov_b32 v81, 0
    v_mov_b32 v82, 0
    v_mov_b32 v83, 0
    v_mov_b32 v84, 0
    v_mov_b32 v85, 0
    v_mov_b32 v86, 0
    v_mov_b32 v87, 0
    v_mov_b32 v88, 0
    v_mov_b32 v89, 0
    v_mov_b32 v90, 0
    v_mov_b32 v91, 0
    s_mov_b32 s30, s42
    s_mov_b32 s31, s43
    s_mov_b32 s32, 0x480000
    s_mov_b32 s28, 64
Lsl62:
    buffer_load_dwordx4 a[0:3], v2, s[12:15], s30 offen sc1
    buffer_load_dwordx2 v[108:109], v3, s[12:15], s31 offen sc1
    s_waitcnt vmcnt(0)
    v_mfma_f32_32x32x8_bf16 v[36:51], v[108:109], v[32:33], 0
    v_mfma_f32_32x32x16_bf16 v[36:51], a[0:3], v[28:31], v[36:51]
    s_nop 11
    v_max3_f32 v18, v18, v36, v37
    v_max3_f32 v18, v18, v38, v39
    v_max3_f32 v18, v18, v40, v41
    v_max3_f32 v18, v18, v42, v43
    v_max3_f32 v18, v18, v44, v45
    v_max3_f32 v18, v18, v46, v47
    v_max3_f32 v18, v18, v48, v49
    v_max3_f32 v18, v18, v50, v51
    s_add_u32 s30, s30, 512
    s_add_u32 s31, s31, 512
    s_sub_u32 s28, s28, 1
    s_cmp_lg_u32 s28, 0
    s_cbranch_scc1 Lsl62
    v_mov_b32 v19, v18
    s_nop 1
    v_permlane32_swap_b32 v18, v19
    v_max_f32 v18, v18, v19
    s_mov_b32 s30, s42
    s_mov_b32 s31, s43
    s_mov_b32 s32, 0x480000
    s_mov_b32 s28, 64
Lsl63:
    buffer_load_dwordx4 a[0:3], v2, s[12:15], s30 offen sc1
    buffer_load_dwordx2 v[108:109], v3, s[12:15], s31 offen sc1
    buffer_load_dwordx4 a[64:67], v4, s[12:15], s32 offen sc1
    s_add_u32 s32, s32, 18688
    buffer_load_dwordx4 a[68:71], v4, s[12:15], s32 offen sc1
    s_add_u32 s32, s32, 18688
    s_waitcnt vmcnt(0)
    v_mfma_f32_32x32x8_bf16 v[36:51], v[108:109], v[32:33], 0
    v_mfma_f32_32x32x16_bf16 v[36:51], a[0:3], v[28:31], v[36:51]
    s_nop 11
    v_sub_f32 v36, v36, v18
    v_sub_f32 v37, v37, v18
    v_sub_f32 v38, v38, v18
    v_sub_f32 v39, v39, v18
    v_sub_f32 v40, v40, v18
    v_sub_f32 v41, v41, v18
    v_sub_f32 v42, v42, v18
    v_sub_f32 v43, v43, v18
    v_sub_f32 v44, v44, v18
    v_sub_f32 v45, v45, v18
    v_sub_f32 v46, v46, v18
    v_sub_f32 v47, v47, v18
    v_sub_f32 v48, v48, v18
    v_sub_f32 v49, v49, v18
    v_sub_f32 v50, v50, v18
    v_sub_f32 v51, v51, v18
    v_exp_f32 v36, v36
    v_exp_f32 v37, v37
    v_exp_f32 v38, v38
    v_exp_f32 v39, v39
    v_exp_f32 v40, v40
    v_exp_f32 v41, v41
    v_exp_f32 v42, v42
    v_exp_f32 v43, v43
    v_exp_f32 v44, v44
    v_exp_f32 v45, v45
    v_exp_f32 v46, v46
    v_exp_f32 v47, v47
    v_exp_f32 v48, v48
    v_exp_f32 v49, v49
    v_exp_f32 v50, v50
    v_exp_f32 v51, v51
    v_cvt_pk_bf16_f32 v68, v36, v37
    v_cvt_pk_bf16_f32 v69, v38, v39
    v_cvt_pk_bf16_f32 v70, v40, v41
    v_cvt_pk_bf16_f32 v71, v42, v43
    v_cvt_pk_bf16_f32 v72, v44, v45
    v_cvt_pk_bf16_f32 v73, v46, v47
    v_cvt_pk_bf16_f32 v74, v48, v49
    v_cvt_pk_bf16_f32 v75, v50, v51
    v_mfma_f32_32x32x16_bf16 v[76:91], a[64:67], v[68:71], v[76:91]
    s_nop 0
    v_mfma_f32_32x32x16_bf16 v[76:91], a[68:71], v[72:75], v[76:91]
    s_add_u32 s30, s30, 512
    s_add_u32 s31, s31, 512
    s_sub_u32 s28, s28, 1
    s_cmp_lg_u32 s28, 0
    s_cbranch_scc1 Lsl63
    s_nop 6
    v_mov_b32 v156, v76
    v_mov_b32 v157, v77
    v_mov_b32 v158, v78
    v_mov_b32 v159, v79
    v_mov_b32 v160, v80
    v_mov_b32 v161, v81
    v_mov_b32 v162, v82
    v_mov_b32 v163, v83
    v_mov_b32 v164, v84
    v_mov_b32 v165, v85
    v_mov_b32 v166, v86
    v_mov_b32 v167, v86
    s_nop 1
    v_permlane32_swap_b32 v166, v167
    s_branch Lfin28

.section .rodata,"a"
.p2align 6
.amdhsa_kernel sequential_preLN__softmax_full_mha__swiglu_ffn__prompt_kernel
  .amdhsa_next_free_vgpr 512
  .amdhsa_next_free_sgpr 102
  .amdhsa_accum_offset 256
  .amdhsa_group_segment_fixed_size 0
  .amdhsa_kernarg_size 80
  .amdhsa_user_sgpr_count 2
  .amdhsa_user_sgpr_kernarg_segment_ptr 1
  .amdhsa_system_sgpr_workgroup_id_x 1
.end_amdhsa_kernel
```
